```python
import torch

def _softmax(x, axis=-1):
    return torch.softmax(x, dim=axis)

def _gelu(x):
    return torch.nn.functional.gelu(x, approximate='tanh')

def _silu(x):
    return torch.nn.functional.silu(x)

def _sigmoid(x):
    return torch.sigmoid(x)

def _layernorm(x, axis=-1, eps=1e-05):
    m = x.mean(dim=axis, keepdim=True)
    v = x.var(dim=axis, keepdim=True, unbiased=False)
    return (x - m) / torch.sqrt(v + eps)

def _scatter_add(tgt, idx, src, axis=0):
    return tgt.clone().index_add_(axis, idx, src)

def _segment_sum(src, seg, n):
    out = torch.zeros((n,) + src.shape[1:], dtype=src.dtype)
    return out.index_add_(0, seg, src)

def _pad(x, pw):
    flat = tuple((v for pair in reversed(pw) for v in pair))
    return torch.nn.functional.pad(x, flat)
kernel_name = 'adaLN_cond__sliding_block__mixer_gmlp__prompt'

def setup_inputs():

    _w = lambda a: (lambda t: t.to(torch.bfloat16) if t.is_floating_point() else t)(torch.as_tensor(a))

    def _A_setup():
        B, S, D = (1, 2048, 448)
        return {'x': _w((lambda *s: torch.randn(*s, dtype=torch.bfloat16) * 0.05)(B, S, D)), 'wqkv': _w((lambda *s: torch.randn(*s, dtype=torch.bfloat16) * 0.05)(D, 3 * D)), 'wo': _w((lambda *s: torch.randn(*s, dtype=torch.bfloat16) * 0.05)(D, D))}
    _A_in = _A_setup()

    def _B_setup():
        B, S, D, F = (1, 2048, 448, 1792)
        Fh = F // 2
        return {'x': _w((lambda *s: torch.randn(*s, dtype=torch.bfloat16) * 0.05)(B, S, D)), 'w_in': _w((lambda *s: torch.randn(*s, dtype=torch.bfloat16) * 0.4)(D, 2 * Fh)), 'w_sp': _w(0.01 * (lambda *s: torch.randn(*s, dtype=torch.bfloat16) * 0.4)(S, S)), 'b_sp': _w(1.0 + 0.01 * (lambda *s: torch.randn(*s, dtype=torch.bfloat16) * 0.05)(S)), 'w_out': _w((lambda *s: torch.randn(*s, dtype=torch.bfloat16) * 0.05)(Fh, D))}
    _B_in = _B_setup()
    return {'A_x': _A_in['x'], 'A_wqkv': _A_in['wqkv'], 'A_wo': _A_in['wo'], 'B_x': _B_in['x'], 'B_w_in': _B_in['w_in'], 'B_w_sp': _B_in['w_sp'], 'B_b_sp': _B_in['b_sp'], 'B_w_out': _B_in['w_out'], 'c': _w((lambda *s: torch.randn(*s, dtype=torch.bfloat16) * 0.1)(1, 448) * 8.0), 'w_mod': _w((lambda *s: torch.randn(*s, dtype=torch.bfloat16) * 0.1)(448, 6 * 448) * 448 ** (-0.5) * 8.0)}

def reference(A_x, A_wqkv, A_wo, B_x, B_w_in, B_w_sp, B_b_sp, B_w_out, c, w_mod):

    def _A_ref(x, wqkv, wo):
        B, S, D = x.shape
        H = 16
        Dh = D // H
        W = 256
        qkv = (lambda x, *d: x.permute(*d))((x @ wqkv).reshape(B, S, 3, H, Dh), 2, 0, 3, 1, 4)
        q, k, v = (qkv[0], qkv[1], qkv[2])
        scores = torch.einsum('bhqd,bhkd->bhqk', q, k) * Dh ** (-0.5)
        idx = torch.arange(S)
        mask = (idx[:, None] - idx[None, :] >= 0) & (idx[:, None] - idx[None, :] < W)
        scores = torch.where(mask[None, None], scores, -1000000000.0)
        p = _softmax(scores, axis=-1)
        o = torch.einsum('bhqk,bhkd->bhqd', p, v)
        return (lambda x, *d: x.permute(*d))(o, 0, 2, 1, 3).reshape(B, S, D) @ wo

    def _B_ref(x, w_in, w_sp, b_sp, w_out):
        B, S, D = x.shape
        F = w_in.shape[-1]
        Fh = F // 2
        z = _gelu(torch.einsum('bsd,df->bsf', x, w_in))
        z1 = z[..., :Fh].clone()
        z2 = _layernorm(z[..., Fh:], axis=-1)
        g = torch.einsum('ts,bsf->btf', w_sp, z2) + b_sp[None, :, None]
        return torch.einsum('bsf,fd->bsd', z1 * g, w_out)
    x = A_x
    mod = (_silu(c) @ w_mod).reshape(c.shape[0], 6, 1, -1)
    sa, ca, ga, sb, cb, gb = (mod[:, 0].clone(), mod[:, 1].clone(), mod[:, 2].clone(), mod[:, 3].clone(), mod[:, 4].clone(), mod[:, 5].clone())
    h = _layernorm(x, axis=-1) * (1 + ca) + sa
    x = x + ga * _A_ref(h, A_wqkv, A_wo)
    h = _layernorm(x, axis=-1) * (1 + cb) + sb
    x = x + gb * _B_ref(h, B_w_in, B_w_sp, B_b_sp, B_w_out)
    return x
```

```asm
; @launch grid=(256,1,1) block=(256,1,1) lds=163840
.amdgcn_target "amdgcn-amd-amdhsa--gfx950"
.text
.globl adaLN_cond__sliding_block__mixer_gmlp__prompt_kernel
.p2align 8
.type adaLN_cond__sliding_block__mixer_gmlp__prompt_kernel,@function
adaLN_cond__sliding_block__mixer_gmlp__prompt_kernel:
    s_cmp_ge_u32 s2, 256
    s_nop 0
    s_cbranch_scc1 L_end
    s_load_dwordx2 s[4:5], s[0:1], 96
    s_load_dwordx2 s[8:9], s[0:1], 64
    s_load_dwordx2 s[12:13], s[0:1], 72
    s_load_dwordx2 s[16:17], s[0:1], 0
    s_load_dwordx2 s[20:21], s[0:1], 8
    s_load_dwordx2 s[24:25], s[0:1], 88
    v_and_b32 v1, 63, v0
    v_lshrrev_b32 v0, 6, v0
    v_mov_b32 v2, 0
    v_lshlrev_b32 v3, 4, v1
    v_readfirstlane_b32 s30, v0
    s_mov_b32 s3, s2
    s_and_b32 s28, s2, 7
    s_lshr_b32 s29, s2, 3
    s_lshr_b32 s39, s29, 4
    s_lshl_b32 s31, s28, 1
    s_add_u32 s31, s31, s39
    s_and_b32 s32, s29, 15
    s_lshr_b32 s39, s29, 2
    s_lshl_b32 s33, s28, 3
    s_add_u32 s33, s33, s39
    s_and_b32 s34, s29, 3
    s_lshr_b32 s39, s29, 3
    s_lshl_b32 s35, s28, 2
    s_add_u32 s35, s35, s39
    s_and_b32 s36, s29, 7
    s_lshr_b32 s39, s29, 3
    s_lshl_b32 s39, s39, 3
    s_add_u32 s39, s39, s28
    s_lshl_b32 s39, s39, 3
    s_and_b32 s47, s29, 7
    s_add_u32 s47, s47, s39
    s_mov_b32 s44, 0x4f3f2f10
    s_mov_b32 s45, 0x98f7f6f5
    s_lshl_b32 s39, s32, 2
    s_lshr_b64 s[44:45], s[44:45], s39
    s_and_b32 s39, s44, 15
    s_mul_i32 s48, s28, 14
    s_and_b32 s40, s31, 1
    s_mul_i32 s40, s40, 7
    s_add_u32 s48, s48, s40
    s_add_u32 s48, s48, s39
    s_cmp_lt_u32 s39, 7
    s_cselect_b32 s48, s48, 999
    s_mov_b32 s46, 0xffff0000
    s_getpc_b64 s[44:45]
    L_pc_here1:
    s_lshl_b32 s39, s29, 2
    s_add_u32 s39, s39, s30
    s_mul_i32 s39, s39, 8
    v_and_b32 v8, 7, v1
    v_add_u32 v8, s39, v8
    .set CODE_LINES1, (L_end - L_pc_here1) / 128
    s_mov_b32 s40, CODE_LINES1
    v_min_u32 v8, s40, v8
    v_lshlrev_b32 v8, 7, v8
    v_mov_b32 v7, s45
    v_add_co_u32 v6, vcc, s44, v8
    s_nop 1
    v_addc_co_u32 v7, vcc, 0, v7, vcc
    global_load_dword v9, v[6:7], off
    s_waitcnt lgkmcnt(0)
    s_mov_b32 s6, 25165824
    s_mov_b32 s7, 0x20000
    s_mov_b32 s10, 896
    s_mov_b32 s11, 0x20000
    s_mov_b32 s14, 2408448
    s_mov_b32 s15, 0x20000
    s_mov_b32 s18, 1835008
    s_mov_b32 s19, 0x20000
    s_mov_b32 s22, 1204224
    s_mov_b32 s23, 0x20000
    s_mov_b32 s26, 256
    s_mov_b32 s27, 0x20000
    buffer_load_dword v6, v2, s[4:7], 0 offen sc1
    v_cmp_gt_u32 vcc, 56, v1
    v_mov_b32 v7, 0x7f000000
    s_nop 0
    v_cndmask_b32 v7, v7, v3, vcc
    s_lshl_b32 s39, s31, 4
    s_add_u32 s39, s39, s32
    s_lshl_b32 s39, s39, 2
    s_add_u32 s39, s39, s30
    s_mov_b32 s49, s39
    s_mul_i32 s39, s39, 1792
    buffer_load_dwordx4 v[12:15], v7, s[16:19], s39 offen
    buffer_load_dwordx4 v[16:19], v7, s[16:19], s39 offen offset:896
    s_cmp_ge_u32 s48, 112
    s_nop 0
    s_cbranch_scc1 L_noprod1_1
    s_lshl_b32 s39, s30, 6
    v_add_u32 v28, s39, v1
    v_lshlrev_b32 v29, 1, v28
    s_mov_b32 s40, 5376
    buffer_load_ushort v10, v29, s[8:11], 0 offen
    buffer_load_ushort v11, v29, s[8:11], 0 offen offset:512
    v_mul_lo_u32 v28, v28, s40
    s_lshl_b32 s39, s48, 4
    s_add_u32 s39, s39, 0
    s_add_u32 s40, s39, 1376256
    buffer_load_dwordx4 v[20:23], v28, s[12:15], s39 offen
    buffer_load_dwordx4 v[24:27], v28, s[12:15], s40 offen
    s_nop 1
L_noprod1_1:
    v_lshrrev_b32 v28, 3, v1
    v_mul_u32_u24 v30, 896, v28
    v_lshrrev_b32 v28, 4, v1
    v_and_b32 v29, 7, v1
    v_xor_b32 v28, v28, v29
    v_lshl_add_u32 v31, v28, 4, v30
    v_xor_b32 v28, 4, v28
    v_lshl_add_u32 v30, v28, 4, v30
    s_lshl_b32 s39, s31, 2
    s_add_u32 s39, s39, s30
    s_mul_i32 s50, s39, 28672
    s_mul_i32 s51, s30, 28672
    v_bfe_u32 v28, v1, 3, 2
    v_mul_u32_u24 v32, 7168, v28
    v_and_b32 v28, 7, v1
    v_lshl_add_u32 v32, v28, 7, v32
    s_mul_i32 s39, s30, 28672
    v_add_u32 v32, s39, v32
    v_bfe_u32 v28, v1, 1, 3
    v_lshrrev_b32 v29, 5, v1
    v_xor_b32 v28, v28, v29
    v_xor_b32 v29, 6, v28
    v_lshl_add_u32 v35, v29, 4, v32
    v_xor_b32 v29, 4, v28
    v_lshl_add_u32 v34, v29, 4, v32
    v_xor_b32 v29, 2, v28
    v_lshl_add_u32 v33, v29, 4, v32
    v_xor_b32 v29, 0, v28
    v_lshl_add_u32 v32, v29, 4, v32
    v_cmp_le_u32 s[52:53], 32, v1
    v_lshrrev_b32 v8, 2, v1
    v_mul_u32_u24 v8, 2688, v8
    v_and_b32 v7, 3, v1
    v_lshl_add_u32 v8, v7, 4, v8
    s_mul_i32 s54, s32, 56
    s_and_b32 s39, s32, 1
    s_lshl_b32 s39, s39, 3
    s_sub_u32 s54, s54, s39
    s_mul_i32 s39, s30, 43008
    s_add_u32 s54, s54, s39
    s_lshl_b32 s55, s30, 10
    v_lshrrev_b32 v36, 5, v1
    v_lshlrev_b32 v28, 8, v36
    v_bfe_u32 v36, v1, 2, 2
    v_lshl_add_u32 v28, v36, 6, v28
    v_bfe_u32 v36, v1, 4, 1
    v_lshl_add_u32 v28, v36, 5, v28
    v_and_b32 v36, 3, v1
    v_lshl_add_u32 v28, v36, 3, v28
    s_and_b32 s39, s32, 1
    s_lshl_b32 s39, s39, 3
    v_add_u32 v28, s39, v28
    s_mov_b32 s39, 114688
    v_add_u32 v7, s39, v28
    v_and_b32 v29, 31, v1
    v_lshlrev_b32 v29, 3, v29
    v_add_u32 v29, 157696, v29
    v_bfe_u32 v36, v1, 3, 1
    v_lshrrev_b32 v37, 5, v1
    v_cmp_eq_u32 vcc, v36, v37
    v_and_b32 v36, 1, v1
    v_lshlrev_b32 v36, 4, v36
    v_mov_b32 v37, 0xffff
    v_lshlrev_b32 v37, v36, v37
    v_cndmask_b32 v37, 0, v37, vcc
    v_bfe_u32 v36, v1, 1, 2
    v_bfe_u32 v38, v1, 4, 1
    v_lshl_add_u32 v36, v38, 2, v36
    v_cmp_eq_u32 vcc, 0, v36
    s_nop 1
    v_cndmask_b32 v40, 0, v37, vcc
    v_cmp_eq_u32 vcc, 1, v36
    s_nop 1
    v_cndmask_b32 v41, 0, v37, vcc
    v_cmp_eq_u32 vcc, 2, v36
    s_nop 1
    v_cndmask_b32 v42, 0, v37, vcc
    v_cmp_eq_u32 vcc, 3, v36
    s_nop 1
    v_cndmask_b32 v43, 0, v37, vcc
    v_cmp_eq_u32 vcc, 4, v36
    s_nop 1
    v_cndmask_b32 v44, 0, v37, vcc
    v_cmp_eq_u32 vcc, 5, v36
    s_nop 1
    v_cndmask_b32 v45, 0, v37, vcc
    v_cmp_eq_u32 vcc, 6, v36
    s_nop 1
    v_cndmask_b32 v46, 0, v37, vcc
    v_cmp_eq_u32 vcc, 7, v36
    s_nop 1
    v_cndmask_b32 v47, 0, v37, vcc
    v_mov_b32 v36, -1
    v_cndmask_b32 v39, v36, v2, s[52:53]
    s_waitcnt vmcnt(2)
    v_readfirstlane_b32 s39, v6
    s_nop 3
    s_mul_i32 s37, s39, 0x9E3779B1
    s_add_u32 s37, s37, 0x7F4A7C15
    s_not_b32 s38, s37
    v_mov_b32 v4, s37
    v_mov_b32 v5, s38
    s_mov_b32 s56, 0x3f803f80
    v_mov_b32 v48, 0
    v_mov_b32 v49, 0
    v_mov_b32 v50, 0
    v_mov_b32 v51, 0
    s_waitcnt vmcnt(1)
    v_dot2_f32_bf16 v48, v12, s56, v48
    v_dot2_f32_bf16 v50, v12, v12, v50
    s_waitcnt vmcnt(0)
    v_dot2_f32_bf16 v49, v16, s56, v49
    v_dot2_f32_bf16 v51, v16, v16, v51
    v_dot2_f32_bf16 v48, v13, s56, v48
    v_dot2_f32_bf16 v50, v13, v13, v50
    v_dot2_f32_bf16 v49, v17, s56, v49
    v_dot2_f32_bf16 v51, v17, v17, v51
    v_dot2_f32_bf16 v48, v14, s56, v48
    v_dot2_f32_bf16 v50, v14, v14, v50
    v_dot2_f32_bf16 v49, v18, s56, v49
    v_dot2_f32_bf16 v51, v18, v18, v51
    v_dot2_f32_bf16 v48, v15, s56, v48
    v_dot2_f32_bf16 v50, v15, v15, v50
    v_dot2_f32_bf16 v49, v19, s56, v49
    v_dot2_f32_bf16 v51, v19, v19, v51
    s_nop 1
    v_permlane32_swap_b32 v48, v49
    v_permlane32_swap_b32 v50, v51
    v_add_f32 v48, v48, v49
    v_add_f32 v50, v50, v51
    s_nop 1
    v_permlane16_swap_b32 v48, v50
    v_add_f32 v48, v48, v50
    s_nop 1
    v_add_f32_dpp v48, v48, v48 row_ror:8 row_mask:0xf bank_mask:0xf
    s_nop 1
    v_add_f32_dpp v48, v48, v48 row_ror:4 row_mask:0xf bank_mask:0xf
    s_nop 1
    v_add_f32_dpp v48, v48, v48 row_ror:2 row_mask:0xf bank_mask:0xf
    s_nop 1
    v_add_f32_dpp v48, v48, v48 row_ror:1 row_mask:0xf bank_mask:0xf
    v_mov_b32 v50, v48
    s_nop 1
    v_permlane16_swap_b32 v48, v50
    v_mul_f32 v48, 0x3b124925, v48
    v_mul_f32 v50, 0x3b124925, v50
    v_fma_f32 v6, -v48, v48, v50
    v_max_f32 v6, 0, v6
    v_add_f32 v50, 0x3727c5ac, v6
    v_sub_f32 v52, 0, v48
    v_mov_b32 v53, v50
    v_mov_b32 v54, v4
    v_mov_b32 v55, v5
    v_lshrrev_b32 v6, 5, v1
    v_lshlrev_b32 v6, 4, v6
    s_lshl_b32 s39, s49, 5
    s_add_u32 s39, s39, 983040
    s_mov_b32 s44, 1
    s_mov_b32 s45, 1
    s_mov_b64 exec, s[44:45]
    buffer_store_dwordx4 v[52:55], v6, s[4:7], s39 offen sc1
    s_mov_b64 exec, -1
    s_cmp_ge_u32 s48, 112
    s_nop 0
    s_cbranch_scc1 L_noprod2_2
    v_lshlrev_b32 v57, 16, v10
    v_mul_f32 v56, 0xbfb8aa3b, v57
    v_exp_f32 v56, v56
    s_nop 0
    v_add_f32 v56, 1.0, v56
    v_rcp_f32 v56, v56
    s_nop 0
    v_mul_f32 v56, v57, v56
    v_cvt_pk_bf16_f32 v56, v56, v56
    v_and_b32 v36, s46, v56
    v_lshlrev_b32 v48, 16, v20
    v_and_b32 v49, s46, v20
    v_lshlrev_b32 v50, 16, v21
    v_and_b32 v51, s46, v21
    v_lshlrev_b32 v52, 16, v22
    v_and_b32 v53, s46, v22
    v_lshlrev_b32 v54, 16, v23
    v_and_b32 v55, s46, v23
    v_pk_mul_f32 v[12:13], v[48:49], v[36:37] op_sel_hi:[1,0]
    v_pk_mul_f32 v[14:15], v[50:51], v[36:37] op_sel_hi:[1,0]
    v_pk_mul_f32 v[16:17], v[52:53], v[36:37] op_sel_hi:[1,0]
    v_pk_mul_f32 v[18:19], v[54:55], v[36:37] op_sel_hi:[1,0]
    v_lshlrev_b32 v57, 16, v11
    v_mul_f32 v56, 0xbfb8aa3b, v57
    v_exp_f32 v56, v56
    s_nop 0
    v_add_f32 v56, 1.0, v56
    v_rcp_f32 v56, v56
    s_nop 0
    v_mul_f32 v56, v57, v56
    v_cvt_pk_bf16_f32 v56, v56, v56
    v_and_b32 v36, s46, v56
    v_lshlrev_b32 v48, 16, v24
    v_and_b32 v49, s46, v24
    v_lshlrev_b32 v50, 16, v25
    v_and_b32 v51, s46, v25
    v_lshlrev_b32 v52, 16, v26
    v_and_b32 v53, s46, v26
    v_lshlrev_b32 v54, 16, v27
    v_and_b32 v55, s46, v27
    v_pk_fma_f32 v[12:13], v[48:49], v[36:37], v[12:13] op_sel_hi:[1,0,1]
    v_pk_fma_f32 v[14:15], v[50:51], v[36:37], v[14:15] op_sel_hi:[1,0,1]
    v_pk_fma_f32 v[16:17], v[52:53], v[36:37], v[16:17] op_sel_hi:[1,0,1]
    v_pk_fma_f32 v[18:19], v[54:55], v[36:37], v[18:19] op_sel_hi:[1,0,1]
    v_permlane32_swap_b32 v12, v13
    v_permlane32_swap_b32 v14, v15
    v_permlane32_swap_b32 v16, v17
    v_permlane32_swap_b32 v18, v19
    v_add_f32 v48, v12, v13
    v_add_f32 v49, v14, v15
    v_add_f32 v50, v16, v17
    v_add_f32 v51, v18, v19
    v_permlane16_swap_b32 v48, v49
    s_nop 0
    v_permlane16_swap_b32 v50, v51
    v_add_f32 v12, v48, v49
    v_add_f32 v13, v50, v51
    s_nop 0
    v_add_f32_dpp v12, v12, v12 row_ror:8 row_mask:0xf bank_mask:0xf
    v_add_f32_dpp v13, v13, v13 row_ror:8 row_mask:0xf bank_mask:0xf
    s_nop 0
    v_add_f32_dpp v12, v12, v12 row_ror:4 row_mask:0xf bank_mask:0xf
    v_add_f32_dpp v13, v13, v13 row_ror:4 row_mask:0xf bank_mask:0xf
    s_nop 0
    v_add_f32_dpp v12, v12, v12 row_ror:2 row_mask:0xf bank_mask:0xf
    v_add_f32_dpp v13, v13, v13 row_ror:2 row_mask:0xf bank_mask:0xf
    s_nop 0
    v_add_f32_dpp v12, v12, v12 row_ror:1 row_mask:0xf bank_mask:0xf
    v_add_f32_dpp v13, v13, v13 row_ror:1 row_mask:0xf bank_mask:0xf
    v_bfe_u32 v57, v1, 4, 1
    v_lshlrev_b32 v56, 1, v57
    v_lshrrev_b32 v57, 5, v1
    v_add_u32 v56, v56, v57
    v_lshlrev_b32 v56, 4, v56
    s_lshl_b32 s39, s30, 2
    s_add_u32 s39, s39, 161280
    v_add_u32 v56, s39, v56
    ds_write_b32 v56, v12
    ds_write_b32 v56, v13 offset:64
    s_waitcnt lgkmcnt(0)
    s_barrier
    s_cmp_lg_u32 s30, 0
    s_nop 0
    s_cbranch_scc1 L_modw_3
    v_and_b32 v56, 7, v1
    v_lshlrev_b32 v57, 4, v56
    v_add_u32 v57, 161280, v57
    ds_read_b128 v[48:51], v57
    v_and_b32 v53, 1, v56
    v_lshlrev_b32 v53, 4, v53
    v_lshrrev_b32 v53, v53, v4
    v_and_b32 v53, 0xffff, v53
    v_bfe_u32 v54, v56, 1, 1
    v_mul_u32_u24 v54, 0x5a5a, v54
    v_xor_b32 v53, v53, v54
    v_lshlrev_b32 v56, 2, v56
    s_lshl_b32 s39, s48, 5
    s_add_u32 s39, s39, 4096
    s_waitcnt lgkmcnt(0)
    v_add_f32 v48, v48, v49
    v_add_f32 v50, v50, v51
    v_add_f32 v48, v48, v50
    v_cvt_pk_bf16_f32 v48, v48, v48
    v_and_b32 v48, s46, v48
    v_or_b32 v48, v48, v53
    buffer_store_dword v48, v56, s[4:7], s39 offen sc1
    s_nop 1
L_modw_3:
L_noprod2_2:
    s_add_u32 m0, s51, 0
    s_nop 0
    buffer_load_dwordx4 v31, s[16:19], s50 offen offset:0 lds
    s_add_u32 m0, s51, 896
    s_nop 0
    buffer_load_dwordx4 v31, s[16:19], s50 offen offset:128 lds
    s_add_u32 m0, s51, 1792
    s_nop 0
    buffer_load_dwordx4 v31, s[16:19], s50 offen offset:256 lds
    s_add_u32 m0, s51, 2688
    s_nop 0
    buffer_load_dwordx4 v31, s[16:19], s50 offen offset:384 lds
    s_add_u32 m0, s51, 3584
    s_nop 0
    buffer_load_dwordx4 v31, s[16:19], s50 offen offset:512 lds
    s_add_u32 m0, s51, 4480
    s_nop 0
    buffer_load_dwordx4 v31, s[16:19], s50 offen offset:640 lds
    s_add_u32 m0, s51, 5376
    s_nop 0
    buffer_load_dwordx4 v31, s[16:19], s50 offen offset:768 lds
    s_add_u32 s50, s50, 7168
    s_add_u32 m0, s51, 7168
    s_nop 0
    buffer_load_dwordx4 v30, s[16:19], s50 offen offset:0 lds
    s_add_u32 m0, s51, 8064
    s_nop 0
    buffer_load_dwordx4 v30, s[16:19], s50 offen offset:128 lds
    s_add_u32 m0, s51, 8960
    s_nop 0
    buffer_load_dwordx4 v30, s[16:19], s50 offen offset:256 lds
    s_add_u32 m0, s51, 9856
    s_nop 0
    buffer_load_dwordx4 v30, s[16:19], s50 offen offset:384 lds
    s_add_u32 m0, s51, 10752
    s_nop 0
    buffer_load_dwordx4 v30, s[16:19], s50 offen offset:512 lds
    s_add_u32 m0, s51, 11648
    s_nop 0
    buffer_load_dwordx4 v30, s[16:19], s50 offen offset:640 lds
    s_add_u32 m0, s51, 12544
    s_nop 0
    buffer_load_dwordx4 v30, s[16:19], s50 offen offset:768 lds
    s_add_u32 s50, s50, 7168
    s_add_u32 m0, s51, 14336
    s_nop 0
    buffer_load_dwordx4 v31, s[16:19], s50 offen offset:0 lds
    s_add_u32 m0, s51, 15232
    s_nop 0
    buffer_load_dwordx4 v31, s[16:19], s50 offen offset:128 lds
    s_add_u32 m0, s51, 16128
    s_nop 0
    buffer_load_dwordx4 v31, s[16:19], s50 offen offset:256 lds
    s_add_u32 m0, s51, 17024
    s_nop 0
    buffer_load_dwordx4 v31, s[16:19], s50 offen offset:384 lds
    s_add_u32 m0, s51, 17920
    s_nop 0
    buffer_load_dwordx4 v31, s[16:19], s50 offen offset:512 lds
    s_add_u32 m0, s51, 18816
    s_nop 0
    buffer_load_dwordx4 v31, s[16:19], s50 offen offset:640 lds
    s_add_u32 m0, s51, 19712
    s_nop 0
    buffer_load_dwordx4 v31, s[16:19], s50 offen offset:768 lds
    s_add_u32 s50, s50, 7168
    s_add_u32 m0, s51, 21504
    s_nop 0
    buffer_load_dwordx4 v30, s[16:19], s50 offen offset:0 lds
    s_add_u32 m0, s51, 22400
    s_nop 0
    buffer_load_dwordx4 v30, s[16:19], s50 offen offset:128 lds
    s_add_u32 m0, s51, 23296
    s_nop 0
    buffer_load_dwordx4 v30, s[16:19], s50 offen offset:256 lds
    s_add_u32 m0, s51, 24192
    s_nop 0
    buffer_load_dwordx4 v30, s[16:19], s50 offen offset:384 lds
    s_add_u32 m0, s51, 25088
    s_nop 0
    buffer_load_dwordx4 v30, s[16:19], s50 offen offset:512 lds
    s_add_u32 m0, s51, 25984
    s_nop 0
    buffer_load_dwordx4 v30, s[16:19], s50 offen offset:640 lds
    s_add_u32 m0, s51, 26880
    s_nop 0
    buffer_load_dwordx4 v30, s[16:19], s50 offen offset:768 lds
    s_add_u32 s40, s54, 0
    s_add_u32 m0, s55, 114688
    s_nop 0
    buffer_load_dwordx4 v8, s[20:23], s40 offen lds
    s_add_u32 s40, s54, 896
    s_add_u32 m0, s55, 129024
    s_nop 0
    buffer_load_dwordx4 v8, s[20:23], s40 offen lds
    s_add_u32 s40, s54, 1792
    s_add_u32 m0, s55, 143360
    s_nop 0
    buffer_load_dwordx4 v8, s[20:23], s40 offen lds
    s_add_u32 s40, s54, 172032
    s_add_u32 m0, s55, 118784
    s_nop 0
    buffer_load_dwordx4 v8, s[20:23], s40 offen lds
    s_add_u32 s40, s54, 172928
    s_add_u32 m0, s55, 133120
    s_nop 0
    buffer_load_dwordx4 v8, s[20:23], s40 offen lds
    s_add_u32 s40, s54, 173824
    s_add_u32 m0, s55, 147456
    s_nop 0
    buffer_load_dwordx4 v8, s[20:23], s40 offen lds
    v_and_b32 v6, 31, v1
    v_lshlrev_b32 v6, 4, v6
    s_lshl_b32 s49, s31, 2
    s_add_u32 s49, s49, s30
    s_lshl_b32 s49, s49, 9
    s_add_u32 s49, s49, 983040
    s_lshl_b32 s39, s30, 6
    v_add_u32 v10, s39, v1
    v_min_u32 v10, 223, v10
    v_lshlrev_b32 v11, 4, v10
    s_mov_b32 s42, 4096
    s_mov_b32 s43, 400000
    s_xor_b32 s40, s37, 0x5a5a5a5a
    s_mov_b32 s41, 0x05040100
    buffer_load_dwordx4 v[16:19], v11, s[4:7], s42 offen sc1
    buffer_load_dwordx4 v[12:15], v6, s[4:7], s49 offen sc1
    s_waitcnt vmcnt(8)
    ds_read_b128 a[0:3], v32 offset:0
    ds_read_b128 a[4:7], v33 offset:0
    ds_read_b128 a[8:11], v34 offset:0
    ds_read_b128 a[12:15], v35 offset:0
    ds_read_b128 a[16:19], v32 offset:1024
    ds_read_b128 a[20:23], v33 offset:1024
    ds_read_b128 a[24:27], v34 offset:1024
    ds_read_b128 a[28:31], v35 offset:1024
    ds_read_b128 a[32:35], v32 offset:2048
    ds_read_b128 a[36:39], v33 offset:2048
    ds_read_b128 a[40:43], v34 offset:2048
    ds_read_b128 a[44:47], v35 offset:2048
    ds_read_b128 a[48:51], v32 offset:3072
    ds_read_b128 a[52:55], v33 offset:3072
    ds_read_b128 a[56:59], v34 offset:3072
    ds_read_b128 a[60:63], v35 offset:3072
    ds_read_b128 a[64:67], v32 offset:4096
    ds_read_b128 a[68:71], v33 offset:4096
    ds_read_b128 a[72:75], v34 offset:4096
    ds_read_b128 a[76:79], v35 offset:4096
    ds_read_b128 a[80:83], v32 offset:5120
    ds_read_b128 a[84:87], v33 offset:5120
    ds_read_b128 a[88:91], v34 offset:5120
    ds_read_b128 a[92:95], v35 offset:5120
    ds_read_b128 a[96:99], v32 offset:6144
    ds_read_b128 a[100:103], v33 offset:6144
    ds_read_b128 a[104:107], v34 offset:6144
    ds_read_b128 a[108:111], v35 offset:6144
    s_waitcnt vmcnt(0)
    v_perm_b32 v20, v17, v16, s41
    v_perm_b32 v21, v19, v18, s41
    v_cmp_eq_u32 vcc, s37, v20
    v_cmp_eq_u32 s[44:45], s40, v21
    v_cmp_eq_u32 s[50:51], s37, v14
    s_nop 2
    s_and_b64 vcc, vcc, s[44:45]
    v_cmp_eq_u32 s[44:45], s38, v15
    s_and_b64 vcc, vcc, s[50:51]
    s_nop 2
    s_and_b64 vcc, vcc, s[44:45]
    s_cmp_eq_u64 vcc, -1
    s_nop 0
    s_cbranch_scc1 L_mpolld_5
L_mpoll_4:
    buffer_load_dwordx4 v[16:19], v11, s[4:7], s42 offen sc1
    buffer_load_dwordx4 v[12:15], v6, s[4:7], s49 offen sc1
    s_waitcnt vmcnt(0)
    v_perm_b32 v20, v17, v16, s41
    v_perm_b32 v21, v19, v18, s41
    v_cmp_eq_u32 vcc, s37, v20
    v_cmp_eq_u32 s[44:45], s40, v21
    v_cmp_eq_u32 s[50:51], s37, v14
    s_nop 2
    s_and_b64 vcc, vcc, s[44:45]
    v_cmp_eq_u32 s[44:45], s38, v15
    s_and_b64 vcc, vcc, s[50:51]
    s_nop 2
    s_and_b64 vcc, vcc, s[44:45]
    s_cmp_eq_u64 vcc, -1
    s_nop 0
    s_cbranch_scc1 L_mpolld_5
    s_sub_u32 s43, s43, 1
    s_cmp_lg_u32 s43, 0
    s_nop 0
    s_cbranch_scc1 L_mpoll_4
    v_mov_b32 v20, 1
    s_mov_b32 s39, 0
    buffer_store_dword v20, v2, s[24:27], s39 offen
    s_nop 1
L_mpolld_5:
    s_add_u32 s40, s54, 344064
    s_add_u32 m0, s55, 122880
    s_nop 0
    buffer_load_dwordx4 v8, s[20:23], s40 offen lds
    s_add_u32 s40, s54, 344960
    s_add_u32 m0, s55, 137216
    s_nop 0
    buffer_load_dwordx4 v8, s[20:23], s40 offen lds
    s_add_u32 s40, s54, 345856
    s_add_u32 m0, s55, 151552
    s_nop 0
    buffer_load_dwordx4 v8, s[20:23], s40 offen lds
    v_cmp_le_u32 vcc, 112, v10
    v_and_b32 v16, s46, v16
    v_and_b32 v17, s46, v17
    v_and_b32 v18, s46, v18
    v_and_b32 v19, s46, v19
    v_add_f32 v20, 1.0, v16
    v_add_f32 v21, 1.0, v17
    v_add_f32 v22, 1.0, v18
    v_add_f32 v23, 1.0, v19
    v_cndmask_b32 v16, v16, v20, vcc
    v_cndmask_b32 v17, v17, v21, vcc
    v_cndmask_b32 v18, v18, v22, vcc
    v_cndmask_b32 v19, v19, v23, vcc
    v_cvt_pk_bf16_f32 v16, v16, v16
    v_cvt_pk_bf16_f32 v17, v17, v17
    v_cvt_pk_bf16_f32 v18, v18, v18
    v_cvt_pk_bf16_f32 v19, v19, v19
    v_lshlrev_b32 v11, 1, v11
    v_mov_b32 v20, 4
    v_mov_b32 v21, -3584
    v_cndmask_b32 v20, v20, v21, vcc
    s_mov_b32 s39, 157696
    v_add3_u32 v11, v11, v20, s39
    ds_write2_b32 v11, v16, v17 offset0:0 offset1:2
    ds_write2_b32 v11, v18, v19 offset0:4 offset1:6
    v_rsq_f32 v16, v13
    v_sqrt_f32 v13, v13
    v_cvt_pk_bf16_f32 v10, v12, v12
    v_and_b32 v10, s46, v10
    v_sub_f32 v10, v12, v10
    v_cvt_pk_bf16_f32 v20, v12, v10
    v_cvt_pk_bf16_f32 v10, v13, v13
    v_and_b32 v10, s46, v10
    v_sub_f32 v10, v13, v10
    v_cvt_pk_bf16_f32 v21, v13, v10
    v_cndmask_b32 v20, v20, v2, s[52:53]
    v_cndmask_b32 v21, v21, v2, s[52:53]
    v_mov_b32 v22, 0
    v_mov_b32 v23, 0
    v_and_b32 v10, 31, v1
    v_lshlrev_b32 v10, 2, v10
    s_lshl_b32 s39, s30, 7
    s_add_u32 s39, s39, 161536
    v_add_u32 v10, s39, v10
    ds_write_b32 v10, v16
    s_waitcnt lgkmcnt(0)
    s_barrier
    v_mov_b32 v154, 0
    v_mov_b32 v155, 0
    v_mov_b32 v166, 0
    v_mov_b32 v167, 0
    ds_read_b64 v[10:11], v29 offset:0
    ds_read_b64 v[12:13], v29 offset:256
    ds_read_b64_tr_b16 v[100:101], v7 offset:14336
    ds_read_b64_tr_b16 v[102:103], v7 offset:14848
    ds_read_b64_tr_b16 v[104:105], v7 offset:28672
    ds_read_b64_tr_b16 v[106:107], v7 offset:29184
    ds_read_b64_tr_b16 v[96:97], v7 offset:0
    ds_read_b64_tr_b16 v[98:99], v7 offset:512
    ds_read_b64_tr_b16 v[112:113], v7 offset:15360
    ds_read_b64_tr_b16 v[114:115], v7 offset:15872
    ds_read_b64_tr_b16 v[116:117], v7 offset:29696
    ds_read_b64_tr_b16 v[118:119], v7 offset:30208
    ds_read_b64_tr_b16 v[108:109], v7 offset:1024
    ds_read_b64_tr_b16 v[110:111], v7 offset:1536
    s_waitcnt lgkmcnt(13)
    v_and_b32 v144, v10, v40
    v_and_b32 v145, v10, v41
    v_and_b32 v146, v10, v42
    v_and_b32 v147, v10, v43
    v_and_b32 v148, v10, v44
    v_and_b32 v149, v10, v45
    v_and_b32 v150, v10, v46
    v_and_b32 v151, v10, v47
    v_and_b32 v152, v10, v39
    v_and_b32 v153, v11, v39
    v_mfma_f32_32x32x16_bf16 v[168:183], v[144:147], a[0:3], 0
    v_mfma_f32_32x32x16_bf16 v[168:183], v[148:151], a[4:7], v[168:183]
    v_mfma_f32_32x32x16_bf16 v[168:183], v[152:155], v[20:23], v[168:183]
    s_waitcnt lgkmcnt(12)
    v_and_b32 v156, v12, v40
    v_and_b32 v157, v12, v41
    v_and_b32 v158, v12, v42
    v_and_b32 v159, v12, v43
    v_and_b32 v160, v12, v44
    v_and_b32 v161, v12, v45
    v_and_b32 v162, v12, v46
    v_and_b32 v163, v12, v47
    v_and_b32 v164, v12, v39
    v_and_b32 v165, v13, v39
    ds_read_b64 v[10:11], v29 offset:512
    v_cvt_pk_bf16_f32 v184, v168, v169
    v_cvt_pk_bf16_f32 v185, v170, v171
    v_cvt_pk_bf16_f32 v186, v172, v173
    v_cvt_pk_bf16_f32 v187, v174, v175
    v_cvt_pk_bf16_f32 v188, v176, v177
    v_cvt_pk_bf16_f32 v189, v178, v179
    v_cvt_pk_bf16_f32 v190, v180, v181
    v_cvt_pk_bf16_f32 v191, v182, v183
    v_mfma_f32_32x32x16_bf16 v[168:183], v[156:159], a[8:11], 0
    s_waitcnt lgkmcnt(0)
    v_and_b32 v144, v10, v40
    v_and_b32 v145, v10, v41
    ds_read_b64_tr_b16 v[124:125], v7 offset:16384
    ds_read_b64_tr_b16 v[122:123], v7 offset:2560
    v_mfma_f32_32x32x16_bf16 v[168:183], v[160:163], a[12:15], v[168:183]
    v_and_b32 v146, v10, v42
    v_and_b32 v147, v10, v43
    ds_read_b64_tr_b16 v[126:127], v7 offset:16896
    ds_read_b64_tr_b16 v[136:137], v7 offset:17408
    s_add_u32 s40, s54, 516096
    s_mov_b32 s39, 126976
    s_cmp_lt_u32 s30, 2
    s_cselect_b32 s39, s39, 0
    s_add_u32 m0, s55, s39
    s_nop 0
    buffer_load_dwordx4 v8, s[20:23], s40 offen lds
    v_mfma_f32_32x32x16_bf16 v[168:183], v[164:167], v[20:23], v[168:183]
    v_and_b32 v148, v10, v44
    v_and_b32 v149, v10, v45
    ds_read_b64_tr_b16 v[128:129], v7 offset:30720
    ds_read_b64_tr_b16 v[138:139], v7 offset:17920
    s_add_u32 s40, s54, 516992
    s_mov_b32 s39, 141312
    s_cmp_lt_u32 s30, 2
    s_cselect_b32 s39, s39, 14336
    s_add_u32 m0, s55, s39
    s_nop 0
    buffer_load_dwordx4 v8, s[20:23], s40 offen lds
    v_mfma_f32_32x32x16_bf16 v[64:79], v[100:103], v[184:187], 0
    v_and_b32 v150, v10, v46
    v_and_b32 v151, v10, v47
    ds_read_b64_tr_b16 v[130:131], v7 offset:31232
    ds_read_b64_tr_b16 v[134:135], v7 offset:3584
    v_mfma_f32_32x32x16_bf16 v[80:95], v[184:187], v[104:107], 0
    v_and_b32 v152, v10, v39
    v_and_b32 v153, v11, v39
    ds_read_b64_tr_b16 v[120:121], v7 offset:2048
    ds_read_b64 v[12:13], v29 offset:768
    s_add_u32 s40, s54, 517888
    s_mov_b32 s39, 155648
    s_cmp_lt_u32 s30, 2
    s_cselect_b32 s39, s39, 28672
    s_add_u32 m0, s55, s39
    s_nop 0
    buffer_load_dwordx4 v8, s[20:23], s40 offen lds
    v_mfma_f32_32x32x16_bf16 v[48:63], v[96:99], v[184:187], 0
    v_cvt_pk_bf16_f32 v192, v168, v169
    v_cvt_pk_bf16_f32 v193, v170, v171
    ds_read_b64_tr_b16 v[140:141], v7 offset:31744
    s_add_u32 s40, s54, 688128
    s_add_u32 m0, s55, 4096
    s_nop 0
    buffer_load_dwordx4 v8, s[20:23], s40 offen lds
    v_mfma_f32_32x32x16_bf16 v[64:79], v[112:115], v[188:191], v[64:79]
    v_cvt_pk_bf16_f32 v194, v172, v173
    v_cvt_pk_bf16_f32 v195, v174, v175
    ds_read_b64_tr_b16 v[142:143], v7 offset:32256
    v_mfma_f32_32x32x16_bf16 v[80:95], v[188:191], v[116:119], v[80:95]
    v_cvt_pk_bf16_f32 v196, v176, v177
    v_cvt_pk_bf16_f32 v197, v178, v179
    ds_read_b64_tr_b16 v[132:133], v7 offset:3072
    s_add_u32 s40, s54, 689024
    s_add_u32 m0, s55, 18432
    s_nop 0
    buffer_load_dwordx4 v8, s[20:23], s40 offen lds
    v_mfma_f32_32x32x16_bf16 v[48:63], v[108:111], v[188:191], v[48:63]
    v_cvt_pk_bf16_f32 v198, v180, v181
    v_cvt_pk_bf16_f32 v199, v182, v183
    s_add_u32 s40, s54, 689920
    s_add_u32 m0, s55, 32768
    s_nop 0
    buffer_load_dwordx4 v8, s[20:23], s40 offen lds
    v_mfma_f32_32x32x16_bf16 v[168:183], v[144:147], a[16:19], 0
    s_waitcnt lgkmcnt(3)
    v_and_b32 v156, v12, v40
    v_and_b32 v157, v12, v41
    ds_read_b64_tr_b16 v[100:101], v7 offset:18432
    ds_read_b64_tr_b16 v[98:99], v7 offset:4608
    v_mfma_f32_32x32x16_bf16 v[168:183], v[148:151], a[20:23], v[168:183]
    v_and_b32 v158, v12, v42
    v_and_b32 v159, v12, v43
    ds_read_b64_tr_b16 v[102:103], v7 offset:18944
    ds_read_b64_tr_b16 v[112:113], v7 offset:19456
    s_add_u32 s40, s54, 860160
    s_add_u32 m0, s55, 8192
    s_nop 0
    buffer_load_dwordx4 v8, s[20:23], s40 offen lds
    v_mfma_f32_32x32x16_bf16 v[168:183], v[152:155], v[20:23], v[168:183]
    v_and_b32 v160, v12, v44
    v_and_b32 v161, v12, v45
    ds_read_b64_tr_b16 v[104:105], v7 offset:32768
    ds_read_b64_tr_b16 v[114:115], v7 offset:19968
    s_add_u32 s40, s54, 861056
    s_add_u32 m0, s55, 22528
    s_nop 0
    buffer_load_dwordx4 v8, s[20:23], s40 offen lds
    v_mfma_f32_32x32x16_bf16 v[64:79], v[124:127], v[192:195], v[64:79]
    v_and_b32 v162, v12, v46
    v_and_b32 v163, v12, v47
    ds_read_b64_tr_b16 v[106:107], v7 offset:33280
    ds_read_b64_tr_b16 v[110:111], v7 offset:5632
    v_mfma_f32_32x32x16_bf16 v[80:95], v[192:195], v[128:131], v[80:95]
    v_and_b32 v164, v12, v39
    v_and_b32 v165, v13, v39
    ds_read_b64_tr_b16 v[96:97], v7 offset:4096
    ds_read_b64 v[10:11], v29 offset:1024
    s_add_u32 s40, s54, 861952
    s_add_u32 m0, s55, 36864
    s_nop 0
    buffer_load_dwordx4 v8, s[20:23], s40 offen lds
    v_mfma_f32_32x32x16_bf16 v[48:63], v[120:123], v[192:195], v[48:63]
    v_cvt_pk_bf16_f32 v184, v168, v169
    v_cvt_pk_bf16_f32 v185, v170, v171
    ds_read_b64_tr_b16 v[116:117], v7 offset:33792
    s_add_u32 s40, s54, 1032192
    s_add_u32 m0, s55, 12288
    s_nop 0
    buffer_load_dwordx4 v8, s[20:23], s40 offen lds
    v_mfma_f32_32x32x16_bf16 v[64:79], v[136:139], v[196:199], v[64:79]
    v_cvt_pk_bf16_f32 v186, v172, v173
    v_cvt_pk_bf16_f32 v187, v174, v175
    ds_read_b64_tr_b16 v[118:119], v7 offset:34304
    s_waitcnt lgkmcnt(13)
    v_mfma_f32_32x32x16_bf16 v[80:95], v[196:199], v[140:143], v[80:95]
    v_cvt_pk_bf16_f32 v188, v176, v177
    v_cvt_pk_bf16_f32 v189, v178, v179
    ds_read_b64_tr_b16 v[108:109], v7 offset:5120
    s_add_u32 s40, s54, 1033088
    s_add_u32 m0, s55, 26624
    s_nop 0
    buffer_load_dwordx4 v8, s[20:23], s40 offen lds
    s_waitcnt lgkmcnt(13)
    v_mfma_f32_32x32x16_bf16 v[48:63], v[132:135], v[196:199], v[48:63]
    v_cvt_pk_bf16_f32 v190, v180, v181
    v_cvt_pk_bf16_f32 v191, v182, v183
    s_add_u32 s40, s54, 1033984
    s_add_u32 m0, s55, 40960
    s_nop 0
    buffer_load_dwordx4 v8, s[20:23], s40 offen lds
    v_mfma_f32_32x32x16_bf16 v[168:183], v[156:159], a[24:27], 0
    s_waitcnt lgkmcnt(3)
    v_and_b32 v144, v10, v40
    v_and_b32 v145, v10, v41
    ds_read_b64_tr_b16 v[124:125], v7 offset:20480
    ds_read_b64_tr_b16 v[122:123], v7 offset:6656
    v_mfma_f32_32x32x16_bf16 v[168:183], v[160:163], a[28:31], v[168:183]
    v_and_b32 v146, v10, v42
    v_and_b32 v147, v10, v43
    ds_read_b64_tr_b16 v[126:127], v7 offset:20992
    ds_read_b64_tr_b16 v[136:137], v7 offset:21504
    v_mfma_f32_32x32x16_bf16 v[168:183], v[164:167], v[20:23], v[168:183]
    v_and_b32 v148, v10, v44
    v_and_b32 v149, v10, v45
    ds_read_b64_tr_b16 v[128:129], v7 offset:34816
    ds_read_b64_tr_b16 v[138:139], v7 offset:22016
    v_mfma_f32_32x32x16_bf16 v[64:79], v[100:103], v[184:187], v[64:79]
    v_and_b32 v150, v10, v46
    v_and_b32 v151, v10, v47
    ds_read_b64_tr_b16 v[130:131], v7 offset:35328
    ds_read_b64_tr_b16 v[134:135], v7 offset:7680
    v_mfma_f32_32x32x16_bf16 v[80:95], v[184:187], v[104:107], v[80:95]
    v_and_b32 v152, v10, v39
    v_and_b32 v153, v11, v39
    ds_read_b64_tr_b16 v[120:121], v7 offset:6144
    ds_read_b64 v[12:13], v29 offset:1280
    v_mfma_f32_32x32x16_bf16 v[48:63], v[96:99], v[184:187], v[48:63]
    v_cvt_pk_bf16_f32 v192, v168, v169
    v_cvt_pk_bf16_f32 v193, v170, v171
    ds_read_b64_tr_b16 v[140:141], v7 offset:35840
    v_mfma_f32_32x32x16_bf16 v[64:79], v[112:115], v[188:191], v[64:79]
    v_cvt_pk_bf16_f32 v194, v172, v173
    v_cvt_pk_bf16_f32 v195, v174, v175
    ds_read_b64_tr_b16 v[142:143], v7 offset:36352
    s_waitcnt lgkmcnt(13)
    v_mfma_f32_32x32x16_bf16 v[80:95], v[188:191], v[116:119], v[80:95]
    v_cvt_pk_bf16_f32 v196, v176, v177
    v_cvt_pk_bf16_f32 v197, v178, v179
    ds_read_b64_tr_b16 v[132:133], v7 offset:7168
    s_waitcnt lgkmcnt(13)
    v_mfma_f32_32x32x16_bf16 v[48:63], v[108:111], v[188:191], v[48:63]
    v_cvt_pk_bf16_f32 v198, v180, v181
    v_cvt_pk_bf16_f32 v199, v182, v183
    s_waitcnt vmcnt(12)
    s_waitcnt lgkmcnt(0)
    s_barrier
    v_mfma_f32_32x32x16_bf16 v[168:183], v[144:147], a[32:35], 0
    v_and_b32 v156, v12, v40
    v_and_b32 v157, v12, v41
    ds_read_b64_tr_b16 v[100:101], v7 offset:22528
    ds_read_b64_tr_b16 v[98:99], v7 offset:8704
    v_mfma_f32_32x32x16_bf16 v[168:183], v[148:151], a[36:39], v[168:183]
    v_and_b32 v158, v12, v42
    v_and_b32 v159, v12, v43
    ds_read_b64_tr_b16 v[102:103], v7 offset:23040
    ds_read_b64_tr_b16 v[112:113], v7 offset:23552
    v_mfma_f32_32x32x16_bf16 v[168:183], v[152:155], v[20:23], v[168:183]
    v_and_b32 v160, v12, v44
    v_and_b32 v161, v12, v45
    ds_read_b64_tr_b16 v[104:105], v7 offset:36864
    ds_read_b64_tr_b16 v[114:115], v7 offset:24064
    s_load_dwordx2 s[20:21], s[0:1], 32
    s_load_dwordx2 s[60:61], s[0:1], 56
    s_load_dwordx2 s[64:65], s[0:1], 16
    s_waitcnt lgkmcnt(0)
    s_mov_b32 s22, 1605632
    s_mov_b32 s23, 0x20000
    s_mov_b32 s62, 802816
    s_mov_b32 s63, 0x20000
    s_mov_b32 s66, 401408
    s_mov_b32 s67, 0x20000
    s_lshl_b32 s49, s3, 2
    s_add_u32 s49, s49, s30
    s_mul_i32 s40, s49, 4682
    s_lshr_b32 s40, s40, 16
    s_mul_i32 s41, s40, 14
    s_sub_u32 s41, s49, s41
    s_mul_i32 s50, s41, 114688
    s_lshl_b32 s42, s40, 7
    s_add_u32 s50, s50, s42
    s_mul_i32 s51, s40, 56
    s_add_u32 s51, s51, s41
    s_lshl_b32 s51, s51, 10
    s_add_u32 s51, s51, 20971520
    s_mov_b32 s54, 14336
    s_mov_b32 s55, 3584
    s_mov_b32 s57, 32
    s_mov_b32 s58, 1024
    s_mov_b32 s68, s20
    s_mov_b32 s69, s21
    s_mov_b32 s70, s22
    s_mov_b32 s71, s23
    s_mov_b32 s59, 0
    s_cmp_lt_u32 s49, 392
    s_nop 0
    s_cbranch_scc1 L_ppD_8
    s_mov_b32 s55, 896
    s_mov_b32 s57, 64
    s_cmp_lt_u32 s49, 784
    s_nop 0
    s_cbranch_scc0 L_ppB_7
    s_sub_u32 s39, s49, 392
    s_mul_i32 s40, s39, 1171
    s_lshr_b32 s40, s40, 16
    s_mul_i32 s41, s40, 56
    s_sub_u32 s41, s39, s41
    s_mul_i32 s50, s41, 14336
    s_lshl_b32 s42, s40, 7
    s_add_u32 s50, s50, s42
    s_mul_i32 s51, s40, 112
    s_add_u32 s51, s51, s41
    s_lshl_b32 s51, s51, 10
    s_add_u32 s51, s51, 17825792
    s_mov_b32 s54, 57344
    s_mov_b32 s58, 512
    s_mov_b32 s59, 1
    s_mov_b32 s68, s60
    s_mov_b32 s69, s61
    s_mov_b32 s70, s62
    s_nop 0
    s_branch L_ppD_8
L_ppB_7:
    s_sub_u32 s39, s49, 784
    s_min_u32 s39, s39, 223
    s_lshr_b32 s40, s39, 5
    s_and_b32 s41, s39, 31
    s_lshr_b32 s42, s41, 1
    s_mul_i32 s50, s42, 28
    s_and_b32 s42, s41, 1
    s_lshl_b32 s42, s42, 4
    s_add_u32 s50, s50, s42
    s_mul_i32 s50, s50, 896
    s_lshl_b32 s42, s40, 7
    s_add_u32 s50, s50, s42
    s_lshl_b32 s51, s40, 6
    s_add_u32 s51, s51, s41
    s_lshl_b32 s51, s51, 10
    s_add_u32 s51, s51, 18677760
    s_cmp_lt_u32 s49, 1008
    s_cselect_b32 s51, s51, 2130706432
    s_mov_b32 s54, 32768
    s_mov_b32 s59, 2
    s_mov_b32 s68, s64
    s_mov_b32 s69, s65
    s_mov_b32 s70, s66
    s_nop 0
L_ppD_8:
    v_lshrrev_b32 v8, 3, v1
    v_mul_lo_u32 v6, v8, s55
    v_and_b32 v8, 7, v1
    v_lshl_add_u32 v6, v8, 4, v6
    s_lshl_b32 s40, s55, 3
    buffer_load_dwordx4 v[200:203], v6, s[68:71], s50 offen
    s_add_u32 s50, s50, s40
    buffer_load_dwordx4 v[204:207], v6, s[68:71], s50 offen
    s_add_u32 s50, s50, s40
    s_cmp_eq_u32 s59, 0
    s_cselect_b32 s50, s50, 2130706432
    buffer_load_dwordx4 v[208:211], v6, s[68:71], s50 offen
    s_add_u32 s50, s50, s40
    buffer_load_dwordx4 v[212:215], v6, s[68:71], s50 offen
    s_lshl_b32 s20, s30, 12
    v_bfe_u32 v24, v1, 2, 2
    v_bfe_u32 v25, v1, 4, 1
    v_lshl_add_u32 v6, v25, 4, v24
    v_lshrrev_b32 v25, 5, v1
    v_lshl_add_u32 v6, v25, 2, v6
    v_lshlrev_b32 v6, 7, v6
    s_cmp_eq_u32 s59, 1
    s_cselect_b32 s39, 3, 2
    v_lshlrev_b32 v25, s39, v25
    v_add_u32 v25, v25, v24
    v_lshlrev_b32 v25, 7, v25
    v_bfe_u32 v26, v1, 4, 1
    v_lshl_add_u32 v25, v26, 5, v25
    s_cmp_eq_u32 s59, 0
    s_cselect_b64 s[44:45], -1, 0
    v_cndmask_b32 v6, v25, v6, s[44:45]
    v_and_b32 v24, 3, v1
    v_lshl_add_u32 v6, v24, 3, v6
    s_add_u32 s39, s20, 98304
    v_add_u32 v6, s39, v6
    v_mov_b32 v30, v6
    v_add_u32 v31, s58, v30
    v_add_u32 v32, s57, v30
    v_add_u32 v33, s58, v32
    v_add_u32 v34, s57, v32
    v_add_u32 v35, s58, v34
    v_add_u32 v36, s57, v34
    v_add_u32 v37, s58, v36
    v_mfma_f32_32x32x16_bf16 v[64:79], v[124:127], v[192:195], v[64:79]
    v_and_b32 v162, v12, v46
    v_and_b32 v163, v12, v47
    ds_read_b64_tr_b16 v[106:107], v7 offset:37376
    ds_read_b64_tr_b16 v[110:111], v7 offset:9728
    v_mfma_f32_32x32x16_bf16 v[80:95], v[192:195], v[128:131], v[80:95]
    v_and_b32 v164, v12, v39
    v_and_b32 v165, v13, v39
    ds_read_b64_tr_b16 v[96:97], v7 offset:8192
    ds_read_b64 v[10:11], v29 offset:1536
    v_mfma_f32_32x32x16_bf16 v[48:63], v[120:123], v[192:195], v[48:63]
    v_cvt_pk_bf16_f32 v184, v168, v169
    v_cvt_pk_bf16_f32 v185, v170, v171
    ds_read_b64_tr_b16 v[116:117], v7 offset:37888
    v_mfma_f32_32x32x16_bf16 v[64:79], v[136:139], v[196:199], v[64:79]
    v_cvt_pk_bf16_f32 v186, v172, v173
    v_cvt_pk_bf16_f32 v187, v174, v175
    ds_read_b64_tr_b16 v[118:119], v7 offset:38400
    v_mfma_f32_32x32x16_bf16 v[80:95], v[196:199], v[140:143], v[80:95]
    v_cvt_pk_bf16_f32 v188, v176, v177
    v_cvt_pk_bf16_f32 v189, v178, v179
    ds_read_b64_tr_b16 v[108:109], v7 offset:9216
    v_mfma_f32_32x32x16_bf16 v[48:63], v[132:135], v[196:199], v[48:63]
    v_cvt_pk_bf16_f32 v190, v180, v181
    v_cvt_pk_bf16_f32 v191, v182, v183
    v_mfma_f32_32x32x16_bf16 v[168:183], v[156:159], a[40:43], 0
    s_waitcnt lgkmcnt(3)
    v_and_b32 v144, v10, v40
    v_and_b32 v145, v10, v41
    ds_read_b64_tr_b16 v[124:125], v7 offset:24576
    ds_read_b64_tr_b16 v[122:123], v7 offset:10752
    v_mfma_f32_32x32x16_bf16 v[168:183], v[160:163], a[44:47], v[168:183]
    v_and_b32 v146, v10, v42
    v_and_b32 v147, v10, v43
    ds_read_b64_tr_b16 v[126:127], v7 offset:25088
    ds_read_b64_tr_b16 v[136:137], v7 offset:25600
    v_mfma_f32_32x32x16_bf16 v[168:183], v[164:167], v[20:23], v[168:183]
    v_and_b32 v148, v10, v44
    v_and_b32 v149, v10, v45
    ds_read_b64_tr_b16 v[128:129], v7 offset:38912
    ds_read_b64_tr_b16 v[138:139], v7 offset:26112
    v_mfma_f32_32x32x16_bf16 v[64:79], v[100:103], v[184:187], v[64:79]
    v_and_b32 v150, v10, v46
    v_and_b32 v151, v10, v47
    ds_read_b64_tr_b16 v[130:131], v7 offset:39424
    ds_read_b64_tr_b16 v[134:135], v7 offset:11776
    v_mfma_f32_32x32x16_bf16 v[80:95], v[184:187], v[104:107], v[80:95]
    v_and_b32 v152, v10, v39
    v_and_b32 v153, v11, v39
    ds_read_b64_tr_b16 v[120:121], v7 offset:10240
    ds_read_b64 v[12:13], v29 offset:1792
    v_mfma_f32_32x32x16_bf16 v[48:63], v[96:99], v[184:187], v[48:63]
    v_cvt_pk_bf16_f32 v192, v168, v169
    v_cvt_pk_bf16_f32 v193, v170, v171
    ds_read_b64_tr_b16 v[140:141], v7 offset:39936
    v_mfma_f32_32x32x16_bf16 v[64:79], v[112:115], v[188:191], v[64:79]
    v_cvt_pk_bf16_f32 v194, v172, v173
    v_cvt_pk_bf16_f32 v195, v174, v175
    ds_read_b64_tr_b16 v[142:143], v7 offset:40448
    s_waitcnt lgkmcnt(13)
    v_mfma_f32_32x32x16_bf16 v[80:95], v[188:191], v[116:119], v[80:95]
    v_cvt_pk_bf16_f32 v196, v176, v177
    v_cvt_pk_bf16_f32 v197, v178, v179
    ds_read_b64_tr_b16 v[132:133], v7 offset:11264
    s_waitcnt lgkmcnt(13)
    v_mfma_f32_32x32x16_bf16 v[48:63], v[108:111], v[188:191], v[48:63]
    v_cvt_pk_bf16_f32 v198, v180, v181
    v_cvt_pk_bf16_f32 v199, v182, v183
    s_waitcnt vmcnt(13)
    s_waitcnt lgkmcnt(0)
    s_barrier
    v_mfma_f32_32x32x16_bf16 v[168:183], v[144:147], a[48:51], 0
    v_and_b32 v156, v12, v40
    v_and_b32 v157, v12, v41
    ds_read_b64_tr_b16 v[100:101], v7 offset:26624
    ds_read_b64_tr_b16 v[98:99], v7 offset:12800
    v_mfma_f32_32x32x16_bf16 v[168:183], v[148:151], a[52:55], v[168:183]
    v_and_b32 v158, v12, v42
    v_and_b32 v159, v12, v43
    ds_read_b64_tr_b16 v[102:103], v7 offset:27136
    ds_read_b64_tr_b16 v[112:113], v7 offset:27648
    v_mfma_f32_32x32x16_bf16 v[168:183], v[152:155], v[20:23], v[168:183]
    v_and_b32 v160, v12, v44
    v_and_b32 v161, v12, v45
    ds_read_b64_tr_b16 v[104:105], v7 offset:40960
    ds_read_b64_tr_b16 v[114:115], v7 offset:28160
    v_mfma_f32_32x32x16_bf16 v[64:79], v[124:127], v[192:195], v[64:79]
    v_and_b32 v162, v12, v46
    v_and_b32 v163, v12, v47
    ds_read_b64_tr_b16 v[106:107], v7 offset:41472
    ds_read_b64_tr_b16 v[110:111], v7 offset:13824
    v_mfma_f32_32x32x16_bf16 v[80:95], v[192:195], v[128:131], v[80:95]
    v_and_b32 v164, v12, v39
    v_and_b32 v165, v13, v39
    ds_read_b64_tr_b16 v[96:97], v7 offset:12288
    ds_read_b64 v[10:11], v29 offset:2048
    v_mfma_f32_32x32x16_bf16 v[48:63], v[120:123], v[192:195], v[48:63]
    v_cvt_pk_bf16_f32 v184, v168, v169
    v_cvt_pk_bf16_f32 v185, v170, v171
    ds_read_b64_tr_b16 v[116:117], v7 offset:41984
    v_mfma_f32_32x32x16_bf16 v[64:79], v[136:139], v[196:199], v[64:79]
    v_cvt_pk_bf16_f32 v186, v172, v173
    v_cvt_pk_bf16_f32 v187, v174, v175
    ds_read_b64_tr_b16 v[118:119], v7 offset:42496
    v_mfma_f32_32x32x16_bf16 v[80:95], v[196:199], v[140:143], v[80:95]
    v_cvt_pk_bf16_f32 v188, v176, v177
    v_cvt_pk_bf16_f32 v189, v178, v179
    ds_read_b64_tr_b16 v[108:109], v7 offset:13312
    v_mfma_f32_32x32x16_bf16 v[48:63], v[132:135], v[196:199], v[48:63]
    v_cvt_pk_bf16_f32 v190, v180, v181
    v_cvt_pk_bf16_f32 v191, v182, v183
    v_mfma_f32_32x32x16_bf16 v[168:183], v[156:159], a[56:59], 0
    s_waitcnt lgkmcnt(3)
    v_and_b32 v144, v10, v40
    v_and_b32 v145, v10, v41
    ds_read_b64_tr_b16 v[124:125], v28 offset:16384
    ds_read_b64_tr_b16 v[122:123], v28 offset:2560
    v_mfma_f32_32x32x16_bf16 v[168:183], v[160:163], a[60:63], v[168:183]
    v_and_b32 v146, v10, v42
    v_and_b32 v147, v10, v43
    ds_read_b64_tr_b16 v[126:127], v28 offset:16896
    ds_read_b64_tr_b16 v[136:137], v28 offset:17408
    v_mfma_f32_32x32x16_bf16 v[168:183], v[164:167], v[20:23], v[168:183]
    v_and_b32 v148, v10, v44
    v_and_b32 v149, v10, v45
    ds_read_b64_tr_b16 v[128:129], v28 offset:30720
    ds_read_b64_tr_b16 v[138:139], v28 offset:17920
    v_mfma_f32_32x32x16_bf16 v[64:79], v[100:103], v[184:187], v[64:79]
    v_and_b32 v150, v10, v46
    v_and_b32 v151, v10, v47
    ds_read_b64_tr_b16 v[130:131], v28 offset:31232
    ds_read_b64_tr_b16 v[134:135], v28 offset:3584
    v_mfma_f32_32x32x16_bf16 v[80:95], v[184:187], v[104:107], v[80:95]
    v_and_b32 v152, v10, v39
    v_and_b32 v153, v11, v39
    ds_read_b64_tr_b16 v[120:121], v28 offset:2048
    ds_read_b64 v[12:13], v29 offset:2304
    v_mfma_f32_32x32x16_bf16 v[48:63], v[96:99], v[184:187], v[48:63]
    v_cvt_pk_bf16_f32 v192, v168, v169
    v_cvt_pk_bf16_f32 v193, v170, v171
    ds_read_b64_tr_b16 v[140:141], v28 offset:31744
    v_mfma_f32_32x32x16_bf16 v[64:79], v[112:115], v[188:191], v[64:79]
    v_cvt_pk_bf16_f32 v194, v172, v173
    v_cvt_pk_bf16_f32 v195, v174, v175
    ds_read_b64_tr_b16 v[142:143], v28 offset:32256
    s_waitcnt lgkmcnt(13)
    v_mfma_f32_32x32x16_bf16 v[80:95], v[188:191], v[116:119], v[80:95]
    v_cvt_pk_bf16_f32 v196, v176, v177
    v_cvt_pk_bf16_f32 v197, v178, v179
    ds_read_b64_tr_b16 v[132:133], v28 offset:3072
    s_waitcnt lgkmcnt(13)
    v_mfma_f32_32x32x16_bf16 v[48:63], v[108:111], v[188:191], v[48:63]
    v_cvt_pk_bf16_f32 v198, v180, v181
    v_cvt_pk_bf16_f32 v199, v182, v183
    s_waitcnt vmcnt(10)
    s_waitcnt lgkmcnt(0)
    s_barrier
    v_mfma_f32_32x32x16_bf16 v[168:183], v[144:147], a[64:67], 0
    v_and_b32 v156, v12, v40
    v_and_b32 v157, v12, v41
    ds_read_b64_tr_b16 v[100:101], v28 offset:18432
    ds_read_b64_tr_b16 v[98:99], v28 offset:4608
    v_mfma_f32_32x32x16_bf16 v[168:183], v[148:151], a[68:71], v[168:183]
    v_and_b32 v158, v12, v42
    v_and_b32 v159, v12, v43
    ds_read_b64_tr_b16 v[102:103], v28 offset:18944
    ds_read_b64_tr_b16 v[112:113], v28 offset:19456
    v_mfma_f32_32x32x16_bf16 v[168:183], v[152:155], v[20:23], v[168:183]
    v_and_b32 v160, v12, v44
    v_and_b32 v161, v12, v45
    ds_read_b64_tr_b16 v[104:105], v28 offset:32768
    ds_read_b64_tr_b16 v[114:115], v28 offset:19968
    v_mfma_f32_32x32x16_bf16 v[64:79], v[124:127], v[192:195], v[64:79]
    v_and_b32 v162, v12, v46
    v_and_b32 v163, v12, v47
    ds_read_b64_tr_b16 v[106:107], v28 offset:33280
    ds_read_b64_tr_b16 v[110:111], v28 offset:5632
    v_mfma_f32_32x32x16_bf16 v[80:95], v[192:195], v[128:131], v[80:95]
    v_and_b32 v164, v12, v39
    v_and_b32 v165, v13, v39
    ds_read_b64_tr_b16 v[96:97], v28 offset:4096
    ds_read_b64 v[10:11], v29 offset:2560
    v_mfma_f32_32x32x16_bf16 v[48:63], v[120:123], v[192:195], v[48:63]
    v_cvt_pk_bf16_f32 v184, v168, v169
    v_cvt_pk_bf16_f32 v185, v170, v171
    ds_read_b64_tr_b16 v[116:117], v28 offset:33792
    v_mfma_f32_32x32x16_bf16 v[64:79], v[136:139], v[196:199], v[64:79]
    v_cvt_pk_bf16_f32 v186, v172, v173
    v_cvt_pk_bf16_f32 v187, v174, v175
    ds_read_b64_tr_b16 v[118:119], v28 offset:34304
    v_mfma_f32_32x32x16_bf16 v[80:95], v[196:199], v[140:143], v[80:95]
    v_cvt_pk_bf16_f32 v188, v176, v177
    v_cvt_pk_bf16_f32 v189, v178, v179
    ds_read_b64_tr_b16 v[108:109], v28 offset:5120
    v_mfma_f32_32x32x16_bf16 v[48:63], v[132:135], v[196:199], v[48:63]
    v_cvt_pk_bf16_f32 v190, v180, v181
    v_cvt_pk_bf16_f32 v191, v182, v183
    s_cmp_ge_u32 s47, 224
    s_nop 8
    s_cbranch_scc1 L_noprod1_9
    s_lshl_b32 s39, s30, 6
    v_add_u32 v14, s39, v1
    v_lshlrev_b32 v15, 1, v14
    s_mov_b32 s40, 5376
    buffer_load_ushort a120, v15, s[8:11], 0 offen
    buffer_load_ushort a121, v15, s[8:11], 0 offen offset:512
    v_mul_lo_u32 v14, v14, s40
    s_lshl_b32 s39, s47, 4
    s_add_u32 s39, s39, 1792
    s_add_u32 s40, s39, 1376256
    buffer_load_dwordx4 a[112:115], v14, s[12:15], s39 offen
    buffer_load_dwordx4 a[116:119], v14, s[12:15], s40 offen
    s_nop 1
L_noprod1_9:
    v_mfma_f32_32x32x16_bf16 v[168:183], v[156:159], a[72:75], 0
    s_waitcnt lgkmcnt(3)
    v_and_b32 v144, v10, v40
    v_and_b32 v145, v10, v41
    ds_read_b64_tr_b16 v[124:125], v28 offset:20480
    ds_read_b64_tr_b16 v[122:123], v28 offset:6656
    v_mfma_f32_32x32x16_bf16 v[168:183], v[160:163], a[76:79], v[168:183]
    v_and_b32 v146, v10, v42
    v_and_b32 v147, v10, v43
    ds_read_b64_tr_b16 v[126:127], v28 offset:20992
    ds_read_b64_tr_b16 v[136:137], v28 offset:21504
    v_mfma_f32_32x32x16_bf16 v[168:183], v[164:167], v[20:23], v[168:183]
    v_and_b32 v148, v10, v44
    v_and_b32 v149, v10, v45
    ds_read_b64_tr_b16 v[128:129], v28 offset:34816
    ds_read_b64_tr_b16 v[138:139], v28 offset:22016
    v_mfma_f32_32x32x16_bf16 v[64:79], v[100:103], v[184:187], v[64:79]
    v_and_b32 v150, v10, v46
    v_and_b32 v151, v10, v47
    ds_read_b64_tr_b16 v[130:131], v28 offset:35328
    ds_read_b64_tr_b16 v[134:135], v28 offset:7680
    v_mfma_f32_32x32x16_bf16 v[80:95], v[184:187], v[104:107], v[80:95]
    v_and_b32 v152, v10, v39
    v_and_b32 v153, v11, v39
    ds_read_b64_tr_b16 v[120:121], v28 offset:6144
    ds_read_b64 v[12:13], v29 offset:2816
    v_mfma_f32_32x32x16_bf16 v[48:63], v[96:99], v[184:187], v[48:63]
    v_cvt_pk_bf16_f32 v192, v168, v169
    v_cvt_pk_bf16_f32 v193, v170, v171
    ds_read_b64_tr_b16 v[140:141], v28 offset:35840
    v_mfma_f32_32x32x16_bf16 v[64:79], v[112:115], v[188:191], v[64:79]
    v_cvt_pk_bf16_f32 v194, v172, v173
    v_cvt_pk_bf16_f32 v195, v174, v175
    ds_read_b64_tr_b16 v[142:143], v28 offset:36352
    s_waitcnt lgkmcnt(13)
    v_mfma_f32_32x32x16_bf16 v[80:95], v[188:191], v[116:119], v[80:95]
    v_cvt_pk_bf16_f32 v196, v176, v177
    v_cvt_pk_bf16_f32 v197, v178, v179
    ds_read_b64_tr_b16 v[132:133], v28 offset:7168
    s_waitcnt lgkmcnt(13)
    v_mfma_f32_32x32x16_bf16 v[48:63], v[108:111], v[188:191], v[48:63]
    v_cvt_pk_bf16_f32 v198, v180, v181
    v_cvt_pk_bf16_f32 v199, v182, v183
    s_waitcnt vmcnt(7)
    s_waitcnt lgkmcnt(0)
    s_barrier
    v_mfma_f32_32x32x16_bf16 v[168:183], v[144:147], a[80:83], 0
    v_and_b32 v156, v12, v40
    v_and_b32 v157, v12, v41
    ds_read_b64_tr_b16 v[100:101], v28 offset:22528
    ds_read_b64_tr_b16 v[98:99], v28 offset:8704
    v_mfma_f32_32x32x16_bf16 v[168:183], v[148:151], a[84:87], v[168:183]
    v_and_b32 v158, v12, v42
    v_and_b32 v159, v12, v43
    ds_read_b64_tr_b16 v[102:103], v28 offset:23040
    ds_read_b64_tr_b16 v[112:113], v28 offset:23552
    v_mfma_f32_32x32x16_bf16 v[168:183], v[152:155], v[20:23], v[168:183]
    v_and_b32 v160, v12, v44
    v_and_b32 v161, v12, v45
    ds_read_b64_tr_b16 v[104:105], v28 offset:36864
    ds_read_b64_tr_b16 v[114:115], v28 offset:24064
    v_mfma_f32_32x32x16_bf16 v[64:79], v[124:127], v[192:195], v[64:79]
    v_and_b32 v162, v12, v46
    v_and_b32 v163, v12, v47
    ds_read_b64_tr_b16 v[106:107], v28 offset:37376
    ds_read_b64_tr_b16 v[110:111], v28 offset:9728
    v_mfma_f32_32x32x16_bf16 v[80:95], v[192:195], v[128:131], v[80:95]
    v_and_b32 v164, v12, v39
    v_and_b32 v165, v13, v39
    ds_read_b64_tr_b16 v[96:97], v28 offset:8192
    ds_read_b64 v[10:11], v29 offset:3072
    v_mfma_f32_32x32x16_bf16 v[48:63], v[120:123], v[192:195], v[48:63]
    v_cvt_pk_bf16_f32 v184, v168, v169
    v_cvt_pk_bf16_f32 v185, v170, v171
    ds_read_b64_tr_b16 v[116:117], v28 offset:37888
    v_mfma_f32_32x32x16_bf16 v[64:79], v[136:139], v[196:199], v[64:79]
    v_cvt_pk_bf16_f32 v186, v172, v173
    v_cvt_pk_bf16_f32 v187, v174, v175
    ds_read_b64_tr_b16 v[118:119], v28 offset:38400
    v_mfma_f32_32x32x16_bf16 v[80:95], v[196:199], v[140:143], v[80:95]
    v_cvt_pk_bf16_f32 v188, v176, v177
    v_cvt_pk_bf16_f32 v189, v178, v179
    ds_read_b64_tr_b16 v[108:109], v28 offset:9216
    v_mfma_f32_32x32x16_bf16 v[48:63], v[132:135], v[196:199], v[48:63]
    v_cvt_pk_bf16_f32 v190, v180, v181
    v_cvt_pk_bf16_f32 v191, v182, v183
    v_mfma_f32_32x32x16_bf16 v[168:183], v[156:159], a[88:91], 0
    s_waitcnt lgkmcnt(3)
    v_and_b32 v144, v10, v40
    v_and_b32 v145, v10, v41
    ds_read_b64_tr_b16 v[124:125], v28 offset:24576
    ds_read_b64_tr_b16 v[122:123], v28 offset:10752
    v_mfma_f32_32x32x16_bf16 v[168:183], v[160:163], a[92:95], v[168:183]
    v_and_b32 v146, v10, v42
    v_and_b32 v147, v10, v43
    ds_read_b64_tr_b16 v[126:127], v28 offset:25088
    ds_read_b64_tr_b16 v[136:137], v28 offset:25600
    s_add_u32 s39, s20, 98304
    v_add_u32 v6, s39, v3
    v_mfma_f32_32x32x16_bf16 v[168:183], v[164:167], v[20:23], v[168:183]
    v_and_b32 v148, v10, v44
    v_and_b32 v149, v10, v45
    ds_read_b64_tr_b16 v[128:129], v28 offset:38912
    ds_read_b64_tr_b16 v[138:139], v28 offset:26112
    s_waitcnt vmcnt(3)
    ds_write_b128 v6, v[200:203] offset:0
    v_mfma_f32_32x32x16_bf16 v[64:79], v[100:103], v[184:187], v[64:79]
    v_and_b32 v150, v10, v46
    v_and_b32 v151, v10, v47
    ds_read_b64_tr_b16 v[130:131], v28 offset:39424
    ds_read_b64_tr_b16 v[134:135], v28 offset:11776
    s_waitcnt vmcnt(2)
    ds_write_b128 v6, v[204:207] offset:1024
    v_mfma_f32_32x32x16_bf16 v[80:95], v[184:187], v[104:107], v[80:95]
    v_and_b32 v152, v10, v39
    v_and_b32 v153, v11, v39
    ds_read_b64_tr_b16 v[120:121], v28 offset:10240
    ds_read_b64 v[12:13], v29 offset:3328
    s_waitcnt vmcnt(1)
    ds_write_b128 v6, v[208:211] offset:2048
    v_mfma_f32_32x32x16_bf16 v[48:63], v[96:99], v[184:187], v[48:63]
    v_cvt_pk_bf16_f32 v192, v168, v169
    v_cvt_pk_bf16_f32 v193, v170, v171
    ds_read_b64_tr_b16 v[140:141], v28 offset:39936
    s_waitcnt vmcnt(0)
    ds_write_b128 v6, v[212:215] offset:3072
    v_mfma_f32_32x32x16_bf16 v[64:79], v[112:115], v[188:191], v[64:79]
    v_cvt_pk_bf16_f32 v194, v172, v173
    v_cvt_pk_bf16_f32 v195, v174, v175
    ds_read_b64_tr_b16 v[142:143], v28 offset:40448
    s_waitcnt lgkmcnt(15)
    v_mfma_f32_32x32x16_bf16 v[80:95], v[188:191], v[116:119], v[80:95]
    v_cvt_pk_bf16_f32 v196, v176, v177
    v_cvt_pk_bf16_f32 v197, v178, v179
    ds_read_b64_tr_b16 v[132:133], v28 offset:11264
    v_mfma_f32_32x32x16_bf16 v[48:63], v[108:111], v[188:191], v[48:63]
    v_cvt_pk_bf16_f32 v198, v180, v181
    v_cvt_pk_bf16_f32 v199, v182, v183
    s_waitcnt lgkmcnt(0)
    s_barrier
    v_mfma_f32_32x32x16_bf16 v[168:183], v[144:147], a[96:99], 0
    v_and_b32 v156, v12, v40
    v_and_b32 v157, v12, v41
    ds_read_b64_tr_b16 v[100:101], v28 offset:26624
    ds_read_b64_tr_b16 v[98:99], v28 offset:12800
    ds_read_b64_tr_b16 v[200:201], v30
    v_mfma_f32_32x32x16_bf16 v[168:183], v[148:151], a[100:103], v[168:183]
    v_and_b32 v158, v12, v42
    v_and_b32 v159, v12, v43
    ds_read_b64_tr_b16 v[102:103], v28 offset:27136
    ds_read_b64_tr_b16 v[112:113], v28 offset:27648
    ds_read_b64_tr_b16 v[202:203], v31
    v_mfma_f32_32x32x16_bf16 v[168:183], v[152:155], v[20:23], v[168:183]
    v_and_b32 v160, v12, v44
    v_and_b32 v161, v12, v45
    ds_read_b64_tr_b16 v[104:105], v28 offset:40960
    ds_read_b64_tr_b16 v[114:115], v28 offset:28160
    ds_read_b64_tr_b16 v[204:205], v32
    v_mfma_f32_32x32x16_bf16 v[64:79], v[124:127], v[192:195], v[64:79]
    v_and_b32 v162, v12, v46
    v_and_b32 v163, v12, v47
    ds_read_b64_tr_b16 v[106:107], v28 offset:41472
    ds_read_b64_tr_b16 v[110:111], v28 offset:13824
    ds_read_b64_tr_b16 v[206:207], v33
    v_mfma_f32_32x32x16_bf16 v[80:95], v[192:195], v[128:131], v[80:95]
    v_and_b32 v164, v12, v39
    v_and_b32 v165, v13, v39
    ds_read_b64_tr_b16 v[96:97], v28 offset:12288
    ds_read_b64_tr_b16 v[208:209], v34
    v_mfma_f32_32x32x16_bf16 v[48:63], v[120:123], v[192:195], v[48:63]
    v_cvt_pk_bf16_f32 v184, v168, v169
    v_cvt_pk_bf16_f32 v185, v170, v171
    ds_read_b64_tr_b16 v[116:117], v28 offset:41984
    ds_read_b64_tr_b16 v[210:211], v35
    v_mfma_f32_32x32x16_bf16 v[64:79], v[136:139], v[196:199], v[64:79]
    v_cvt_pk_bf16_f32 v186, v172, v173
    v_cvt_pk_bf16_f32 v187, v174, v175
    ds_read_b64_tr_b16 v[118:119], v28 offset:42496
    ds_read_b64_tr_b16 v[212:213], v36
    v_mfma_f32_32x32x16_bf16 v[80:95], v[196:199], v[140:143], v[80:95]
    v_cvt_pk_bf16_f32 v188, v176, v177
    v_cvt_pk_bf16_f32 v189, v178, v179
    ds_read_b64_tr_b16 v[108:109], v28 offset:13312
    ds_read_b64_tr_b16 v[214:215], v37
    v_mfma_f32_32x32x16_bf16 v[48:63], v[132:135], v[196:199], v[48:63]
    v_cvt_pk_bf16_f32 v190, v180, v181
    v_cvt_pk_bf16_f32 v191, v182, v183
    v_mfma_f32_32x32x16_bf16 v[168:183], v[156:159], a[104:107], 0
    ds_read_b64_tr_b16 v[124:125], v28 offset:28672
    ds_read_b64_tr_b16 v[122:123], v28 offset:14848
    v_mfma_f32_32x32x16_bf16 v[168:183], v[160:163], a[108:111], v[168:183]
    ds_read_b64_tr_b16 v[126:127], v28 offset:29184
    ds_read_b64_tr_b16 v[136:137], v28 offset:29696
    s_waitcnt lgkmcnt(15)
    buffer_store_dwordx4 v[200:203], v3, s[4:7], s51 offen sc1
    v_mfma_f32_32x32x16_bf16 v[168:183], v[164:167], v[20:23], v[168:183]
    ds_read_b64_tr_b16 v[128:129], v28 offset:43008
    ds_read_b64_tr_b16 v[138:139], v28 offset:30208
    v_mfma_f32_32x32x16_bf16 v[64:79], v[100:103], v[184:187], v[64:79]
    ds_read_b64_tr_b16 v[130:131], v28 offset:43520
    ds_read_b64_tr_b16 v[134:135], v28 offset:15872
    s_add_u32 s51, s51, s54
    s_waitcnt lgkmcnt(15)
    buffer_store_dwordx4 v[204:207], v3, s[4:7], s51 offen sc1
    v_mfma_f32_32x32x16_bf16 v[80:95], v[184:187], v[104:107], v[80:95]
    ds_read_b64_tr_b16 v[120:121], v28 offset:14336
    v_mfma_f32_32x32x16_bf16 v[48:63], v[96:99], v[184:187], v[48:63]
    s_nop 0
    v_cvt_pk_bf16_f32 v192, v168, v169
    v_cvt_pk_bf16_f32 v193, v170, v171
    ds_read_b64_tr_b16 v[140:141], v28 offset:44032
    s_add_u32 s51, s51, s54
    s_cmp_eq_u32 s59, 0
    s_cselect_b32 s51, s51, 2130706432
    s_waitcnt lgkmcnt(14)
    buffer_store_dwordx4 v[208:211], v3, s[4:7], s51 offen sc1
    v_mfma_f32_32x32x16_bf16 v[64:79], v[112:115], v[188:191], v[64:79]
    v_cvt_pk_bf16_f32 v194, v172, v173
    v_cvt_pk_bf16_f32 v195, v174, v175
    ds_read_b64_tr_b16 v[142:143], v28 offset:44544
    s_waitcnt lgkmcnt(14)
    v_mfma_f32_32x32x16_bf16 v[80:95], v[188:191], v[116:119], v[80:95]
    v_cvt_pk_bf16_f32 v196, v176, v177
    v_cvt_pk_bf16_f32 v197, v178, v179
    ds_read_b64_tr_b16 v[132:133], v28 offset:15360
    s_add_u32 s51, s51, s54
    s_waitcnt lgkmcnt(12)
    buffer_store_dwordx4 v[212:215], v3, s[4:7], s51 offen sc1
    v_mfma_f32_32x32x16_bf16 v[48:63], v[108:111], v[188:191], v[48:63]
    v_cvt_pk_bf16_f32 v198, v180, v181
    v_cvt_pk_bf16_f32 v199, v182, v183
    s_waitcnt lgkmcnt(9)
    v_mfma_f32_32x32x16_bf16 v[64:79], v[124:127], v[192:195], v[64:79]
    s_waitcnt lgkmcnt(5)
    v_mfma_f32_32x32x16_bf16 v[80:95], v[192:195], v[128:131], v[80:95]
    s_waitcnt lgkmcnt(3)
    v_mfma_f32_32x32x16_bf16 v[48:63], v[120:123], v[192:195], v[48:63]
    v_mfma_f32_32x32x16_bf16 v[64:79], v[136:139], v[196:199], v[64:79]
    s_waitcnt lgkmcnt(1)
    v_mfma_f32_32x32x16_bf16 v[80:95], v[196:199], v[140:143], v[80:95]
    s_waitcnt lgkmcnt(0)
    v_mfma_f32_32x32x16_bf16 v[48:63], v[132:135], v[196:199], v[48:63]
    v_lshrrev_b32 v6, 5, v1
    v_lshlrev_b32 v6, 4, v6
    s_lshl_b32 s39, s30, 7
    s_add_u32 s39, s39, 161536
    v_add_u32 v6, s39, v6
    ds_read_b128 v[96:99], v6 offset:0
    ds_read_b128 v[100:103], v6 offset:32
    ds_read_b128 v[104:107], v6 offset:64
    ds_read_b128 v[108:111], v6 offset:96
    s_lshl_b32 s39, s32, 6
    s_lshl_b32 s40, s31, 2
    s_add_u32 s39, s39, s40
    s_add_u32 s39, s39, s30
    s_lshl_b32 s39, s39, 12
    s_add_u32 s42, s39, 1048576
    v_and_b32 v7, 31, v1
    v_cmp_le_u32 vcc, 28, v7
    v_cmp_eq_u32 s[44:45], 28, v7
    v_mov_b32 v8, 0x3f803f80
    s_nop 0
    v_cndmask_b32 v8, v2, v8, s[44:45]
    v_pk_mul_f32 v[64:65], v[64:65], v[16:17] op_sel_hi:[1,0]
    v_pk_mul_f32 v[66:67], v[66:67], v[16:17] op_sel_hi:[1,0]
    v_pk_mul_f32 v[68:69], v[68:69], v[16:17] op_sel_hi:[1,0]
    v_pk_mul_f32 v[70:71], v[70:71], v[16:17] op_sel_hi:[1,0]
    v_pk_mul_f32 v[72:73], v[72:73], v[16:17] op_sel_hi:[1,0]
    v_pk_mul_f32 v[74:75], v[74:75], v[16:17] op_sel_hi:[1,0]
    v_pk_mul_f32 v[76:77], v[76:77], v[16:17] op_sel_hi:[1,0]
    v_pk_mul_f32 v[78:79], v[78:79], v[16:17] op_sel_hi:[1,0]
    v_cvt_pk_bf16_f32 v28, v64, v65
    v_cvt_pk_bf16_f32 v29, v66, v67
    v_cvt_pk_bf16_f32 v30, v68, v69
    v_cvt_pk_bf16_f32 v31, v70, v71
    v_cvt_pk_bf16_f32 v32, v72, v73
    v_cvt_pk_bf16_f32 v33, v74, v75
    v_cvt_pk_bf16_f32 v34, v76, v77
    v_cvt_pk_bf16_f32 v35, v78, v79
    v_cndmask_b32 v34, v34, v2, s[52:53]
    v_cndmask_b32 v35, v35, v2, s[52:53]
    buffer_store_dwordx4 v[28:31], v3, s[4:7], s42 offen offset:0 sc1
    buffer_store_dwordx4 v[32:35], v3, s[4:7], s42 offen offset:1024 sc1
    s_waitcnt lgkmcnt(3)
    v_pk_mul_f32 v[80:81], v[80:81], v[96:97]
    v_pk_mul_f32 v[82:83], v[82:83], v[98:99]
    s_waitcnt lgkmcnt(2)
    v_pk_mul_f32 v[84:85], v[84:85], v[100:101]
    v_pk_mul_f32 v[86:87], v[86:87], v[102:103]
    s_waitcnt lgkmcnt(1)
    v_pk_mul_f32 v[88:89], v[88:89], v[104:105]
    v_pk_mul_f32 v[90:91], v[90:91], v[106:107]
    s_waitcnt lgkmcnt(0)
    v_pk_mul_f32 v[92:93], v[92:93], v[108:109]
    v_pk_mul_f32 v[94:95], v[94:95], v[110:111]
    v_cvt_pk_bf16_f32 v36, v80, v81
    v_cvt_pk_bf16_f32 v37, v82, v83
    v_cvt_pk_bf16_f32 v38, v84, v85
    v_cvt_pk_bf16_f32 v39, v86, v87
    v_cvt_pk_bf16_f32 v40, v88, v89
    v_cvt_pk_bf16_f32 v41, v90, v91
    v_cvt_pk_bf16_f32 v42, v92, v93
    v_cvt_pk_bf16_f32 v43, v94, v95
    v_cndmask_b32 v36, v36, v8, vcc
    v_cndmask_b32 v37, v37, v8, vcc
    v_cndmask_b32 v38, v38, v8, vcc
    v_cndmask_b32 v39, v39, v8, vcc
    v_cndmask_b32 v40, v40, v8, vcc
    v_cndmask_b32 v41, v41, v8, vcc
    v_cndmask_b32 v42, v42, v8, vcc
    v_cndmask_b32 v43, v43, v8, vcc
    buffer_store_dwordx4 v[36:39], v3, s[4:7], s42 offen offset:2048 sc1
    buffer_store_dwordx4 v[40:43], v3, s[4:7], s42 offen offset:3072 sc1
    s_lshl_b32 s39, s30, 12
    s_add_u32 s39, s39, 81920
    v_add_u32 v7, s39, v3
    ds_write_b128 v7, v[28:31] offset:0
    ds_write_b128 v7, v[32:35] offset:1024
    ds_write_b128 v7, v[36:39] offset:2048
    ds_write_b128 v7, v[40:43] offset:3072
    v_mul_f32 v6, 0x3e8b97f6, v16
    v_mov_b32 v16, v6
    v_pk_mul_f32 v[48:49], v[48:49], v[16:17] op_sel_hi:[1,0]
    v_pk_mul_f32 v[50:51], v[50:51], v[16:17] op_sel_hi:[1,0]
    v_pk_mul_f32 v[52:53], v[52:53], v[16:17] op_sel_hi:[1,0]
    v_pk_mul_f32 v[54:55], v[54:55], v[16:17] op_sel_hi:[1,0]
    v_pk_mul_f32 v[56:57], v[56:57], v[16:17] op_sel_hi:[1,0]
    v_pk_mul_f32 v[58:59], v[58:59], v[16:17] op_sel_hi:[1,0]
    v_pk_mul_f32 v[60:61], v[60:61], v[16:17] op_sel_hi:[1,0]
    v_pk_mul_f32 v[62:63], v[62:63], v[16:17] op_sel_hi:[1,0]
    v_cvt_pk_bf16_f32 v20, v48, v49
    v_cvt_pk_bf16_f32 v21, v50, v51
    v_cvt_pk_bf16_f32 v22, v52, v53
    v_cvt_pk_bf16_f32 v23, v54, v55
    v_cvt_pk_bf16_f32 v24, v56, v57
    v_cvt_pk_bf16_f32 v25, v58, v59
    v_cvt_pk_bf16_f32 v26, v60, v61
    v_cvt_pk_bf16_f32 v27, v62, v63
    v_mov_b32 v6, 0x3f80
    v_cndmask_b32 v26, v26, v6, s[52:53]
    v_cndmask_b32 v27, v27, v2, s[52:53]
    s_lshl_b32 s39, s31, 4
    s_add_u32 s39, s39, s32
    s_lshl_b32 s39, s39, 2
    s_add_u32 s39, s39, s30
    s_lshl_b32 s39, s39, 7
    s_add_u32 s39, s39, 65536
    s_mov_b32 s20, s39
    s_waitcnt vmcnt(0)
    buffer_store_dwordx2 v[4:5], v2, s[4:7], s20 offen sc1
    s_lshl_b32 s39, s49, 3
    s_add_u32 s39, s39, 19922944
    buffer_store_dwordx2 v[4:5], v2, s[4:7], s39 offen sc1
    v_and_b32 v6, 31, v1
    v_lshrrev_b32 v7, 5, v1
    v_lshlrev_b32 v7, 2, v7
    v_sub_u32 v6, v6, v7
    v_cmp_le_i32 s[20:21], 0, v6
    v_cmp_le_i32 s[22:23], 1, v6
    v_cmp_le_i32 s[50:51], 2, v6
    v_cmp_le_i32 s[54:55], 3, v6
    v_cmp_le_i32 s[58:59], 8, v6
    v_cmp_le_i32 s[60:61], 9, v6
    v_cmp_le_i32 s[62:63], 10, v6
    v_cmp_le_i32 s[64:65], 11, v6
    v_cmp_le_i32 s[66:67], 16, v6
    v_cmp_le_i32 s[68:69], 17, v6
    v_cmp_le_i32 s[70:71], 18, v6
    v_cmp_le_i32 s[72:73], 19, v6
    v_cmp_le_i32 s[74:75], 24, v6
    v_cmp_le_i32 s[76:77], 25, v6
    v_cmp_le_i32 s[78:79], 26, v6
    v_cmp_le_i32 s[80:81], 27, v6
    v_mov_b32 v7, 0xffff
    v_mov_b32 v8, s46
    v_cndmask_b32 v10, 0, v7, s[20:21]
    v_cndmask_b32 v6, v2, v8, s[22:23]
    v_or_b32 v10, v10, v6
    v_cndmask_b32 v11, 0, v7, s[50:51]
    v_cndmask_b32 v6, v2, v8, s[54:55]
    v_or_b32 v11, v11, v6
    v_cndmask_b32 v12, 0, v7, s[58:59]
    v_cndmask_b32 v6, v2, v8, s[60:61]
    v_or_b32 v12, v12, v6
    v_cndmask_b32 v13, 0, v7, s[62:63]
    v_cndmask_b32 v6, v2, v8, s[64:65]
    v_or_b32 v13, v13, v6
    v_cndmask_b32 v14, 0, v7, s[66:67]
    v_cndmask_b32 v6, v2, v8, s[68:69]
    v_or_b32 v14, v14, v6
    v_cndmask_b32 v15, 0, v7, s[70:71]
    v_cndmask_b32 v6, v2, v8, s[72:73]
    v_or_b32 v15, v15, v6
    v_cndmask_b32 v16, 0, v7, s[74:75]
    v_cndmask_b32 v6, v2, v8, s[76:77]
    v_or_b32 v16, v16, v6
    v_cndmask_b32 v17, 0, v7, s[78:79]
    v_cndmask_b32 v6, v2, v8, s[80:81]
    v_or_b32 v17, v17, v6
    s_lshr_b32 s39, s30, 1
    s_add_u32 s39, s39, s31
    s_lshl_b32 s57, s34, 2
    s_add_u32 s57, s57, s30
    v_and_b32 v8, 31, v1
    v_lshlrev_b32 v8, 3, v8
    s_min_u32 s82, s57, 13
    s_lshr_b32 s82, s82, 1
    s_lshl_b32 s82, s82, 8
    s_add_u32 s82, s82, 19929216
    s_mov_b32 s83, s39
    s_lshl_b32 s39, s30, 1
    s_min_u32 s39, s39, 6
    s_mul_i32 s40, s36, 7
    s_add_u32 s39, s39, s40
    s_add_u32 s39, s39, 56
    s_add_u32 s40, s39, 1
    s_min_u32 s40, s40, 111
    s_lshr_b32 s39, s39, 2
    s_mul_i32 s39, s39, 14
    s_lshr_b32 s40, s40, 2
    s_mul_i32 s40, s40, 14
    v_min_u32 v19, 27, v1
    v_cmp_gt_u32 vcc, 14, v19
    v_add_u32 v18, s39, v19
    v_subrev_u32 v19, 14, v19
    v_add_u32 v19, s40, v19
    v_cndmask_b32 v18, v19, v18, vcc
    v_lshlrev_b32 v18, 3, v18
    s_mov_b32 s84, 19922944
    s_load_dwordx2 s[88:89], s[0:1], 40
    s_waitcnt lgkmcnt(0)
    s_mov_b32 s90, 8388608
    s_mov_b32 s91, 0x20000
    s_lshl_b32 s85, s35, 3
    s_add_u32 s85, s85, s36
    s_lshl_b32 s85, s85, 15
    s_lshl_b32 s40, s30, 10
    s_add_u32 s85, s85, s40
    s_add_u32 s85, s85, 512
    v_lshrrev_b32 v172, 2, v1
    v_lshlrev_b32 v172, 12, v172
    v_and_b32 v173, 3, v1
    v_lshl_add_u32 v172, v173, 7, v172
    v_cmp_gt_u32 vcc, 32, v1
    v_mov_b32 v173, 0x7f000000
    s_nop 0
    v_cndmask_b32 v172, v173, v172, vcc
    s_min_u32 s86, s57, 13
    s_lshl_b32 s86, s86, 15
    s_add_u32 s86, s86, 18677760
    s_cmp_lt_u32 s57, 14
    s_cselect_b32 s86, s86, 2130706432
    s_lshl_b32 s39, s30, 1
    s_add_u32 s39, s39, 0
    s_min_u32 s39, s39, 6
    s_mul_i32 s40, s36, 7
    s_add_u32 s39, s39, s40
    s_add_u32 s39, s39, 56
    s_mul_i32 s87, s39, 14336
    s_add_u32 s87, s87, 20971520
    s_lshl_b32 s39, s30, 1
    s_add_u32 s39, s39, 1
    s_min_u32 s39, s39, 6
    s_mul_i32 s40, s36, 7
    s_add_u32 s39, s39, s40
    s_add_u32 s39, s39, 56
    s_mul_i32 s92, s39, 14336
    s_add_u32 s92, s92, 20971520
    s_cmp_lt_u32 s30, 3
    s_cselect_b32 s92, s92, 2130706432
    s_mov_b32 s39, s83
    s_cmp_lt_u32 s39, 2
    s_nop 0
    s_cbranch_scc1 L_nohalo_10
    s_sub_u32 s39, s39, 2
    s_lshl_b32 s40, s30, 1
    s_and_b32 s40, s40, 3
    s_lshl_b32 s41, s32, 6
    s_lshl_b32 s42, s39, 2
    s_add_u32 s41, s41, s42
    s_add_u32 s41, s41, s40
    s_lshl_b32 s41, s41, 12
    s_add_u32 s49, s41, 1048576
    s_lshl_b32 s39, s39, 4
    s_add_u32 s39, s39, s32
    s_lshl_b32 s39, s39, 2
    s_add_u32 s39, s39, s40
    s_lshl_b32 s39, s39, 7
    s_add_u32 s42, s39, 65536
    v_and_b32 v6, 1, v1
    v_lshlrev_b32 v6, 7, v6
    s_mov_b32 s43, 400000
    s_nop 1
L_poll_12:
    buffer_load_dwordx2 v[178:179], v6, s[4:7], s42 offen sc1
    s_waitcnt vmcnt(0)
    v_cmp_eq_u32 vcc, s37, v178
    v_cmp_eq_u32 s[44:45], s38, v179
    s_nop 3
    s_and_b64 vcc, vcc, s[44:45]
    s_cmp_eq_u64 vcc, -1
    s_nop 0
    s_cbranch_scc1 L_polld_13
    s_sub_u32 s43, s43, 1
    s_cmp_lg_u32 s43, 0
    s_nop 0
    s_cbranch_scc1 L_poll_12
    v_mov_b32 v178, 2
    s_mov_b32 s39, 0
    buffer_store_dword v178, v2, s[24:27], s39 offen
    s_nop 1
L_polld_13:
    buffer_load_dwordx2 v[174:175], v8, s[4:7], s82 offen sc1
    buffer_load_dwordx2 v[176:177], v18, s[4:7], s84 offen sc1
    s_lshl_b32 s41, s30, 13
    s_add_u32 m0, s41, 49152
    s_nop 0
    buffer_load_dwordx4 v3, s[4:7], s49 offen offset:0 sc1 lds
    buffer_load_dwordx4 v3, s[4:7], s49 offen offset:1024 sc1 lds
    buffer_load_dwordx4 v3, s[4:7], s49 offen offset:2048 sc1 lds
    buffer_load_dwordx4 v3, s[4:7], s49 offen offset:3072 sc1 lds
    s_add_u32 m0, s41, 53248
    s_add_u32 s49, s49, 4096
    buffer_load_dwordx4 v3, s[4:7], s49 offen offset:0 sc1 lds
    buffer_load_dwordx4 v3, s[4:7], s49 offen offset:1024 sc1 lds
    buffer_load_dwordx4 v3, s[4:7], s49 offen offset:2048 sc1 lds
    buffer_load_dwordx4 v3, s[4:7], s49 offen offset:3072 sc1 lds
    s_nop 1
    s_branch L_halo_done_11
L_nohalo_10:
    s_waitcnt vmcnt(0)
    buffer_load_dwordx2 v[174:175], v8, s[4:7], s82 offen sc1
    buffer_load_dwordx2 v[176:177], v18, s[4:7], s84 offen sc1
    v_mov_b32 v28, 0
    v_mov_b32 v29, 0
    v_mov_b32 v30, 0
    v_mov_b32 v31, 0
    v_mov_b32 v32, 0
    v_mov_b32 v33, 0
    v_mov_b32 v34, 0
    v_mov_b32 v35, 0
    v_mov_b32 v6, 0xf149
    v_cndmask_b32 v34, v2, v6, s[52:53]
    s_lshl_b32 s41, s30, 13
    s_add_u32 s41, s41, 49152
    v_add_u32 v6, s41, v3
    ds_write_b128 v6, v[28:31] offset:0
    ds_write_b128 v6, v[32:35] offset:1024
    ds_write_b128 v6, v[28:31] offset:2048
    ds_write_b128 v6, v[28:31] offset:3072
    ds_write_b128 v6, v[28:31] offset:4096
    ds_write_b128 v6, v[32:35] offset:5120
    ds_write_b128 v6, v[28:31] offset:6144
    ds_write_b128 v6, v[28:31] offset:7168
    s_waitcnt lgkmcnt(0)
L_halo_done_11:
    s_cmp_ge_u32 s47, 224
    s_nop 0
    s_cbranch_scc1 L_noprod2_15
    v_accvgpr_read_b32 v198, a120
    v_accvgpr_read_b32 v199, a121
    v_accvgpr_read_b32 v200, a112
    v_accvgpr_read_b32 v201, a113
    v_accvgpr_read_b32 v202, a114
    v_accvgpr_read_b32 v203, a115
    v_accvgpr_read_b32 v204, a116
    v_accvgpr_read_b32 v205, a117
    v_accvgpr_read_b32 v206, a118
    v_accvgpr_read_b32 v207, a119
    v_lshlrev_b32 v197, 16, v198
    v_mul_f32 v196, 0xbfb8aa3b, v197
    v_exp_f32 v196, v196
    s_nop 0
    v_add_f32 v196, 1.0, v196
    v_rcp_f32 v196, v196
    s_nop 0
    v_mul_f32 v196, v197, v196
    v_cvt_pk_bf16_f32 v196, v196, v196
    v_and_b32 v194, s46, v196
    v_lshlrev_b32 v186, 16, v200
    v_and_b32 v187, s46, v200
    v_lshlrev_b32 v188, 16, v201
    v_and_b32 v189, s46, v201
    v_lshlrev_b32 v190, 16, v202
    v_and_b32 v191, s46, v202
    v_lshlrev_b32 v192, 16, v203
    v_and_b32 v193, s46, v203
    v_pk_mul_f32 v[178:179], v[186:187], v[194:195] op_sel_hi:[1,0]
    v_pk_mul_f32 v[180:181], v[188:189], v[194:195] op_sel_hi:[1,0]
    v_pk_mul_f32 v[182:183], v[190:191], v[194:195] op_sel_hi:[1,0]
    v_pk_mul_f32 v[184:185], v[192:193], v[194:195] op_sel_hi:[1,0]
    v_lshlrev_b32 v197, 16, v199
    v_mul_f32 v196, 0xbfb8aa3b, v197
    v_exp_f32 v196, v196
    s_nop 0
    v_add_f32 v196, 1.0, v196
    v_rcp_f32 v196, v196
    s_nop 0
    v_mul_f32 v196, v197, v196
    v_cvt_pk_bf16_f32 v196, v196, v196
    v_and_b32 v194, s46, v196
    v_lshlrev_b32 v186, 16, v204
    v_and_b32 v187, s46, v204
    v_lshlrev_b32 v188, 16, v205
    v_and_b32 v189, s46, v205
    v_lshlrev_b32 v190, 16, v206
    v_and_b32 v191, s46, v206
    v_lshlrev_b32 v192, 16, v207
    v_and_b32 v193, s46, v207
    v_pk_fma_f32 v[178:179], v[186:187], v[194:195], v[178:179] op_sel_hi:[1,0,1]
    v_pk_fma_f32 v[180:181], v[188:189], v[194:195], v[180:181] op_sel_hi:[1,0,1]
    v_pk_fma_f32 v[182:183], v[190:191], v[194:195], v[182:183] op_sel_hi:[1,0,1]
    v_pk_fma_f32 v[184:185], v[192:193], v[194:195], v[184:185] op_sel_hi:[1,0,1]
    v_permlane32_swap_b32 v178, v179
    v_permlane32_swap_b32 v180, v181
    v_permlane32_swap_b32 v182, v183
    v_permlane32_swap_b32 v184, v185
    v_add_f32 v186, v178, v179
    v_add_f32 v187, v180, v181
    v_add_f32 v188, v182, v183
    v_add_f32 v189, v184, v185
    v_permlane16_swap_b32 v186, v187
    s_nop 0
    v_permlane16_swap_b32 v188, v189
    v_add_f32 v178, v186, v187
    v_add_f32 v179, v188, v189
    s_nop 0
    v_add_f32_dpp v178, v178, v178 row_ror:8 row_mask:0xf bank_mask:0xf
    v_add_f32_dpp v179, v179, v179 row_ror:8 row_mask:0xf bank_mask:0xf
    s_nop 0
    v_add_f32_dpp v178, v178, v178 row_ror:4 row_mask:0xf bank_mask:0xf
    v_add_f32_dpp v179, v179, v179 row_ror:4 row_mask:0xf bank_mask:0xf
    s_nop 0
    v_add_f32_dpp v178, v178, v178 row_ror:2 row_mask:0xf bank_mask:0xf
    v_add_f32_dpp v179, v179, v179 row_ror:2 row_mask:0xf bank_mask:0xf
    s_nop 0
    v_add_f32_dpp v178, v178, v178 row_ror:1 row_mask:0xf bank_mask:0xf
    v_add_f32_dpp v179, v179, v179 row_ror:1 row_mask:0xf bank_mask:0xf
    v_bfe_u32 v197, v1, 4, 1
    v_lshlrev_b32 v196, 1, v197
    v_lshrrev_b32 v197, 5, v1
    v_add_u32 v196, v196, v197
    v_lshlrev_b32 v196, 4, v196
    s_lshl_b32 s39, s30, 2
    s_add_u32 s39, s39, 161280
    v_add_u32 v196, s39, v196
    ds_write_b32 v196, v178
    ds_write_b32 v196, v179 offset:64
    s_waitcnt lgkmcnt(0)
    s_waitcnt vmcnt(0)
    s_barrier
    s_cmp_lg_u32 s30, 0
    s_nop 0
    s_cbranch_scc1 L_modw_16
    v_and_b32 v196, 7, v1
    v_lshlrev_b32 v197, 4, v196
    v_add_u32 v197, 161280, v197
    ds_read_b128 v[186:189], v197
    v_and_b32 v191, 1, v196
    v_lshlrev_b32 v191, 4, v191
    v_lshrrev_b32 v191, v191, v4
    v_and_b32 v191, 0xffff, v191
    v_bfe_u32 v192, v196, 1, 1
    v_mul_u32_u24 v192, 0x5a5a, v192
    v_xor_b32 v191, v191, v192
    v_lshlrev_b32 v196, 2, v196
    s_lshl_b32 s39, s47, 5
    s_add_u32 s39, s39, 7680
    s_waitcnt lgkmcnt(0)
    v_add_f32 v186, v186, v187
    v_add_f32 v188, v188, v189
    v_add_f32 v186, v186, v188
    v_cvt_pk_bf16_f32 v186, v186, v186
    v_and_b32 v186, s46, v186
    v_or_b32 v186, v186, v191
    buffer_store_dword v186, v196, s[4:7], s39 offen sc1
    s_nop 1
L_modw_16:
L_noprod2_15:
    s_cmp_lt_u32 s47, 224
    s_nop 0
    s_cbranch_scc1 L_m2np_14
    s_waitcnt vmcnt(0)
L_m2np_14:
    s_waitcnt lgkmcnt(0)
    s_barrier
    v_cmp_eq_u32 vcc, s37, v174
    v_cmp_eq_u32 s[44:45], s38, v175
    s_nop 3
    s_and_b64 vcc, vcc, s[44:45]
    s_cmp_eq_u64 vcc, -1
    s_nop 0
    s_cbranch_scc1 L_fc_17
    s_mov_b32 s43, 400000
    s_nop 0
L_poll_18:
    buffer_load_dwordx2 v[178:179], v8, s[4:7], s82 offen sc1
    s_waitcnt vmcnt(0)
    v_cmp_eq_u32 vcc, s37, v178
    v_cmp_eq_u32 s[44:45], s38, v179
    s_nop 3
    s_and_b64 vcc, vcc, s[44:45]
    s_cmp_eq_u64 vcc, -1
    s_nop 0
    s_cbranch_scc1 L_polld_19
    s_sub_u32 s43, s43, 1
    s_cmp_lg_u32 s43, 0
    s_nop 0
    s_cbranch_scc1 L_poll_18
    v_mov_b32 v178, 11
    s_mov_b32 s39, 0
    buffer_store_dword v178, v2, s[24:27], s39 offen
    s_nop 1
L_polld_19:
L_fc_17:
    v_cmp_eq_u32 vcc, s37, v176
    v_cmp_eq_u32 s[44:45], s38, v177
    s_nop 3
    s_and_b64 vcc, vcc, s[44:45]
    s_cmp_eq_u64 vcc, -1
    s_nop 0
    s_cbranch_scc1 L_fc_20
    s_mov_b32 s43, 400000
    s_nop 0
L_poll_21:
    buffer_load_dwordx2 v[174:175], v18, s[4:7], s84 offen sc1
    s_waitcnt vmcnt(0)
    v_cmp_eq_u32 vcc, s37, v174
    v_cmp_eq_u32 s[44:45], s38, v175
    s_nop 3
    s_and_b64 vcc, vcc, s[44:45]
    s_cmp_eq_u64 vcc, -1
    s_nop 0
    s_cbranch_scc1 L_polld_22
    s_sub_u32 s43, s43, 1
    s_cmp_lg_u32 s43, 0
    s_nop 0
    s_cbranch_scc1 L_poll_21
    v_mov_b32 v174, 14
    s_mov_b32 s39, 0
    buffer_store_dword v174, v2, s[24:27], s39 offen
    s_nop 1
L_polld_22:
L_fc_20:
    buffer_load_dword v19, v172, s[88:91], s85 offen
    s_lshl_b32 s39, s30, 12
    s_add_u32 s39, s39, 49152
    v_add_u32 v8, s39, v3
    ds_read_b128 v[172:175], v8 offset:0
    ds_read_b128 v[176:179], v8 offset:1024
    ds_read_b128 v[180:183], v8 offset:32768
    ds_read_b128 v[184:187], v8 offset:33792
    s_waitcnt lgkmcnt(3)
    v_mfma_f32_32x32x16_bf16 v[28:43], v[172:175], v[20:23], 0
    s_waitcnt lgkmcnt(2)
    v_mfma_f32_32x32x16_bf16 v[28:43], v[176:179], v[24:27], v[28:43]
    buffer_load_dwordx4 a[124:127], v3, s[4:7], s86 offen offset:0 sc1
    ds_read_b128 v[188:191], v8 offset:4096
    ds_read_b128 v[192:195], v8 offset:5120
    s_waitcnt lgkmcnt(3)
    v_mfma_f32_32x32x16_bf16 v[156:171], v[180:183], v[20:23], 0
    s_waitcnt lgkmcnt(2)
    v_mfma_f32_32x32x16_bf16 v[156:171], v[184:187], v[24:27], v[156:171]
    buffer_load_dwordx4 a[128:131], v3, s[4:7], s86 offen offset:1024 sc1
    ds_read_b128 v[172:175], v8 offset:8192
    ds_read_b128 v[176:179], v8 offset:9216
    s_waitcnt lgkmcnt(3)
    v_mfma_f32_32x32x16_bf16 v[44:59], v[188:191], v[20:23], 0
    s_waitcnt lgkmcnt(2)
    v_mfma_f32_32x32x16_bf16 v[44:59], v[192:195], v[24:27], v[44:59]
    buffer_load_dwordx4 a[132:135], v3, s[4:7], s86 offen offset:2048 sc1
    ds_read_b128 v[180:183], v8 offset:12288
    ds_read_b128 v[184:187], v8 offset:13312
    s_waitcnt lgkmcnt(3)
    v_mfma_f32_32x32x16_bf16 v[60:75], v[172:175], v[20:23], 0
    s_waitcnt lgkmcnt(2)
    v_mfma_f32_32x32x16_bf16 v[60:75], v[176:179], v[24:27], v[60:75]
    buffer_load_dwordx4 a[136:139], v3, s[4:7], s86 offen offset:3072 sc1
    ds_read_b128 v[188:191], v8 offset:16384
    ds_read_b128 v[192:195], v8 offset:17408
    v_cndmask_b32 v156, v28, v156, s[20:21]
    v_cndmask_b32 v157, v29, v157, s[22:23]
    v_cndmask_b32 v158, v30, v158, s[50:51]
    v_cndmask_b32 v159, v31, v159, s[54:55]
    v_cndmask_b32 v160, v32, v160, s[58:59]
    v_cndmask_b32 v161, v33, v161, s[60:61]
    v_cndmask_b32 v162, v34, v162, s[62:63]
    v_cndmask_b32 v163, v35, v163, s[64:65]
    v_cndmask_b32 v164, v36, v164, s[66:67]
    v_cndmask_b32 v165, v37, v165, s[68:69]
    v_cndmask_b32 v166, v38, v166, s[70:71]
    v_cndmask_b32 v167, v39, v167, s[72:73]
    v_cndmask_b32 v168, v40, v168, s[74:75]
    v_cndmask_b32 v169, v41, v169, s[76:77]
    v_cndmask_b32 v170, v42, v170, s[78:79]
    v_cndmask_b32 v171, v43, v171, s[80:81]
    s_waitcnt lgkmcnt(3)
    v_mfma_f32_32x32x16_bf16 v[76:91], v[180:183], v[20:23], 0
    s_waitcnt lgkmcnt(2)
    v_mfma_f32_32x32x16_bf16 v[76:91], v[184:187], v[24:27], v[76:91]
    s_add_u32 s86, s86, 4096
    buffer_load_dwordx4 a[140:143], v3, s[4:7], s86 offen offset:0 sc1
    ds_read_b128 v[172:175], v8 offset:20480
    ds_read_b128 v[176:179], v8 offset:21504
    v_max_f32 v196, v156, v157
    v_max_f32 v197, v158, v159
    v_max_f32 v198, v160, v161
    v_max_f32 v199, v162, v163
    v_max3_f32 v196, v164, v165, v196
    v_max3_f32 v197, v166, v167, v197
    v_max3_f32 v198, v168, v169, v198
    v_max3_f32 v199, v170, v171, v199
    s_waitcnt lgkmcnt(3)
    v_mfma_f32_32x32x16_bf16 v[92:107], v[188:191], v[20:23], 0
    s_waitcnt lgkmcnt(2)
    v_mfma_f32_32x32x16_bf16 v[92:107], v[192:195], v[24:27], v[92:107]
    buffer_load_dwordx4 a[144:147], v3, s[4:7], s86 offen offset:1024 sc1
    ds_read_b128 v[180:183], v8 offset:24576
    ds_read_b128 v[184:187], v8 offset:25600
    v_max3_f32 v196, v44, v45, v196
    v_max3_f32 v197, v46, v47, v197
    v_max3_f32 v198, v48, v49, v198
    v_max3_f32 v199, v50, v51, v199
    v_max3_f32 v196, v52, v53, v196
    v_max3_f32 v197, v54, v55, v197
    v_max3_f32 v198, v56, v57, v198
    v_max3_f32 v199, v58, v59, v199
    s_waitcnt lgkmcnt(3)
    v_mfma_f32_32x32x16_bf16 v[108:123], v[172:175], v[20:23], 0
    s_waitcnt lgkmcnt(2)
    v_mfma_f32_32x32x16_bf16 v[108:123], v[176:179], v[24:27], v[108:123]
    buffer_load_dwordx4 a[148:151], v3, s[4:7], s86 offen offset:2048 sc1
    ds_read_b128 v[188:191], v8 offset:28672
    ds_read_b128 v[192:195], v8 offset:29696
    v_max3_f32 v196, v60, v61, v196
    v_max3_f32 v197, v62, v63, v197
    v_max3_f32 v198, v64, v65, v198
    v_max3_f32 v199, v66, v67, v199
    v_max3_f32 v196, v68, v69, v196
    v_max3_f32 v197, v70, v71, v197
    v_max3_f32 v198, v72, v73, v198
    v_max3_f32 v199, v74, v75, v199
    s_waitcnt lgkmcnt(3)
    v_mfma_f32_32x32x16_bf16 v[124:139], v[180:183], v[20:23], 0
    s_waitcnt lgkmcnt(2)
    v_mfma_f32_32x32x16_bf16 v[124:139], v[184:187], v[24:27], v[124:139]
    buffer_load_dwordx4 a[152:155], v3, s[4:7], s86 offen offset:3072 sc1
    v_max3_f32 v196, v76, v77, v196
    v_max3_f32 v197, v78, v79, v197
    v_max3_f32 v198, v80, v81, v198
    v_max3_f32 v199, v82, v83, v199
    v_max3_f32 v196, v84, v85, v196
    v_max3_f32 v197, v86, v87, v197
    v_max3_f32 v198, v88, v89, v198
    v_max3_f32 v199, v90, v91, v199
    s_waitcnt lgkmcnt(1)
    v_mfma_f32_32x32x16_bf16 v[140:155], v[188:191], v[20:23], 0
    s_waitcnt lgkmcnt(0)
    v_mfma_f32_32x32x16_bf16 v[140:155], v[192:195], v[24:27], v[140:155]
    s_add_u32 s86, s86, 4096
    buffer_load_dwordx4 a[156:159], v3, s[4:7], s86 offen offset:0 sc1
    v_max3_f32 v196, v92, v93, v196
    v_max3_f32 v197, v94, v95, v197
    v_max3_f32 v198, v96, v97, v198
    v_max3_f32 v199, v98, v99, v199
    v_max3_f32 v196, v100, v101, v196
    v_max3_f32 v197, v102, v103, v197
    v_max3_f32 v198, v104, v105, v198
    v_max3_f32 v199, v106, v107, v199
    v_max3_f32 v196, v108, v109, v196
    v_max3_f32 v197, v110, v111, v197
    v_max3_f32 v198, v112, v113, v198
    v_max3_f32 v199, v114, v115, v199
    v_max3_f32 v196, v116, v117, v196
    v_max3_f32 v197, v118, v119, v197
    v_max3_f32 v198, v120, v121, v198
    v_max3_f32 v199, v122, v123, v199
    v_max3_f32 v196, v124, v125, v196
    v_max3_f32 v197, v126, v127, v197
    v_max3_f32 v198, v128, v129, v198
    v_max3_f32 v199, v130, v131, v199
    v_max3_f32 v196, v132, v133, v196
    v_max3_f32 v197, v134, v135, v197
    v_max3_f32 v198, v136, v137, v198
    v_max3_f32 v199, v138, v139, v199
    v_max3_f32 v196, v140, v141, v196
    v_max3_f32 v197, v142, v143, v197
    v_max3_f32 v198, v144, v145, v198
    v_max3_f32 v199, v146, v147, v199
    v_max3_f32 v196, v148, v149, v196
    v_max3_f32 v197, v150, v151, v197
    v_max3_f32 v198, v152, v153, v198
    v_max3_f32 v199, v154, v155, v199
    v_max3_f32 v196, v196, v197, v198
    v_max_f32 v196, v196, v199
    v_mov_b32 v197, v196
    s_nop 1
    v_permlane32_swap_b32 v196, v197
    v_max_f32 v196, v196, v197
    v_sub_f32 v200, 0, v196
    ds_read_b128 v[172:175], v8 offset:34816
    ds_read_b128 v[176:179], v8 offset:35840
    ds_read_b128 v[180:183], v8 offset:2048
    ds_read_b128 v[184:187], v8 offset:3072
    v_add_f32 v156, v200, v156
    v_add_f32 v157, v200, v157
    v_add_f32 v158, v200, v158
    v_add_f32 v159, v200, v159
    v_add_f32 v160, v200, v160
    v_add_f32 v161, v200, v161
    v_add_f32 v162, v200, v162
    v_add_f32 v163, v200, v163
    v_add_f32 v164, v200, v164
    v_add_f32 v165, v200, v165
    v_add_f32 v166, v200, v166
    v_add_f32 v167, v200, v167
    v_add_f32 v168, v200, v168
    v_add_f32 v169, v200, v169
    v_add_f32 v170, v200, v170
    v_add_f32 v171, v200, v171
    v_exp_f32 v156, v156
    v_exp_f32 v157, v157
    v_exp_f32 v158, v158
    v_exp_f32 v159, v159
    v_exp_f32 v160, v160
    v_exp_f32 v161, v161
    v_exp_f32 v162, v162
    v_exp_f32 v163, v163
    v_exp_f32 v164, v164
    v_exp_f32 v165, v165
    v_exp_f32 v166, v166
    v_exp_f32 v167, v167
    v_exp_f32 v168, v168
    v_exp_f32 v169, v169
    v_exp_f32 v170, v170
    v_exp_f32 v171, v171
    v_cvt_pk_bf16_f32 v156, v156, v157
    v_cvt_pk_bf16_f32 v157, v158, v159
    v_cvt_pk_bf16_f32 v158, v160, v161
    v_cvt_pk_bf16_f32 v159, v162, v163
    v_cvt_pk_bf16_f32 v160, v164, v165
    v_cvt_pk_bf16_f32 v161, v166, v167
    v_cvt_pk_bf16_f32 v162, v168, v169
    v_cvt_pk_bf16_f32 v163, v170, v171
    v_bfi_b32 v28, v10, v2, v156
    v_bfi_b32 v29, v11, v2, v157
    v_bfi_b32 v30, v12, v2, v158
    v_bfi_b32 v31, v13, v2, v159
    v_bfi_b32 v32, v14, v2, v160
    v_bfi_b32 v33, v15, v2, v161
    v_bfi_b32 v34, v16, v2, v162
    v_bfi_b32 v35, v17, v2, v163
    v_and_b32 v156, v10, v156
    v_and_b32 v157, v11, v157
    v_and_b32 v158, v12, v158
    v_and_b32 v159, v13, v159
    v_and_b32 v160, v14, v160
    v_and_b32 v161, v15, v161
    v_and_b32 v162, v16, v162
    v_and_b32 v163, v17, v163
    s_waitcnt lgkmcnt(3)
    v_mfma_f32_32x32x16_bf16 v[204:219], v[172:175], v[156:159], 0
    ds_read_b128 v[188:191], v8 offset:6144
    v_add_f32 v44, v200, v44
    v_add_f32 v45, v200, v45
    v_add_f32 v46, v200, v46
    v_add_f32 v47, v200, v47
    buffer_load_dwordx4 a[160:163], v3, s[4:7], s86 offen offset:1024 sc1
    v_add_f32 v48, v200, v48
    v_add_f32 v49, v200, v49
    v_add_f32 v50, v200, v50
    v_add_f32 v51, v200, v51
    v_add_f32 v52, v200, v52
    s_waitcnt lgkmcnt(3)
    v_mfma_f32_32x32x16_bf16 v[204:219], v[176:179], v[160:163], v[204:219]
    ds_read_b128 v[192:195], v8 offset:7168
    v_add_f32 v53, v200, v53
    v_add_f32 v54, v200, v54
    v_add_f32 v55, v200, v55
    v_add_f32 v56, v200, v56
    v_add_f32 v57, v200, v57
    v_add_f32 v58, v200, v58
    buffer_load_dwordx4 a[164:167], v3, s[4:7], s86 offen offset:2048 sc1
    v_add_f32 v59, v200, v59
    v_exp_f32 v44, v44
    v_exp_f32 v45, v45
    v_exp_f32 v46, v46
    s_waitcnt lgkmcnt(3)
    v_mfma_f32_32x32x16_bf16 v[204:219], v[180:183], v[28:31], v[204:219]
    ds_read_b128 v[172:175], v8 offset:10240
    v_exp_f32 v47, v47
    v_exp_f32 v48, v48
    v_exp_f32 v49, v49
    v_exp_f32 v50, v50
    v_exp_f32 v51, v51
    v_exp_f32 v52, v52
    v_exp_f32 v53, v53
    buffer_load_dwordx4 a[168:171], v3, s[4:7], s86 offen offset:3072 sc1
    v_exp_f32 v54, v54
    v_exp_f32 v55, v55
    v_exp_f32 v56, v56
    s_waitcnt lgkmcnt(3)
    v_mfma_f32_32x32x16_bf16 v[204:219], v[184:187], v[32:35], v[204:219]
    ds_read_b128 v[176:179], v8 offset:11264
    v_exp_f32 v57, v57
    v_exp_f32 v58, v58
    v_exp_f32 v59, v59
    v_cvt_pk_bf16_f32 v44, v44, v45
    v_cvt_pk_bf16_f32 v45, v46, v47
    v_cvt_pk_bf16_f32 v46, v48, v49
    v_cvt_pk_bf16_f32 v47, v50, v51
    v_cvt_pk_bf16_f32 v48, v52, v53
    v_cvt_pk_bf16_f32 v49, v54, v55
    v_cvt_pk_bf16_f32 v50, v56, v57
    v_cvt_pk_bf16_f32 v51, v58, v59
    s_waitcnt lgkmcnt(3)
    v_mfma_f32_32x32x16_bf16 v[204:219], v[188:191], v[44:47], v[204:219]
    ds_read_b128 v[180:183], v8 offset:14336
    v_add_f32 v60, v200, v60
    v_add_f32 v61, v200, v61
    v_add_f32 v62, v200, v62
    v_add_f32 v63, v200, v63
    s_add_u32 s86, s86, 4096
    buffer_load_dwordx4 a[172:175], v3, s[4:7], s86 offen offset:0 sc1
    v_add_f32 v64, v200, v64
    v_add_f32 v65, v200, v65
    v_add_f32 v66, v200, v66
    v_add_f32 v67, v200, v67
    v_add_f32 v68, v200, v68
    v_add_f32 v69, v200, v69
    v_add_f32 v70, v200, v70
    v_add_f32 v71, v200, v71
    v_add_f32 v72, v200, v72
    v_add_f32 v73, v200, v73
    v_add_f32 v74, v200, v74
    buffer_load_dwordx4 a[176:179], v3, s[4:7], s86 offen offset:1024 sc1
    v_add_f32 v75, v200, v75
    v_exp_f32 v60, v60
    v_exp_f32 v61, v61
    v_exp_f32 v62, v62
    s_waitcnt lgkmcnt(3)
    v_mfma_f32_32x32x16_bf16 v[204:219], v[192:195], v[48:51], v[204:219]
    ds_read_b128 v[184:187], v8 offset:15360
    v_exp_f32 v63, v63
    v_exp_f32 v64, v64
    v_exp_f32 v65, v65
    v_exp_f32 v66, v66
    v_exp_f32 v67, v67
    v_exp_f32 v68, v68
    v_exp_f32 v69, v69
    buffer_load_dwordx4 a[180:183], v3, s[4:7], s86 offen offset:2048 sc1
    v_exp_f32 v70, v70
    v_exp_f32 v71, v71
    v_exp_f32 v72, v72
    v_exp_f32 v73, v73
    v_exp_f32 v74, v74
    v_exp_f32 v75, v75
    v_cvt_pk_bf16_f32 v60, v60, v61
    v_cvt_pk_bf16_f32 v61, v62, v63
    v_cvt_pk_bf16_f32 v62, v64, v65
    v_cvt_pk_bf16_f32 v63, v66, v67
    v_cvt_pk_bf16_f32 v64, v68, v69
    v_cvt_pk_bf16_f32 v65, v70, v71
    v_cvt_pk_bf16_f32 v66, v72, v73
    v_cvt_pk_bf16_f32 v67, v74, v75
    s_waitcnt lgkmcnt(3)
    v_mfma_f32_32x32x16_bf16 v[204:219], v[172:175], v[60:63], v[204:219]
    ds_read_b128 v[188:191], v8 offset:18432
    v_add_f32 v76, v200, v76
    v_add_f32 v77, v200, v77
    v_add_f32 v78, v200, v78
    v_add_f32 v79, v200, v79
    buffer_load_dwordx4 a[184:187], v3, s[4:7], s86 offen offset:3072 sc1
    v_add_f32 v80, v200, v80
    v_add_f32 v81, v200, v81
    v_add_f32 v82, v200, v82
    v_add_f32 v83, v200, v83
    v_add_f32 v84, v200, v84
    v_add_f32 v85, v200, v85
    v_add_f32 v86, v200, v86
    v_add_f32 v87, v200, v87
    v_add_f32 v88, v200, v88
    v_add_f32 v89, v200, v89
    v_add_f32 v90, v200, v90
    s_add_u32 s86, s86, 4096
    buffer_load_dwordx4 a[188:191], v3, s[4:7], s86 offen offset:0 sc1
    v_add_f32 v91, v200, v91
    v_exp_f32 v76, v76
    v_exp_f32 v77, v77
    v_exp_f32 v78, v78
    s_waitcnt lgkmcnt(3)
    v_mfma_f32_32x32x16_bf16 v[204:219], v[176:179], v[64:67], v[204:219]
    ds_read_b128 v[192:195], v8 offset:19456
    v_exp_f32 v79, v79
    v_exp_f32 v80, v80
    v_exp_f32 v81, v81
    v_exp_f32 v82, v82
    v_exp_f32 v83, v83
    v_exp_f32 v84, v84
    v_exp_f32 v85, v85
    buffer_load_dwordx4 a[192:195], v3, s[4:7], s86 offen offset:1024 sc1
    v_exp_f32 v86, v86
    v_exp_f32 v87, v87
    v_exp_f32 v88, v88
    v_exp_f32 v89, v89
    v_exp_f32 v90, v90
    v_exp_f32 v91, v91
    v_cvt_pk_bf16_f32 v76, v76, v77
    v_cvt_pk_bf16_f32 v77, v78, v79
    v_cvt_pk_bf16_f32 v78, v80, v81
    v_cvt_pk_bf16_f32 v79, v82, v83
    v_cvt_pk_bf16_f32 v80, v84, v85
    v_cvt_pk_bf16_f32 v81, v86, v87
    v_cvt_pk_bf16_f32 v82, v88, v89
    v_cvt_pk_bf16_f32 v83, v90, v91
    s_waitcnt lgkmcnt(3)
    v_mfma_f32_32x32x16_bf16 v[204:219], v[180:183], v[76:79], v[204:219]
    ds_read_b128 v[172:175], v8 offset:22528
    v_add_f32 v92, v200, v92
    v_add_f32 v93, v200, v93
    v_add_f32 v94, v200, v94
    v_add_f32 v95, v200, v95
    buffer_load_dwordx4 a[196:199], v3, s[4:7], s86 offen offset:2048 sc1
    v_add_f32 v96, v200, v96
    v_add_f32 v97, v200, v97
    v_add_f32 v98, v200, v98
    v_add_f32 v99, v200, v99
    v_add_f32 v100, v200, v100
    v_add_f32 v101, v200, v101
    v_add_f32 v102, v200, v102
    v_add_f32 v103, v200, v103
    v_add_f32 v104, v200, v104
    v_add_f32 v105, v200, v105
    v_add_f32 v106, v200, v106
    buffer_load_dwordx4 a[200:203], v3, s[4:7], s86 offen offset:3072 sc1
    v_add_f32 v107, v200, v107
    v_exp_f32 v92, v92
    v_exp_f32 v93, v93
    v_exp_f32 v94, v94
    s_waitcnt lgkmcnt(3)
    v_mfma_f32_32x32x16_bf16 v[204:219], v[184:187], v[80:83], v[204:219]
    ds_read_b128 v[176:179], v8 offset:23552
    v_exp_f32 v95, v95
    v_exp_f32 v96, v96
    v_exp_f32 v97, v97
    v_exp_f32 v98, v98
    v_exp_f32 v99, v99
    v_exp_f32 v100, v100
    v_exp_f32 v101, v101
    s_add_u32 s86, s86, 4096
    buffer_load_dwordx4 a[204:207], v3, s[4:7], s86 offen offset:0 sc1
    v_exp_f32 v102, v102
    v_exp_f32 v103, v103
    v_exp_f32 v104, v104
    v_exp_f32 v105, v105
    v_exp_f32 v106, v106
    v_exp_f32 v107, v107
    v_cvt_pk_bf16_f32 v92, v92, v93
    v_cvt_pk_bf16_f32 v93, v94, v95
    v_cvt_pk_bf16_f32 v94, v96, v97
    v_cvt_pk_bf16_f32 v95, v98, v99
    v_cvt_pk_bf16_f32 v96, v100, v101
    v_cvt_pk_bf16_f32 v97, v102, v103
    v_cvt_pk_bf16_f32 v98, v104, v105
    v_cvt_pk_bf16_f32 v99, v106, v107
    s_waitcnt lgkmcnt(3)
    v_mfma_f32_32x32x16_bf16 v[204:219], v[188:191], v[92:95], v[204:219]
    ds_read_b128 v[180:183], v8 offset:26624
    v_add_f32 v108, v200, v108
    v_add_f32 v109, v200, v109
    v_add_f32 v110, v200, v110
    v_add_f32 v111, v200, v111
    buffer_load_dwordx4 a[208:211], v3, s[4:7], s86 offen offset:1024 sc1
    v_add_f32 v112, v200, v112
    v_add_f32 v113, v200, v113
    v_add_f32 v114, v200, v114
    v_add_f32 v115, v200, v115
    v_add_f32 v116, v200, v116
    v_add_f32 v117, v200, v117
    v_add_f32 v118, v200, v118
    v_add_f32 v119, v200, v119
    v_add_f32 v120, v200, v120
    v_add_f32 v121, v200, v121
    v_add_f32 v122, v200, v122
    buffer_load_dwordx4 a[212:215], v3, s[4:7], s86 offen offset:2048 sc1
    v_add_f32 v123, v200, v123
    v_exp_f32 v108, v108
    v_exp_f32 v109, v109
    v_exp_f32 v110, v110
    s_waitcnt lgkmcnt(3)
    v_mfma_f32_32x32x16_bf16 v[204:219], v[192:195], v[96:99], v[204:219]
    ds_read_b128 v[184:187], v8 offset:27648
    v_exp_f32 v111, v111
    v_exp_f32 v112, v112
    v_exp_f32 v113, v113
    v_exp_f32 v114, v114
    v_exp_f32 v115, v115
    v_exp_f32 v116, v116
    v_exp_f32 v117, v117
    buffer_load_dwordx4 a[216:219], v3, s[4:7], s86 offen offset:3072 sc1
    v_exp_f32 v118, v118
    v_exp_f32 v119, v119
    v_exp_f32 v120, v120
    v_exp_f32 v121, v121
    v_exp_f32 v122, v122
    v_exp_f32 v123, v123
    v_cvt_pk_bf16_f32 v108, v108, v109
    v_cvt_pk_bf16_f32 v109, v110, v111
    v_cvt_pk_bf16_f32 v110, v112, v113
    v_cvt_pk_bf16_f32 v111, v114, v115
    v_cvt_pk_bf16_f32 v112, v116, v117
    v_cvt_pk_bf16_f32 v113, v118, v119
    v_cvt_pk_bf16_f32 v114, v120, v121
    v_cvt_pk_bf16_f32 v115, v122, v123
    s_waitcnt lgkmcnt(3)
    v_mfma_f32_32x32x16_bf16 v[204:219], v[172:175], v[108:111], v[204:219]
    ds_read_b128 v[188:191], v8 offset:30720
    v_add_f32 v124, v200, v124
    v_add_f32 v125, v200, v125
    v_add_f32 v126, v200, v126
    v_add_f32 v127, v200, v127
    v_add_f32 v128, v200, v128
    v_add_f32 v129, v200, v129
    v_add_f32 v130, v200, v130
    v_add_f32 v131, v200, v131
    v_add_f32 v132, v200, v132
    v_add_f32 v133, v200, v133
    v_add_f32 v134, v200, v134
    v_add_f32 v135, v200, v135
    v_add_f32 v136, v200, v136
    v_add_f32 v137, v200, v137
    v_add_f32 v138, v200, v138
    v_add_f32 v139, v200, v139
    v_exp_f32 v124, v124
    v_exp_f32 v125, v125
    v_exp_f32 v126, v126
    v_exp_f32 v127, v127
    s_waitcnt lgkmcnt(3)
    v_mfma_f32_32x32x16_bf16 v[204:219], v[176:179], v[112:115], v[204:219]
    ds_read_b128 v[192:195], v8 offset:31744
    v_exp_f32 v128, v128
    v_exp_f32 v129, v129
    v_exp_f32 v130, v130
    v_exp_f32 v131, v131
    v_exp_f32 v132, v132
    v_exp_f32 v133, v133
    v_exp_f32 v134, v134
    v_exp_f32 v135, v135
    v_exp_f32 v136, v136
    v_exp_f32 v137, v137
    v_exp_f32 v138, v138
    v_exp_f32 v139, v139
    v_cvt_pk_bf16_f32 v124, v124, v125
    v_cvt_pk_bf16_f32 v125, v126, v127
    v_cvt_pk_bf16_f32 v126, v128, v129
    v_cvt_pk_bf16_f32 v127, v130, v131
    v_cvt_pk_bf16_f32 v128, v132, v133
    v_cvt_pk_bf16_f32 v129, v134, v135
    v_cvt_pk_bf16_f32 v130, v136, v137
    v_cvt_pk_bf16_f32 v131, v138, v139
    s_waitcnt lgkmcnt(3)
    v_mfma_f32_32x32x16_bf16 v[204:219], v[180:183], v[124:127], v[204:219]
    v_add_f32 v140, v200, v140
    v_add_f32 v141, v200, v141
    v_add_f32 v142, v200, v142
    v_add_f32 v143, v200, v143
    v_add_f32 v144, v200, v144
    v_add_f32 v145, v200, v145
    v_add_f32 v146, v200, v146
    v_add_f32 v147, v200, v147
    v_add_f32 v148, v200, v148
    v_add_f32 v149, v200, v149
    v_add_f32 v150, v200, v150
    v_add_f32 v151, v200, v151
    v_add_f32 v152, v200, v152
    v_add_f32 v153, v200, v153
    v_add_f32 v154, v200, v154
    v_add_f32 v155, v200, v155
    v_exp_f32 v140, v140
    v_exp_f32 v141, v141
    v_exp_f32 v142, v142
    v_exp_f32 v143, v143
    s_waitcnt lgkmcnt(2)
    v_mfma_f32_32x32x16_bf16 v[204:219], v[184:187], v[128:131], v[204:219]
    v_exp_f32 v144, v144
    v_exp_f32 v145, v145
    v_exp_f32 v146, v146
    v_exp_f32 v147, v147
    v_exp_f32 v148, v148
    v_exp_f32 v149, v149
    v_exp_f32 v150, v150
    v_exp_f32 v151, v151
    v_exp_f32 v152, v152
    v_exp_f32 v153, v153
    v_exp_f32 v154, v154
    v_exp_f32 v155, v155
    v_cvt_pk_bf16_f32 v140, v140, v141
    v_cvt_pk_bf16_f32 v141, v142, v143
    v_cvt_pk_bf16_f32 v142, v144, v145
    v_cvt_pk_bf16_f32 v143, v146, v147
    v_cvt_pk_bf16_f32 v144, v148, v149
    v_cvt_pk_bf16_f32 v145, v150, v151
    v_cvt_pk_bf16_f32 v146, v152, v153
    v_cvt_pk_bf16_f32 v147, v154, v155
    s_waitcnt lgkmcnt(1)
    v_mfma_f32_32x32x16_bf16 v[204:219], v[188:191], v[140:143], v[204:219]
    s_waitcnt lgkmcnt(0)
    v_mfma_f32_32x32x16_bf16 v[204:219], v[192:195], v[144:147], v[204:219]
    s_nop 11
    v_mov_b32 v196, v216
    v_mov_b32 v197, v216
    s_nop 1
    v_permlane32_swap_b32 v196, v197
    v_rcp_f32 v200, v197
    s_nop 0
    v_pk_mul_f32 v[204:205], v[204:205], v[200:201] op_sel_hi:[1,0]
    v_pk_mul_f32 v[206:207], v[206:207], v[200:201] op_sel_hi:[1,0]
    v_pk_mul_f32 v[208:209], v[208:209], v[200:201] op_sel_hi:[1,0]
    v_pk_mul_f32 v[210:211], v[210:211], v[200:201] op_sel_hi:[1,0]
    v_pk_mul_f32 v[212:213], v[212:213], v[200:201] op_sel_hi:[1,0]
    v_pk_mul_f32 v[214:215], v[214:215], v[200:201] op_sel_hi:[1,0]
    v_pk_mul_f32 v[216:217], v[216:217], v[200:201] op_sel_hi:[1,0]
    v_pk_mul_f32 v[218:219], v[218:219], v[200:201] op_sel_hi:[1,0]
    v_cndmask_b32 v216, v216, v2, s[52:53]
    v_cndmask_b32 v217, v217, v2, s[52:53]
    v_cndmask_b32 v218, v218, v2, s[52:53]
    v_cndmask_b32 v219, v219, v2, s[52:53]
    v_cvt_pk_bf16_f32 v44, v204, v205
    v_cvt_pk_bf16_f32 v45, v206, v207
    v_cvt_pk_bf16_f32 v46, v208, v209
    v_cvt_pk_bf16_f32 v47, v210, v211
    v_cvt_pk_bf16_f32 v48, v212, v213
    v_cvt_pk_bf16_f32 v49, v214, v215
    v_cvt_pk_bf16_f32 v50, v216, v217
    v_cvt_pk_bf16_f32 v51, v218, v219
    s_lshl_b32 s39, s31, 2
    s_add_u32 s39, s39, s30
    s_lshl_b32 s39, s39, 4
    s_add_u32 s39, s39, s32
    s_lshl_b32 s40, s39, 11
    s_add_u32 s40, s40, 5242880
    buffer_store_dwordx4 v[44:47], v3, s[4:7], s40 offen offset:0 sc1
    buffer_store_dwordx4 v[48:51], v3, s[4:7], s40 offen offset:1024 sc1
    s_lshl_b32 s39, s39, 7
    s_add_u32 s42, s39, 196608
    s_mov_b32 s8, s42
    s_lshl_b32 s39, s30, 1
    s_min_u32 s39, s39, 6
    s_mul_i32 s40, s36, 7
    s_add_u32 s39, s39, s40
    s_add_u32 s40, s39, 1
    s_min_u32 s40, s40, 111
    s_lshr_b32 s39, s39, 2
    s_mul_i32 s39, s39, 14
    s_lshr_b32 s40, s40, 2
    s_mul_i32 s40, s40, 14
    v_min_u32 v60, 27, v1
    v_cmp_gt_u32 vcc, 14, v60
    v_add_u32 v18, s39, v60
    v_subrev_u32 v60, 14, v60
    v_add_u32 v60, s40, v60
    v_cndmask_b32 v18, v60, v18, vcc
    v_lshlrev_b32 v18, 3, v18
    s_mov_b32 s9, 19922944
    v_min_u32 v60, 55, v1
    v_lshlrev_b32 v60, 3, v60
    s_min_u32 s10, s57, 13
    s_lshr_b32 s10, s10, 1
    s_mul_i32 s10, s10, 448
    s_add_u32 s10, s10, 19926080
    s_lshl_b32 s39, s30, 6
    v_add_u32 v61, s39, v1
    v_min_u32 v61, 223, v61
    v_lshlrev_b32 v62, 4, v61
    s_mov_b32 s11, 9472
    v_and_b32 v76, 31, v1
    v_mul_u32_u24 v76, 896, v76
    v_lshrrev_b32 v77, 5, v1
    v_lshl_add_u32 v76, v77, 4, v76
    s_mul_i32 s39, s33, 28672
    s_lshl_b32 s40, s57, 6
    s_add_u32 s39, s39, s40
    buffer_load_dwordx4 v[68:71], v76, s[16:19], s39 offen offset:0
    buffer_load_dwordx4 v[72:75], v76, s[16:19], s39 offen offset:32
    v_lshrrev_b32 v63, 5, v1
    v_lshlrev_b32 v63, 4, v63
    s_min_u32 s39, s57, 13
    s_lshl_b32 s39, s39, 7
    v_add_u32 v63, s39, v63
    s_mov_b32 s12, 7680
    s_mov_b32 s13, 7712
    s_mov_b32 s14, 7744
    s_mov_b32 s15, 7776
    s_mov_b32 s16, 11264
    s_mov_b32 s17, 11296
    s_mov_b32 s18, 11328
    s_mov_b32 s19, 11360
    buffer_load_dwordx2 v[112:113], v18, s[4:7], s9 offen sc1
    buffer_load_dwordx2 v[114:115], v60, s[4:7], s10 offen sc1
    buffer_load_dwordx4 v[80:83], v63, s[4:7], s12 offen sc1
    buffer_load_dwordx4 v[84:87], v63, s[4:7], s13 offen sc1
    buffer_load_dwordx4 v[88:91], v63, s[4:7], s14 offen sc1
    buffer_load_dwordx4 v[92:95], v63, s[4:7], s15 offen sc1
    buffer_load_dwordx4 v[96:99], v63, s[4:7], s16 offen sc1
    buffer_load_dwordx4 v[100:103], v63, s[4:7], s17 offen sc1
    buffer_load_dwordx4 v[104:107], v63, s[4:7], s18 offen sc1
    buffer_load_dwordx4 v[108:111], v63, s[4:7], s19 offen sc1
    buffer_load_dwordx4 v[64:67], v62, s[4:7], s11 offen sc1
    s_mov_b32 s42, s8
    s_waitcnt vmcnt(13)
    buffer_store_dwordx2 v[4:5], v2, s[4:7], s42 offen sc1
    s_add_u32 s86, s86, 4096
    buffer_load_dwordx4 a[220:223], v3, s[4:7], s86 offen offset:0 sc1
    buffer_load_dwordx4 a[224:227], v3, s[4:7], s86 offen offset:1024 sc1
    buffer_load_dwordx4 a[228:231], v3, s[4:7], s86 offen offset:2048 sc1
    buffer_load_dwordx4 a[232:235], v3, s[4:7], s86 offen offset:3072 sc1
    s_add_u32 s86, s86, 4096
    buffer_load_dwordx4 a[236:239], v3, s[4:7], s86 offen offset:0 sc1
    buffer_load_dwordx4 a[240:243], v3, s[4:7], s86 offen offset:1024 sc1
    buffer_load_dwordx4 a[244:247], v3, s[4:7], s86 offen offset:2048 sc1
    buffer_load_dwordx4 a[248:251], v3, s[4:7], s86 offen offset:3072 sc1
    buffer_load_dwordx4 a[0:3], v3, s[4:7], s87 offen offset:0 sc1
    buffer_load_dwordx4 a[56:59], v3, s[4:7], s92 offen offset:0 sc1
    buffer_load_dwordx4 a[4:7], v3, s[4:7], s87 offen offset:1024 sc1
    buffer_load_dwordx4 a[60:63], v3, s[4:7], s92 offen offset:1024 sc1
    s_waitcnt lgkmcnt(0)
    s_barrier
    s_xor_b32 s40, s37, 0x5a5a5a5a
    s_mov_b32 s41, 0x05040100
    s_mov_b64 s[20:21], -1
    s_waitcnt vmcnt(23)
    v_cmp_eq_u32 vcc, s37, v112
    v_cmp_eq_u32 s[44:45], s38, v113
    s_nop 2
    s_and_b64 s[20:21], s[20:21], vcc
    s_and_b64 s[20:21], s[20:21], s[44:45]
    s_waitcnt vmcnt(22)
    v_cmp_eq_u32 vcc, s37, v114
    v_cmp_eq_u32 s[44:45], s38, v115
    s_nop 2
    s_and_b64 s[20:21], s[20:21], vcc
    s_and_b64 s[20:21], s[20:21], s[44:45]
    s_waitcnt vmcnt(21)
    v_perm_b32 v6, v81, v80, s41
    v_perm_b32 v7, v83, v82, s41
    v_cmp_eq_u32 vcc, s37, v6
    v_cmp_eq_u32 s[44:45], s40, v7
    s_nop 2
    s_and_b64 s[20:21], s[20:21], vcc
    s_and_b64 s[20:21], s[20:21], s[44:45]
    s_waitcnt vmcnt(20)
    v_perm_b32 v6, v85, v84, s41
    v_perm_b32 v7, v87, v86, s41
    v_cmp_eq_u32 vcc, s37, v6
    v_cmp_eq_u32 s[44:45], s40, v7
    s_nop 2
    s_and_b64 s[20:21], s[20:21], vcc
    s_and_b64 s[20:21], s[20:21], s[44:45]
    s_waitcnt vmcnt(19)
    v_perm_b32 v6, v89, v88, s41
    v_perm_b32 v7, v91, v90, s41
    v_cmp_eq_u32 vcc, s37, v6
    v_cmp_eq_u32 s[44:45], s40, v7
    s_nop 2
    s_and_b64 s[20:21], s[20:21], vcc
    s_and_b64 s[20:21], s[20:21], s[44:45]
    s_waitcnt vmcnt(18)
    v_perm_b32 v6, v93, v92, s41
    v_perm_b32 v7, v95, v94, s41
    v_cmp_eq_u32 vcc, s37, v6
    v_cmp_eq_u32 s[44:45], s40, v7
    s_nop 2
    s_and_b64 s[20:21], s[20:21], vcc
    s_and_b64 s[20:21], s[20:21], s[44:45]
    s_waitcnt vmcnt(17)
    v_perm_b32 v6, v97, v96, s41
    v_perm_b32 v7, v99, v98, s41
    v_cmp_eq_u32 vcc, s37, v6
    v_cmp_eq_u32 s[44:45], s40, v7
    s_nop 2
    s_and_b64 s[20:21], s[20:21], vcc
    s_and_b64 s[20:21], s[20:21], s[44:45]
    s_waitcnt vmcnt(16)
    v_perm_b32 v6, v101, v100, s41
    v_perm_b32 v7, v103, v102, s41
    v_cmp_eq_u32 vcc, s37, v6
    v_cmp_eq_u32 s[44:45], s40, v7
    s_nop 2
    s_and_b64 s[20:21], s[20:21], vcc
    s_and_b64 s[20:21], s[20:21], s[44:45]
    s_waitcnt vmcnt(15)
    v_perm_b32 v6, v105, v104, s41
    v_perm_b32 v7, v107, v106, s41
    v_cmp_eq_u32 vcc, s37, v6
    v_cmp_eq_u32 s[44:45], s40, v7
    s_nop 2
    s_and_b64 s[20:21], s[20:21], vcc
    s_and_b64 s[20:21], s[20:21], s[44:45]
    s_waitcnt vmcnt(14)
    v_perm_b32 v6, v109, v108, s41
    v_perm_b32 v7, v111, v110, s41
    v_cmp_eq_u32 vcc, s37, v6
    v_cmp_eq_u32 s[44:45], s40, v7
    s_nop 2
    s_and_b64 s[20:21], s[20:21], vcc
    s_and_b64 s[20:21], s[20:21], s[44:45]
    s_waitcnt vmcnt(13)
    v_perm_b32 v6, v65, v64, s41
    v_perm_b32 v7, v67, v66, s41
    v_cmp_eq_u32 vcc, s37, v6
    v_cmp_eq_u32 s[44:45], s40, v7
    s_nop 2
    s_and_b64 s[20:21], s[20:21], vcc
    s_and_b64 s[20:21], s[20:21], s[44:45]
    s_cmp_eq_u64 s[20:21], -1
    s_nop 0
    s_cbranch_scc1 L_apd_24
    s_mov_b32 s43, 400000
    s_nop 0
L_ap_23:
    buffer_load_dwordx2 v[112:113], v18, s[4:7], s9 offen sc1
    buffer_load_dwordx2 v[114:115], v60, s[4:7], s10 offen sc1
    buffer_load_dwordx4 v[80:83], v63, s[4:7], s12 offen sc1
    buffer_load_dwordx4 v[84:87], v63, s[4:7], s13 offen sc1
    buffer_load_dwordx4 v[88:91], v63, s[4:7], s14 offen sc1
    buffer_load_dwordx4 v[92:95], v63, s[4:7], s15 offen sc1
    buffer_load_dwordx4 v[96:99], v63, s[4:7], s16 offen sc1
    buffer_load_dwordx4 v[100:103], v63, s[4:7], s17 offen sc1
    buffer_load_dwordx4 v[104:107], v63, s[4:7], s18 offen sc1
    buffer_load_dwordx4 v[108:111], v63, s[4:7], s19 offen sc1
    buffer_load_dwordx4 v[64:67], v62, s[4:7], s11 offen sc1
    s_waitcnt vmcnt(0)
    s_xor_b32 s40, s37, 0x5a5a5a5a
    s_mov_b32 s41, 0x05040100
    s_mov_b64 s[20:21], -1
    v_cmp_eq_u32 vcc, s37, v112
    v_cmp_eq_u32 s[44:45], s38, v113
    s_nop 2
    s_and_b64 s[20:21], s[20:21], vcc
    s_and_b64 s[20:21], s[20:21], s[44:45]
    v_cmp_eq_u32 vcc, s37, v114
    v_cmp_eq_u32 s[44:45], s38, v115
    s_nop 2
    s_and_b64 s[20:21], s[20:21], vcc
    s_and_b64 s[20:21], s[20:21], s[44:45]
    v_perm_b32 v6, v81, v80, s41
    v_perm_b32 v7, v83, v82, s41
    v_cmp_eq_u32 vcc, s37, v6
    v_cmp_eq_u32 s[44:45], s40, v7
    s_nop 2
    s_and_b64 s[20:21], s[20:21], vcc
    s_and_b64 s[20:21], s[20:21], s[44:45]
    v_perm_b32 v6, v85, v84, s41
    v_perm_b32 v7, v87, v86, s41
    v_cmp_eq_u32 vcc, s37, v6
    v_cmp_eq_u32 s[44:45], s40, v7
    s_nop 2
    s_and_b64 s[20:21], s[20:21], vcc
    s_and_b64 s[20:21], s[20:21], s[44:45]
    v_perm_b32 v6, v89, v88, s41
    v_perm_b32 v7, v91, v90, s41
    v_cmp_eq_u32 vcc, s37, v6
    v_cmp_eq_u32 s[44:45], s40, v7
    s_nop 2
    s_and_b64 s[20:21], s[20:21], vcc
    s_and_b64 s[20:21], s[20:21], s[44:45]
    v_perm_b32 v6, v93, v92, s41
    v_perm_b32 v7, v95, v94, s41
    v_cmp_eq_u32 vcc, s37, v6
    v_cmp_eq_u32 s[44:45], s40, v7
    s_nop 2
    s_and_b64 s[20:21], s[20:21], vcc
    s_and_b64 s[20:21], s[20:21], s[44:45]
    v_perm_b32 v6, v97, v96, s41
    v_perm_b32 v7, v99, v98, s41
    v_cmp_eq_u32 vcc, s37, v6
    v_cmp_eq_u32 s[44:45], s40, v7
    s_nop 2
    s_and_b64 s[20:21], s[20:21], vcc
    s_and_b64 s[20:21], s[20:21], s[44:45]
    v_perm_b32 v6, v101, v100, s41
    v_perm_b32 v7, v103, v102, s41
    v_cmp_eq_u32 vcc, s37, v6
    v_cmp_eq_u32 s[44:45], s40, v7
    s_nop 2
    s_and_b64 s[20:21], s[20:21], vcc
    s_and_b64 s[20:21], s[20:21], s[44:45]
    v_perm_b32 v6, v105, v104, s41
    v_perm_b32 v7, v107, v106, s41
    v_cmp_eq_u32 vcc, s37, v6
    v_cmp_eq_u32 s[44:45], s40, v7
    s_nop 2
    s_and_b64 s[20:21], s[20:21], vcc
    s_and_b64 s[20:21], s[20:21], s[44:45]
    v_perm_b32 v6, v109, v108, s41
    v_perm_b32 v7, v111, v110, s41
    v_cmp_eq_u32 vcc, s37, v6
    v_cmp_eq_u32 s[44:45], s40, v7
    s_nop 2
    s_and_b64 s[20:21], s[20:21], vcc
    s_and_b64 s[20:21], s[20:21], s[44:45]
    v_perm_b32 v6, v65, v64, s41
    v_perm_b32 v7, v67, v66, s41
    v_cmp_eq_u32 vcc, s37, v6
    v_cmp_eq_u32 s[44:45], s40, v7
    s_nop 2
    s_and_b64 s[20:21], s[20:21], vcc
    s_and_b64 s[20:21], s[20:21], s[44:45]
    s_cmp_eq_u64 s[20:21], -1
    s_nop 0
    s_cbranch_scc1 L_apd_24
    s_sub_u32 s43, s43, 1
    s_cmp_lg_u32 s43, 0
    s_nop 0
    s_cbranch_scc1 L_ap_23
    v_mov_b32 v6, 4
    s_mov_b32 s39, 0
    buffer_store_dword v6, v2, s[24:27], s39 offen
    s_nop 1
L_apd_24:
    v_and_b32 v80, s46, v80
    v_and_b32 v81, s46, v81
    v_and_b32 v82, s46, v82
    v_and_b32 v83, s46, v83
    v_and_b32 v84, s46, v84
    v_and_b32 v85, s46, v85
    v_and_b32 v86, s46, v86
    v_and_b32 v87, s46, v87
    v_and_b32 v88, s46, v88
    v_and_b32 v89, s46, v89
    v_and_b32 v90, s46, v90
    v_and_b32 v91, s46, v91
    v_and_b32 v92, s46, v92
    v_and_b32 v93, s46, v93
    v_and_b32 v94, s46, v94
    v_and_b32 v95, s46, v95
    v_and_b32 v96, s46, v96
    v_and_b32 v97, s46, v97
    v_and_b32 v98, s46, v98
    v_and_b32 v99, s46, v99
    v_and_b32 v100, s46, v100
    v_and_b32 v101, s46, v101
    v_and_b32 v102, s46, v102
    v_and_b32 v103, s46, v103
    v_and_b32 v104, s46, v104
    v_and_b32 v105, s46, v105
    v_and_b32 v106, s46, v106
    v_and_b32 v107, s46, v107
    v_and_b32 v108, s46, v108
    v_and_b32 v109, s46, v109
    v_and_b32 v110, s46, v110
    v_and_b32 v111, s46, v111
    v_and_b32 v64, s46, v64
    v_and_b32 v65, s46, v65
    v_and_b32 v66, s46, v66
    v_and_b32 v67, s46, v67
    v_and_b32 v76, 15, v1
    v_lshlrev_b32 v76, 7, v76
    s_lshl_b32 s42, s33, 11
    s_add_u32 s42, s42, 196608
    s_mov_b32 s43, 400000
    s_nop 0
L_poll_25:
    buffer_load_dwordx2 v[6:7], v76, s[4:7], s42 offen sc1
    s_waitcnt vmcnt(0)
    v_cmp_eq_u32 vcc, s37, v6
    v_cmp_eq_u32 s[44:45], s38, v7
    s_nop 3
    s_and_b64 vcc, vcc, s[44:45]
    s_cmp_eq_u64 vcc, -1
    s_nop 0
    s_cbranch_scc1 L_polld_26
    s_sub_u32 s43, s43, 1
    s_cmp_lg_u32 s43, 0
    s_nop 0
    s_cbranch_scc1 L_poll_25
    v_mov_b32 v6, 4
    s_mov_b32 s39, 0
    buffer_store_dword v6, v2, s[24:27], s39 offen
    s_nop 1
L_polld_26:
    s_lshl_b32 s39, s33, 15
    s_lshl_b32 s40, s30, 10
    s_add_u32 s39, s39, s40
    s_add_u32 s39, s39, 5242880
    s_add_u32 m0, s40, 0
    s_nop 0
    buffer_load_dwordx4 v3, s[4:7], s39 offen sc1 lds
    s_add_u32 m0, s40, 4096
    s_add_u32 s39, s39, 4096
    buffer_load_dwordx4 v3, s[4:7], s39 offen sc1 lds
    s_add_u32 m0, s40, 8192
    s_add_u32 s39, s39, 4096
    buffer_load_dwordx4 v3, s[4:7], s39 offen sc1 lds
    s_add_u32 m0, s40, 12288
    s_add_u32 s39, s39, 4096
    buffer_load_dwordx4 v3, s[4:7], s39 offen sc1 lds
    s_add_u32 m0, s40, 16384
    s_add_u32 s39, s39, 4096
    buffer_load_dwordx4 v3, s[4:7], s39 offen sc1 lds
    s_add_u32 m0, s40, 20480
    s_add_u32 s39, s39, 4096
    buffer_load_dwordx4 v3, s[4:7], s39 offen sc1 lds
    s_add_u32 m0, s40, 24576
    s_add_u32 s39, s39, 4096
    buffer_load_dwordx4 v3, s[4:7], s39 offen sc1 lds
    s_add_u32 m0, s40, 28672
    s_add_u32 s39, s39, 4096
    buffer_load_dwordx4 v3, s[4:7], s39 offen sc1 lds
    v_cmp_le_u32 vcc, 112, v61
    v_add_f32 v14, 1.0, v64
    v_add_f32 v15, 1.0, v65
    v_add_f32 v16, 1.0, v66
    v_add_f32 v17, 1.0, v67
    v_cndmask_b32 v64, v64, v14, vcc
    v_cndmask_b32 v65, v65, v15, vcc
    v_cndmask_b32 v66, v66, v16, vcc
    v_cndmask_b32 v67, v67, v17, vcc
    v_cvt_pk_bf16_f32 v64, v64, v65
    v_cvt_pk_bf16_f32 v65, v66, v67
    v_subrev_u32 v11, 112, v61
    v_cndmask_b32 v10, v61, v11, vcc
    v_lshrrev_b32 v11, 3, v10
    v_lshlrev_b32 v11, 6, v11
    v_bfe_u32 v12, v10, 2, 1
    v_lshl_add_u32 v11, v12, 4, v11
    v_and_b32 v12, 1, v10
    v_lshl_add_u32 v11, v12, 5, v11
    v_bfe_u32 v12, v10, 1, 1
    v_lshl_add_u32 v11, v12, 3, v11
    v_mov_b32 v12, 58240
    v_mov_b32 v13, 57344
    v_cndmask_b32 v12, v12, v13, vcc
    v_add_u32 v11, v11, v12
    ds_write_b64 v11, v[64:65]
    v_mov_b32 v14, 0
    v_mov_b32 v15, 0
    v_mov_b32 v16, 0
    v_mov_b32 v17, 0
    s_lshl_b32 s39, s30, 6
    v_add_u32 v10, s39, v1
    v_min_u32 v10, 55, v10
    v_lshlrev_b32 v10, 4, v10
    s_mov_b32 s39, 59136
    v_add_u32 v10, s39, v10
    ds_write_b128 v10, v[14:17]
    v_add_f32 v96, 1.0, v96
    v_add_f32 v97, 1.0, v97
    v_add_f32 v98, 1.0, v98
    v_add_f32 v99, 1.0, v99
    v_add_f32 v100, 1.0, v100
    v_add_f32 v101, 1.0, v101
    v_add_f32 v102, 1.0, v102
    v_add_f32 v103, 1.0, v103
    v_add_f32 v104, 1.0, v104
    v_add_f32 v105, 1.0, v105
    v_add_f32 v106, 1.0, v106
    v_add_f32 v107, 1.0, v107
    v_add_f32 v108, 1.0, v108
    v_add_f32 v109, 1.0, v109
    v_add_f32 v110, 1.0, v110
    v_add_f32 v111, 1.0, v111
    v_cvt_pk_bf16_f32 v76, v96, v97
    v_lshlrev_b32 v96, 16, v76
    v_and_b32 v97, s46, v76
    v_cvt_pk_bf16_f32 v76, v98, v99
    v_lshlrev_b32 v98, 16, v76
    v_and_b32 v99, s46, v76
    v_cvt_pk_bf16_f32 v76, v100, v101
    v_lshlrev_b32 v100, 16, v76
    v_and_b32 v101, s46, v76
    v_cvt_pk_bf16_f32 v76, v102, v103
    v_lshlrev_b32 v102, 16, v76
    v_and_b32 v103, s46, v76
    v_cvt_pk_bf16_f32 v76, v104, v105
    v_lshlrev_b32 v104, 16, v76
    v_and_b32 v105, s46, v76
    v_cvt_pk_bf16_f32 v76, v106, v107
    v_lshlrev_b32 v106, 16, v76
    v_and_b32 v107, s46, v76
    v_cvt_pk_bf16_f32 v76, v108, v109
    v_lshlrev_b32 v108, 16, v76
    v_and_b32 v109, s46, v76
    v_cvt_pk_bf16_f32 v76, v110, v111
    v_lshlrev_b32 v110, 16, v76
    v_and_b32 v111, s46, v76
    s_waitcnt vmcnt(6)
    s_barrier
    ds_read_b128 v[28:31], v3 offset:0
    ds_read_b128 v[32:35], v3 offset:1024
    ds_read_b128 v[36:39], v3 offset:2048
    s_waitcnt lgkmcnt(2)
    v_mfma_f32_32x32x16_bf16 v[12:27], a[124:127], v[28:31], 0
    ds_read_b128 v[40:43], v3 offset:3072
    buffer_load_dwordx4 a[8:11], v3, s[4:7], s87 offen offset:2048 sc1
    s_waitcnt lgkmcnt(2)
    v_mfma_f32_32x32x16_bf16 v[12:27], a[128:131], v[32:35], v[12:27]
    ds_read_b128 v[28:31], v3 offset:4096
    s_waitcnt lgkmcnt(2)
    v_mfma_f32_32x32x16_bf16 v[12:27], a[132:135], v[36:39], v[12:27]
    ds_read_b128 v[32:35], v3 offset:5120
    buffer_load_dwordx4 a[64:67], v3, s[4:7], s92 offen offset:2048 sc1
    s_waitcnt lgkmcnt(2)
    v_mfma_f32_32x32x16_bf16 v[12:27], a[136:139], v[40:43], v[12:27]
    ds_read_b128 v[36:39], v3 offset:6144
    s_waitcnt lgkmcnt(2)
    v_mfma_f32_32x32x16_bf16 v[12:27], a[140:143], v[28:31], v[12:27]
    ds_read_b128 v[40:43], v3 offset:7168
    buffer_load_dwordx4 a[12:15], v3, s[4:7], s87 offen offset:3072 sc1
    s_waitcnt lgkmcnt(2)
    v_mfma_f32_32x32x16_bf16 v[12:27], a[144:147], v[32:35], v[12:27]
    s_waitcnt vmcnt(3)
    s_waitcnt lgkmcnt(0)
    s_barrier
    ds_read_b128 v[28:31], v3 offset:8192
    v_mfma_f32_32x32x16_bf16 v[12:27], a[148:151], v[36:39], v[12:27]
    ds_read_b128 v[32:35], v3 offset:9216
    buffer_load_dwordx4 a[68:71], v3, s[4:7], s92 offen offset:3072 sc1
    v_mfma_f32_32x32x16_bf16 v[12:27], a[152:155], v[40:43], v[12:27]
    ds_read_b128 v[36:39], v3 offset:10240
    s_waitcnt lgkmcnt(2)
    v_mfma_f32_32x32x16_bf16 v[12:27], a[156:159], v[28:31], v[12:27]
    ds_read_b128 v[40:43], v3 offset:11264
    s_add_u32 s87, s87, 4096
    buffer_load_dwordx4 a[16:19], v3, s[4:7], s87 offen offset:0 sc1
    s_waitcnt lgkmcnt(2)
    v_mfma_f32_32x32x16_bf16 v[12:27], a[160:163], v[32:35], v[12:27]
    ds_read_b128 v[28:31], v3 offset:12288
    s_waitcnt lgkmcnt(2)
    v_mfma_f32_32x32x16_bf16 v[12:27], a[164:167], v[36:39], v[12:27]
    ds_read_b128 v[32:35], v3 offset:13312
    s_add_u32 s92, s92, 4096
    buffer_load_dwordx4 a[72:75], v3, s[4:7], s92 offen offset:0 sc1
    s_waitcnt lgkmcnt(2)
    v_mfma_f32_32x32x16_bf16 v[12:27], a[168:171], v[40:43], v[12:27]
    ds_read_b128 v[36:39], v3 offset:14336
    s_waitcnt lgkmcnt(2)
    v_mfma_f32_32x32x16_bf16 v[12:27], a[172:175], v[28:31], v[12:27]
    ds_read_b128 v[40:43], v3 offset:15360
    buffer_load_dwordx4 a[20:23], v3, s[4:7], s87 offen offset:1024 sc1
    s_waitcnt lgkmcnt(2)
    v_mfma_f32_32x32x16_bf16 v[12:27], a[176:179], v[32:35], v[12:27]
    ds_read_b128 v[28:31], v3 offset:16384
    s_waitcnt lgkmcnt(2)
    v_mfma_f32_32x32x16_bf16 v[12:27], a[180:183], v[36:39], v[12:27]
    ds_read_b128 v[32:35], v3 offset:17408
    buffer_load_dwordx4 a[76:79], v3, s[4:7], s92 offen offset:1024 sc1
    s_waitcnt lgkmcnt(2)
    v_mfma_f32_32x32x16_bf16 v[12:27], a[184:187], v[40:43], v[12:27]
    ds_read_b128 v[36:39], v3 offset:18432
    s_waitcnt lgkmcnt(2)
    v_mfma_f32_32x32x16_bf16 v[12:27], a[188:191], v[28:31], v[12:27]
    ds_read_b128 v[40:43], v3 offset:19456
    buffer_load_dwordx4 a[24:27], v3, s[4:7], s87 offen offset:2048 sc1
    s_waitcnt lgkmcnt(2)
    v_mfma_f32_32x32x16_bf16 v[12:27], a[192:195], v[32:35], v[12:27]
    ds_read_b128 v[28:31], v3 offset:20480
    s_waitcnt lgkmcnt(2)
    v_mfma_f32_32x32x16_bf16 v[12:27], a[196:199], v[36:39], v[12:27]
    ds_read_b128 v[32:35], v3 offset:21504
    buffer_load_dwordx4 a[80:83], v3, s[4:7], s92 offen offset:2048 sc1
    s_waitcnt lgkmcnt(2)
    v_mfma_f32_32x32x16_bf16 v[12:27], a[200:203], v[40:43], v[12:27]
    ds_read_b128 v[36:39], v3 offset:22528
    s_waitcnt lgkmcnt(2)
    v_mfma_f32_32x32x16_bf16 v[12:27], a[204:207], v[28:31], v[12:27]
    ds_read_b128 v[40:43], v3 offset:23552
    buffer_load_dwordx4 a[28:31], v3, s[4:7], s87 offen offset:3072 sc1
    s_waitcnt lgkmcnt(2)
    v_mfma_f32_32x32x16_bf16 v[12:27], a[208:211], v[32:35], v[12:27]
    ds_read_b128 v[28:31], v3 offset:24576
    s_waitcnt lgkmcnt(2)
    v_mfma_f32_32x32x16_bf16 v[12:27], a[212:215], v[36:39], v[12:27]
    ds_read_b128 v[32:35], v3 offset:25600
    buffer_load_dwordx4 a[84:87], v3, s[4:7], s92 offen offset:3072 sc1
    s_waitcnt lgkmcnt(2)
    v_mfma_f32_32x32x16_bf16 v[12:27], a[216:219], v[40:43], v[12:27]
    ds_read_b128 v[36:39], v3 offset:26624
    s_waitcnt lgkmcnt(2)
    v_mfma_f32_32x32x16_bf16 v[12:27], a[220:223], v[28:31], v[12:27]
    ds_read_b128 v[40:43], v3 offset:27648
    s_add_u32 s87, s87, 4096
    buffer_load_dwordx4 a[32:35], v3, s[4:7], s87 offen offset:0 sc1
    s_waitcnt lgkmcnt(2)
    v_mfma_f32_32x32x16_bf16 v[12:27], a[224:227], v[32:35], v[12:27]
    ds_read_b128 v[28:31], v3 offset:28672
    s_waitcnt lgkmcnt(2)
    v_mfma_f32_32x32x16_bf16 v[12:27], a[228:231], v[36:39], v[12:27]
    ds_read_b128 v[32:35], v3 offset:29696
    s_add_u32 s92, s92, 4096
    buffer_load_dwordx4 a[88:91], v3, s[4:7], s92 offen offset:0 sc1
    s_waitcnt lgkmcnt(2)
    v_mfma_f32_32x32x16_bf16 v[12:27], a[232:235], v[40:43], v[12:27]
    ds_read_b128 v[36:39], v3 offset:30720
    s_waitcnt lgkmcnt(2)
    v_mfma_f32_32x32x16_bf16 v[12:27], a[236:239], v[28:31], v[12:27]
    ds_read_b128 v[40:43], v3 offset:31744
    buffer_load_dwordx4 a[36:39], v3, s[4:7], s87 offen offset:1024 sc1
    s_waitcnt lgkmcnt(2)
    v_mfma_f32_32x32x16_bf16 v[12:27], a[240:243], v[32:35], v[12:27]
    s_waitcnt lgkmcnt(1)
    v_mfma_f32_32x32x16_bf16 v[12:27], a[244:247], v[36:39], v[12:27]
    buffer_load_dwordx4 a[92:95], v3, s[4:7], s92 offen offset:1024 sc1
    s_waitcnt lgkmcnt(0)
    v_mfma_f32_32x32x16_bf16 v[12:27], a[248:251], v[40:43], v[12:27]
    buffer_load_dwordx4 a[40:43], v3, s[4:7], s87 offen offset:2048 sc1
    buffer_load_dwordx4 a[96:99], v3, s[4:7], s92 offen offset:2048 sc1
    buffer_load_dwordx4 a[44:47], v3, s[4:7], s87 offen offset:3072 sc1
    buffer_load_dwordx4 a[100:103], v3, s[4:7], s92 offen offset:3072 sc1
    s_add_u32 s87, s87, 4096
    buffer_load_dwordx4 a[48:51], v3, s[4:7], s87 offen offset:0 sc1
    s_add_u32 s92, s92, 4096
    buffer_load_dwordx4 a[104:107], v3, s[4:7], s92 offen offset:0 sc1
    buffer_load_dwordx4 a[52:55], v3, s[4:7], s87 offen offset:1024 sc1
    buffer_load_dwordx4 a[108:111], v3, s[4:7], s92 offen offset:1024 sc1
    s_lshl_b32 s39, s30, 1
    s_add_u32 s39, s39, 0
    s_min_u32 s39, s39, 6
    s_mul_i32 s40, s36, 7
    s_add_u32 s39, s39, s40
    s_mul_i32 s8, s39, 14336
    s_add_u32 s8, s8, 20971520
    s_lshl_b32 s39, s30, 1
    s_add_u32 s39, s39, 1
    s_min_u32 s39, s39, 6
    s_mul_i32 s40, s36, 7
    s_add_u32 s39, s39, s40
    s_mul_i32 s9, s39, 14336
    s_add_u32 s9, s9, 20971520
    s_cmp_lt_u32 s30, 3
    s_cselect_b32 s9, s9, 2130706432
    v_permlane32_swap_b32 v68, v70
    v_permlane32_swap_b32 v69, v71
    v_permlane32_swap_b32 v72, v74
    v_permlane32_swap_b32 v73, v75
    v_lshlrev_b32 v28, 16, v68
    v_and_b32 v29, s46, v68
    v_lshlrev_b32 v30, 16, v69
    v_and_b32 v31, s46, v69
    v_lshlrev_b32 v32, 16, v70
    v_and_b32 v33, s46, v70
    v_lshlrev_b32 v34, 16, v71
    v_and_b32 v35, s46, v71
    v_lshlrev_b32 v36, 16, v72
    v_and_b32 v37, s46, v72
    v_lshlrev_b32 v38, 16, v73
    v_and_b32 v39, s46, v73
    v_lshlrev_b32 v40, 16, v74
    v_and_b32 v41, s46, v74
    v_lshlrev_b32 v42, 16, v75
    v_and_b32 v43, s46, v75
    v_bfe_u32 v76, v1, 4, 1
    v_mul_u32_u24 v6, 14336, v76
    v_lshrrev_b32 v76, 5, v1
    v_lshl_add_u32 v6, v76, 9, v6
    v_and_b32 v76, 15, v1
    v_lshl_add_u32 v6, v76, 4, v6
    v_and_b32 v7, 31, v1
    v_lshlrev_b32 v7, 3, v7
    s_mul_i32 s10, s33, 28
    s_add_u32 s10, s10, s57
    s_lshl_b32 s10, s10, 10
    s_add_u32 s10, s10, 7340032
    s_lshl_b32 s11, s33, 4
    s_add_u32 s11, s11, s57
    s_lshl_b32 s12, s11, 7
    s_add_u32 s12, s12, 327680
    s_lshl_b32 s11, s11, 8
    s_add_u32 s11, s11, 19660800
    v_pk_fma_f32 v[28:29], v[80:81], v[12:13], v[28:29]
    v_pk_fma_f32 v[30:31], v[82:83], v[14:15], v[30:31]
    v_pk_fma_f32 v[32:33], v[84:85], v[16:17], v[32:33]
    v_pk_fma_f32 v[34:35], v[86:87], v[18:19], v[34:35]
    v_pk_fma_f32 v[36:37], v[88:89], v[20:21], v[36:37]
    v_pk_fma_f32 v[38:39], v[90:91], v[22:23], v[38:39]
    v_pk_fma_f32 v[40:41], v[92:93], v[24:25], v[40:41]
    v_pk_fma_f32 v[42:43], v[94:95], v[26:27], v[42:43]
    v_pk_mul_f32 v[12:13], v[96:97], v[28:29]
    v_pk_mul_f32 v[14:15], v[98:99], v[30:31]
    v_pk_mul_f32 v[16:17], v[100:101], v[32:33]
    v_pk_mul_f32 v[18:19], v[102:103], v[34:35]
    v_pk_mul_f32 v[20:21], v[104:105], v[36:37]
    v_pk_mul_f32 v[22:23], v[106:107], v[38:39]
    v_pk_mul_f32 v[24:25], v[108:109], v[40:41]
    v_pk_mul_f32 v[26:27], v[110:111], v[42:43]
    v_cvt_pk_bf16_f32 v52, v12, v13
    v_cvt_pk_bf16_f32 v53, v14, v15
    v_cvt_pk_bf16_f32 v54, v16, v17
    v_cvt_pk_bf16_f32 v55, v18, v19
    v_cvt_pk_bf16_f32 v56, v20, v21
    v_cvt_pk_bf16_f32 v57, v22, v23
    v_cvt_pk_bf16_f32 v58, v24, v25
    v_cvt_pk_bf16_f32 v59, v26, v27
    s_cmp_ge_u32 s57, 14
    s_nop 1
    s_cbranch_scc1 L_p3skip_27
    buffer_store_dwordx4 v[52:55], v6, s[4:7], s10 offen offset:0 sc1
    buffer_store_dwordx4 v[56:59], v6, s[4:7], s10 offen offset:256 sc1
    s_nop 1
L_p3skip_27:
    v_cvt_pk_bf16_f32 v44, v28, v29
    v_cvt_pk_bf16_f32 v45, v30, v31
    v_cvt_pk_bf16_f32 v46, v32, v33
    v_cvt_pk_bf16_f32 v47, v34, v35
    v_cvt_pk_bf16_f32 v48, v36, v37
    v_cvt_pk_bf16_f32 v49, v38, v39
    v_cvt_pk_bf16_f32 v50, v40, v41
    v_cvt_pk_bf16_f32 v51, v42, v43
    v_mov_b32 v60, 0
    v_mov_b32 v61, 0
    v_mov_b32 v62, 0
    v_mov_b32 v63, 0
    v_dot2_f32_bf16 v60, v44, s56, v60
    v_dot2_f32_bf16 v62, v44, v44, v62
    v_dot2_f32_bf16 v61, v45, s56, v61
    v_dot2_f32_bf16 v63, v45, v45, v63
    v_dot2_f32_bf16 v60, v46, s56, v60
    v_dot2_f32_bf16 v62, v46, v46, v62
    v_dot2_f32_bf16 v61, v47, s56, v61
    v_dot2_f32_bf16 v63, v47, v47, v63
    v_dot2_f32_bf16 v60, v48, s56, v60
    v_dot2_f32_bf16 v62, v48, v48, v62
    v_dot2_f32_bf16 v61, v49, s56, v61
    v_dot2_f32_bf16 v63, v49, v49, v63
    v_dot2_f32_bf16 v60, v50, s56, v60
    v_dot2_f32_bf16 v62, v50, v50, v62
    v_dot2_f32_bf16 v61, v51, s56, v61
    v_dot2_f32_bf16 v63, v51, v51, v63
    s_nop 1
    v_add_f32 v60, v60, v61
    v_add_f32 v62, v62, v63
    s_nop 1
    v_permlane32_swap_b32 v60, v62
    v_add_f32 v60, v60, v62
    v_mov_b32 v61, v60
    s_nop 1
    v_permlane32_swap_b32 v60, v61
    s_cmp_ge_u32 s57, 14
    s_nop 1
    s_cbranch_scc1 L_p3skip2_28
    s_mov_b32 s44, -1
    s_mov_b32 s45, 0
    s_mov_b64 exec, s[44:45]
    buffer_store_dwordx2 v[60:61], v7, s[4:7], s11 offen sc1
    s_mov_b64 exec, -1
    s_waitcnt vmcnt(0)
    buffer_store_dwordx2 v[4:5], v2, s[4:7], s12 offen sc1
    s_nop 1
L_p3skip2_28:
    buffer_load_dwordx4 a[112:115], v3, s[4:7], s8 offen offset:0 sc1
    buffer_load_dwordx4 a[168:171], v3, s[4:7], s9 offen offset:0 sc1
    buffer_load_dwordx4 a[116:119], v3, s[4:7], s8 offen offset:1024 sc1
    buffer_load_dwordx4 a[172:175], v3, s[4:7], s9 offen offset:1024 sc1
    buffer_load_dwordx4 a[120:123], v3, s[4:7], s8 offen offset:2048 sc1
    buffer_load_dwordx4 a[176:179], v3, s[4:7], s9 offen offset:2048 sc1
    buffer_load_dwordx4 a[124:127], v3, s[4:7], s8 offen offset:3072 sc1
    buffer_load_dwordx4 a[180:183], v3, s[4:7], s9 offen offset:3072 sc1
    s_add_u32 s8, s8, 4096
    buffer_load_dwordx4 a[128:131], v3, s[4:7], s8 offen offset:0 sc1
    s_add_u32 s9, s9, 4096
    buffer_load_dwordx4 a[184:187], v3, s[4:7], s9 offen offset:0 sc1
    buffer_load_dwordx4 a[132:135], v3, s[4:7], s8 offen offset:1024 sc1
    buffer_load_dwordx4 a[188:191], v3, s[4:7], s9 offen offset:1024 sc1
    s_waitcnt lgkmcnt(0)
    s_barrier
    v_mov_b32 v6, 1.0
    v_mov_b32 v7, 1.0
    v_mov_b32 v14, 0xc0135761
    v_mov_b32 v15, 0xbdd2d3e8
    s_load_dwordx2 s[12:13], s[0:1], 40
    s_waitcnt lgkmcnt(0)
    s_mov_b32 s14, 8388608
    s_mov_b32 s15, 0x20000
    v_lshrrev_b32 v16, 3, v1
    v_lshlrev_b32 v18, 12, v16
    v_lshrrev_b32 v16, 4, v1
    v_and_b32 v17, 7, v1
    v_xor_b32 v16, v16, v17
    v_lshl_add_u32 v19, v16, 4, v18
    v_xor_b32 v16, 4, v16
    v_lshl_add_u32 v16, v16, 4, v18
    v_mov_b32 v18, v19
    v_mov_b32 v19, v16
    s_add_u32 s39, s30, 0
    s_and_b32 s39, s39, 3
    s_lshl_b32 s40, s35, 2
    s_add_u32 s39, s39, s40
    s_lshl_b32 s39, s39, 16
    s_lshl_b32 s40, s30, 10
    s_add_u32 s10, s39, s40
    s_add_u32 s39, s30, 1
    s_and_b32 s39, s39, 3
    s_lshl_b32 s40, s35, 2
    s_add_u32 s39, s39, s40
    s_lshl_b32 s39, s39, 16
    s_lshl_b32 s40, s30, 10
    s_add_u32 s11, s39, s40
    s_add_u32 s39, s30, 2
    s_and_b32 s39, s39, 3
    s_lshl_b32 s40, s35, 2
    s_add_u32 s39, s39, s40
    s_lshl_b32 s39, s39, 16
    s_lshl_b32 s40, s30, 10
    s_add_u32 s16, s39, s40
    s_add_u32 s39, s30, 3
    s_and_b32 s39, s39, 3
    s_lshl_b32 s40, s35, 2
    s_add_u32 s39, s39, s40
    s_lshl_b32 s39, s39, 16
    s_lshl_b32 s40, s30, 10
    s_add_u32 s17, s39, s40
    s_lshl_b32 s18, s30, 14
    s_mul_i32 s19, s30, 24576
    v_bfe_u32 v16, v1, 3, 1
    v_lshlrev_b32 v8, 10, v16
    v_and_b32 v16, 7, v1
    v_lshl_add_u32 v8, v16, 7, v8
    v_bfe_u32 v16, v1, 1, 3
    v_lshrrev_b32 v17, 4, v1
    v_xor_b32 v16, v16, v17
    v_xor_b32 v17, 0, v16
    v_lshl_add_u32 v20, v17, 4, v8
    v_add_u32 v20, s18, v20
    s_mov_b32 s39, 98304
    v_add_u32 v20, s39, v20
    v_xor_b32 v17, 4, v16
    v_lshl_add_u32 v21, v17, 4, v8
    v_add_u32 v21, s18, v21
    s_mov_b32 s39, 98304
    v_add_u32 v21, s39, v21
    v_xor_b32 v17, 0, v16
    v_lshl_add_u32 v22, v17, 4, v8
    v_add_u32 v22, s19, v22
    v_xor_b32 v17, 4, v16
    v_lshl_add_u32 v23, v17, 4, v8
    v_add_u32 v23, s19, v23
    v_and_b32 v8, 15, v1
    v_min_u32 v8, 2, v8
    v_mul_u32_u24 v16, 896, v8
    v_lshrrev_b32 v8, 4, v1
    v_lshl_add_u32 v16, v8, 4, v16
    s_mov_b32 s39, 57344
    v_add_u32 v16, s39, v16
    ds_read_b128 v[32:35], v16 offset:0
    ds_read_b128 v[36:39], v16 offset:64
    ds_read_b128 v[40:43], v16 offset:128
    s_waitcnt lgkmcnt(2)
    v_mfma_f32_16x16x32_bf16 v[24:27], a[0:3], v[32:35], 0
    v_mfma_f32_16x16x32_bf16 v[28:31], a[56:59], v[32:35], 0
    ds_read_b128 v[32:35], v16 offset:192
    s_waitcnt lgkmcnt(2)
    v_mfma_f32_16x16x32_bf16 v[24:27], a[4:7], v[36:39], v[24:27]
    v_mfma_f32_16x16x32_bf16 v[28:31], a[60:63], v[36:39], v[28:31]
    ds_read_b128 v[36:39], v16 offset:256
    s_waitcnt vmcnt(35) lgkmcnt(2)
    v_mfma_f32_16x16x32_bf16 v[24:27], a[8:11], v[40:43], v[24:27]
    s_waitcnt vmcnt(34)
    v_mfma_f32_16x16x32_bf16 v[28:31], a[64:67], v[40:43], v[28:31]
    ds_read_b128 v[40:43], v16 offset:320
    s_waitcnt vmcnt(33) lgkmcnt(2)
    v_mfma_f32_16x16x32_bf16 v[24:27], a[12:15], v[32:35], v[24:27]
    s_waitcnt vmcnt(32)
    v_mfma_f32_16x16x32_bf16 v[28:31], a[68:71], v[32:35], v[28:31]
    ds_read_b128 v[32:35], v16 offset:384
    s_waitcnt vmcnt(31) lgkmcnt(2)
    v_mfma_f32_16x16x32_bf16 v[24:27], a[16:19], v[36:39], v[24:27]
    s_waitcnt vmcnt(30)
    v_mfma_f32_16x16x32_bf16 v[28:31], a[72:75], v[36:39], v[28:31]
    ds_read_b128 v[36:39], v16 offset:448
    s_waitcnt vmcnt(29) lgkmcnt(2)
    v_mfma_f32_16x16x32_bf16 v[24:27], a[20:23], v[40:43], v[24:27]
    s_waitcnt vmcnt(28)
    v_mfma_f32_16x16x32_bf16 v[28:31], a[76:79], v[40:43], v[28:31]
    ds_read_b128 v[40:43], v16 offset:512
    s_waitcnt vmcnt(27) lgkmcnt(2)
    v_mfma_f32_16x16x32_bf16 v[24:27], a[24:27], v[32:35], v[24:27]
    s_waitcnt vmcnt(26)
    v_mfma_f32_16x16x32_bf16 v[28:31], a[80:83], v[32:35], v[28:31]
    ds_read_b128 v[32:35], v16 offset:576
    s_waitcnt vmcnt(25) lgkmcnt(2)
    v_mfma_f32_16x16x32_bf16 v[24:27], a[28:31], v[36:39], v[24:27]
    s_waitcnt vmcnt(24)
    v_mfma_f32_16x16x32_bf16 v[28:31], a[84:87], v[36:39], v[28:31]
    ds_read_b128 v[36:39], v16 offset:640
    s_waitcnt vmcnt(23) lgkmcnt(2)
    v_mfma_f32_16x16x32_bf16 v[24:27], a[32:35], v[40:43], v[24:27]
    s_waitcnt vmcnt(22)
    v_mfma_f32_16x16x32_bf16 v[28:31], a[88:91], v[40:43], v[28:31]
    ds_read_b128 v[40:43], v16 offset:704
    s_waitcnt vmcnt(21) lgkmcnt(2)
    v_mfma_f32_16x16x32_bf16 v[24:27], a[36:39], v[32:35], v[24:27]
    s_waitcnt vmcnt(20)
    v_mfma_f32_16x16x32_bf16 v[28:31], a[92:95], v[32:35], v[28:31]
    ds_read_b128 v[32:35], v16 offset:768
    s_waitcnt vmcnt(19) lgkmcnt(2)
    v_mfma_f32_16x16x32_bf16 v[24:27], a[40:43], v[36:39], v[24:27]
    s_waitcnt vmcnt(18)
    v_mfma_f32_16x16x32_bf16 v[28:31], a[96:99], v[36:39], v[28:31]
    ds_read_b128 v[36:39], v16 offset:832
    s_waitcnt vmcnt(17) lgkmcnt(2)
    v_mfma_f32_16x16x32_bf16 v[24:27], a[44:47], v[40:43], v[24:27]
    s_waitcnt vmcnt(16)
    v_mfma_f32_16x16x32_bf16 v[28:31], a[100:103], v[40:43], v[28:31]
    s_waitcnt vmcnt(15) lgkmcnt(1)
    v_mfma_f32_16x16x32_bf16 v[24:27], a[48:51], v[32:35], v[24:27]
    s_waitcnt vmcnt(14)
    v_mfma_f32_16x16x32_bf16 v[28:31], a[104:107], v[32:35], v[28:31]
    s_waitcnt vmcnt(13) lgkmcnt(0)
    v_mfma_f32_16x16x32_bf16 v[24:27], a[52:55], v[36:39], v[24:27]
    s_waitcnt vmcnt(12)
    v_mfma_f32_16x16x32_bf16 v[28:31], a[108:111], v[36:39], v[28:31]
    s_nop 5
    v_mov_b32_dpp v52, v24 row_newbcast:0 row_mask:0xf bank_mask:0xf
    v_mov_b32_dpp v60, v24 row_newbcast:1 row_mask:0xf bank_mask:0xf
    v_mov_b32_dpp v53, v25 row_newbcast:0 row_mask:0xf bank_mask:0xf
    v_mov_b32_dpp v61, v25 row_newbcast:1 row_mask:0xf bank_mask:0xf
    v_mov_b32_dpp v54, v26 row_newbcast:0 row_mask:0xf bank_mask:0xf
    v_mov_b32_dpp v62, v26 row_newbcast:1 row_mask:0xf bank_mask:0xf
    v_mov_b32_dpp v55, v27 row_newbcast:0 row_mask:0xf bank_mask:0xf
    v_mov_b32_dpp v63, v27 row_newbcast:1 row_mask:0xf bank_mask:0xf
    v_mov_b32_dpp v56, v28 row_newbcast:0 row_mask:0xf bank_mask:0xf
    v_mov_b32_dpp v64, v28 row_newbcast:1 row_mask:0xf bank_mask:0xf
    v_mov_b32_dpp v57, v29 row_newbcast:0 row_mask:0xf bank_mask:0xf
    v_mov_b32_dpp v65, v29 row_newbcast:1 row_mask:0xf bank_mask:0xf
    v_mov_b32_dpp v58, v30 row_newbcast:0 row_mask:0xf bank_mask:0xf
    v_mov_b32_dpp v66, v30 row_newbcast:1 row_mask:0xf bank_mask:0xf
    v_mov_b32_dpp v59, v31 row_newbcast:0 row_mask:0xf bank_mask:0xf
    v_mov_b32_dpp v67, v31 row_newbcast:1 row_mask:0xf bank_mask:0xf
    v_min_u32 v10, 13, v1
    v_lshlrev_b32 v10, 7, v10
    s_lshl_b32 s39, s35, 1
    s_lshr_b32 s40, s30, 1
    s_add_u32 s39, s39, s40
    s_mov_b32 s20, s39
    s_lshl_b32 s42, s39, 11
    s_add_u32 s42, s42, 327680
    s_mov_b32 s43, 400000
    s_nop 0
L_poll_29:
    buffer_load_dwordx2 v[16:17], v10, s[4:7], s42 offen sc1
    s_waitcnt vmcnt(0)
    v_cmp_eq_u32 vcc, s37, v16
    v_cmp_eq_u32 s[44:45], s38, v17
    s_nop 3
    s_and_b64 vcc, vcc, s[44:45]
    s_cmp_eq_u64 vcc, -1
    s_nop 0
    s_cbranch_scc1 L_polld_30
    s_sub_u32 s43, s43, 1
    s_cmp_lg_u32 s43, 0
    s_nop 0
    s_cbranch_scc1 L_poll_29
    v_mov_b32 v16, 6
    s_mov_b32 s39, 0
    buffer_store_dword v16, v2, s[24:27], s39 offen
    s_nop 1
L_polld_30:
    v_and_b32 v10, 15, v1
    s_and_b32 s39, s30, 1
    s_lshl_b32 s39, s39, 4
    v_add_u32 v10, s39, v10
    v_lshlrev_b32 v10, 3, v10
    v_lshrrev_b32 v11, 4, v1
    v_lshl_add_u32 v10, v11, 8, v10
    v_mov_b32 v12, 0x7f000000
    v_cmp_gt_u32 vcc, 32, v1
    s_nop 1
    v_cndmask_b32 v12, v12, v10, vcc
    s_lshl_b32 s39, s20, 12
    s_add_u32 s39, s39, 19660800
    buffer_load_dwordx2 v[24:25], v10, s[4:7], s39 offen offset:0 sc1
    buffer_load_dwordx2 v[26:27], v10, s[4:7], s39 offen offset:1024 sc1
    buffer_load_dwordx2 v[28:29], v10, s[4:7], s39 offen offset:2048 sc1
    buffer_load_dwordx2 v[30:31], v12, s[4:7], s39 offen offset:3072 sc1
    s_lshl_b32 s39, s35, 2
    s_add_u32 s39, s39, s30
    s_mul_i32 s39, s39, 14336
    s_add_u32 s39, s39, 7340032
    s_mul_i32 s40, s30, 14336
    s_add_u32 m0, s40, 0
    s_nop 0
    buffer_load_dwordx4 v3, s[4:7], s39 offen offset:0 sc1 lds
    buffer_load_dwordx4 v3, s[4:7], s39 offen offset:1024 sc1 lds
    buffer_load_dwordx4 v3, s[4:7], s39 offen offset:2048 sc1 lds
    buffer_load_dwordx4 v3, s[4:7], s39 offen offset:3072 sc1 lds
    s_add_u32 m0, s40, 4096
    s_add_u32 s39, s39, 4096
    buffer_load_dwordx4 v3, s[4:7], s39 offen offset:0 sc1 lds
    buffer_load_dwordx4 v3, s[4:7], s39 offen offset:1024 sc1 lds
    buffer_load_dwordx4 v3, s[4:7], s39 offen offset:2048 sc1 lds
    buffer_load_dwordx4 v3, s[4:7], s39 offen offset:3072 sc1 lds
    s_add_u32 m0, s40, 8192
    s_add_u32 s39, s39, 4096
    buffer_load_dwordx4 v3, s[4:7], s39 offen offset:0 sc1 lds
    buffer_load_dwordx4 v3, s[4:7], s39 offen offset:1024 sc1 lds
    buffer_load_dwordx4 v3, s[4:7], s39 offen offset:2048 sc1 lds
    buffer_load_dwordx4 v3, s[4:7], s39 offen offset:3072 sc1 lds
    s_add_u32 m0, s40, 12288
    s_add_u32 s39, s39, 4096
    buffer_load_dwordx4 v3, s[4:7], s39 offen offset:0 sc1 lds
    buffer_load_dwordx4 v3, s[4:7], s39 offen offset:1024 sc1 lds
    s_waitcnt vmcnt(16)
    v_pk_add_f32 v[24:25], v[24:25], v[26:27]
    s_waitcnt vmcnt(14)
    v_pk_add_f32 v[28:29], v[28:29], v[30:31]
    v_pk_add_f32 v[24:25], v[24:25], v[28:29]
    s_nop 1
    v_permlane32_swap_b32 v24, v25
    v_add_f32 v24, v24, v25
    v_mov_b32 v25, v24
    s_nop 1
    v_permlane16_swap_b32 v24, v25
    v_add_f32 v24, v24, v25
    v_mov_b32 v25, v24
    s_nop 1
    v_permlane32_swap_b32 v24, v25
    v_mul_f32 v24, 0x3b124925, v24
    v_mul_f32 v25, 0x3b124925, v25
    v_fma_f32 v10, -v24, v24, v25
    v_max_f32 v10, 0, v10
    v_add_f32 v25, 0x3727c5ac, v10
    v_rsq_f32 v26, v25
    v_sub_f32 v27, 0, v24
    v_and_b32 v8, 15, v1
    v_lshlrev_b32 v8, 3, v8
    s_lshl_b32 s39, s30, 7
    s_add_u32 s39, s39, 60032
    v_add_u32 v10, s39, v8
    ds_write_b64 v10, v[26:27]
    s_waitcnt vmcnt(10)
    s_waitcnt lgkmcnt(0)
    s_barrier
    s_mov_b32 s39, 60032
    v_add_u32 v10, s39, v8
    ds_read_b64 v[24:25], v10 offset:0
    ds_read_b64 v[26:27], v10 offset:128
    ds_read_b64 v[28:29], v10 offset:256
    ds_read_b64 v[30:31], v10 offset:384
    s_lshl_b32 s20, s35, 3
    s_add_u32 s20, s20, s36
    s_lshl_b32 s20, s20, 15
    s_lshl_b32 s40, s30, 10
    s_add_u32 s20, s20, s40
    s_add_u32 s20, s20, 0
    v_lshrrev_b32 v16, 2, v1
    v_lshlrev_b32 v16, 12, v16
    v_and_b32 v17, 3, v1
    v_lshl_add_u32 v16, v17, 7, v16
    v_cmp_gt_u32 vcc, 32, v1
    v_mov_b32 v17, 0x7f000000
    s_nop 0
    v_cndmask_b32 v16, v17, v16, vcc
    buffer_load_dword v32, v16, s[12:15], s20 offen
    ds_read_b128 v[100:103], v3 offset:0
    ds_read_b128 v[104:107], v3 offset:14336
    ds_read_b128 v[108:111], v3 offset:28672
    ds_read_b128 v[112:115], v3 offset:43008
    s_waitcnt lgkmcnt(3)
    v_mfma_f32_16x16x32_bf16 v[68:71], a[0:3], v[100:103], 0
    ds_read_b128 v[116:119], v3 offset:1024
    v_mfma_f32_16x16x32_bf16 v[84:87], a[56:59], v[100:103], 0
    ds_read_b128 v[120:123], v3 offset:15360
    s_waitcnt lgkmcnt(4)
    v_mfma_f32_16x16x32_bf16 v[72:75], a[0:3], v[104:107], 0
    ds_read_b128 v[124:127], v3 offset:29696
    v_mfma_f32_16x16x32_bf16 v[88:91], a[56:59], v[104:107], 0
    ds_read_b128 v[128:131], v3 offset:44032
    s_waitcnt lgkmcnt(5)
    v_mfma_f32_16x16x32_bf16 v[76:79], a[0:3], v[108:111], 0
    buffer_load_dwordx4 a[136:139], v3, s[4:7], s8 offen offset:2048 sc1
    v_mfma_f32_16x16x32_bf16 v[92:95], a[56:59], v[108:111], 0
    s_waitcnt lgkmcnt(4)
    v_mfma_f32_16x16x32_bf16 v[80:83], a[0:3], v[112:115], 0
    v_mfma_f32_16x16x32_bf16 v[96:99], a[56:59], v[112:115], 0
    s_waitcnt lgkmcnt(3)
    v_mfma_f32_16x16x32_bf16 v[68:71], a[4:7], v[116:119], v[68:71]
    ds_read_b128 v[100:103], v3 offset:2048
    v_mfma_f32_16x16x32_bf16 v[84:87], a[60:63], v[116:119], v[84:87]
    ds_read_b128 v[104:107], v3 offset:16384
    s_waitcnt lgkmcnt(4)
    v_mfma_f32_16x16x32_bf16 v[72:75], a[4:7], v[120:123], v[72:75]
    ds_read_b128 v[108:111], v3 offset:30720
    v_mfma_f32_16x16x32_bf16 v[88:91], a[60:63], v[120:123], v[88:91]
    ds_read_b128 v[112:115], v3 offset:45056
    s_waitcnt lgkmcnt(5)
    v_mfma_f32_16x16x32_bf16 v[76:79], a[4:7], v[124:127], v[76:79]
    buffer_load_dwordx4 a[192:195], v3, s[4:7], s9 offen offset:2048 sc1
    v_mfma_f32_16x16x32_bf16 v[92:95], a[60:63], v[124:127], v[92:95]
    s_waitcnt lgkmcnt(4)
    v_mfma_f32_16x16x32_bf16 v[80:83], a[4:7], v[128:131], v[80:83]
    v_mfma_f32_16x16x32_bf16 v[96:99], a[60:63], v[128:131], v[96:99]
    s_waitcnt lgkmcnt(3)
    v_mfma_f32_16x16x32_bf16 v[68:71], a[8:11], v[100:103], v[68:71]
    ds_read_b128 v[116:119], v3 offset:3072
    v_mfma_f32_16x16x32_bf16 v[84:87], a[64:67], v[100:103], v[84:87]
    ds_read_b128 v[120:123], v3 offset:17408
    s_waitcnt lgkmcnt(4)
    v_mfma_f32_16x16x32_bf16 v[72:75], a[8:11], v[104:107], v[72:75]
    ds_read_b128 v[124:127], v3 offset:31744
    v_mfma_f32_16x16x32_bf16 v[88:91], a[64:67], v[104:107], v[88:91]
    ds_read_b128 v[128:131], v3 offset:46080
    s_waitcnt lgkmcnt(5)
    v_mfma_f32_16x16x32_bf16 v[76:79], a[8:11], v[108:111], v[76:79]
    buffer_load_dwordx4 a[140:143], v3, s[4:7], s8 offen offset:3072 sc1
    v_mfma_f32_16x16x32_bf16 v[92:95], a[64:67], v[108:111], v[92:95]
    s_waitcnt lgkmcnt(4)
    v_mfma_f32_16x16x32_bf16 v[80:83], a[8:11], v[112:115], v[80:83]
    v_mfma_f32_16x16x32_bf16 v[96:99], a[64:67], v[112:115], v[96:99]
    s_waitcnt vmcnt(4)
    s_waitcnt lgkmcnt(0)
    s_barrier
    v_mfma_f32_16x16x32_bf16 v[68:71], a[12:15], v[116:119], v[68:71]
    ds_read_b128 v[100:103], v3 offset:4096
    v_mfma_f32_16x16x32_bf16 v[84:87], a[68:71], v[116:119], v[84:87]
    ds_read_b128 v[104:107], v3 offset:18432
    v_mfma_f32_16x16x32_bf16 v[72:75], a[12:15], v[120:123], v[72:75]
    ds_read_b128 v[108:111], v3 offset:32768
    v_mfma_f32_16x16x32_bf16 v[88:91], a[68:71], v[120:123], v[88:91]
    ds_read_b128 v[112:115], v3 offset:47104
    v_mfma_f32_16x16x32_bf16 v[76:79], a[12:15], v[124:127], v[76:79]
    buffer_load_dwordx4 a[196:199], v3, s[4:7], s9 offen offset:3072 sc1
    v_mfma_f32_16x16x32_bf16 v[92:95], a[68:71], v[124:127], v[92:95]
    v_mfma_f32_16x16x32_bf16 v[80:83], a[12:15], v[128:131], v[80:83]
    v_mfma_f32_16x16x32_bf16 v[96:99], a[68:71], v[128:131], v[96:99]
    s_waitcnt lgkmcnt(3)
    v_mfma_f32_16x16x32_bf16 v[68:71], a[16:19], v[100:103], v[68:71]
    ds_read_b128 v[116:119], v3 offset:5120
    v_mfma_f32_16x16x32_bf16 v[84:87], a[72:75], v[100:103], v[84:87]
    ds_read_b128 v[120:123], v3 offset:19456
    s_waitcnt lgkmcnt(4)
    v_mfma_f32_16x16x32_bf16 v[72:75], a[16:19], v[104:107], v[72:75]
    ds_read_b128 v[124:127], v3 offset:33792
    v_mfma_f32_16x16x32_bf16 v[88:91], a[72:75], v[104:107], v[88:91]
    ds_read_b128 v[128:131], v3 offset:48128
    s_waitcnt lgkmcnt(5)
    v_mfma_f32_16x16x32_bf16 v[76:79], a[16:19], v[108:111], v[76:79]
    s_add_u32 s8, s8, 4096
    buffer_load_dwordx4 a[144:147], v3, s[4:7], s8 offen offset:0 sc1
    v_mfma_f32_16x16x32_bf16 v[92:95], a[72:75], v[108:111], v[92:95]
    s_waitcnt lgkmcnt(4)
    v_mfma_f32_16x16x32_bf16 v[80:83], a[16:19], v[112:115], v[80:83]
    v_mfma_f32_16x16x32_bf16 v[96:99], a[72:75], v[112:115], v[96:99]
    s_waitcnt lgkmcnt(3)
    v_mfma_f32_16x16x32_bf16 v[68:71], a[20:23], v[116:119], v[68:71]
    ds_read_b128 v[100:103], v3 offset:6144
    v_mfma_f32_16x16x32_bf16 v[84:87], a[76:79], v[116:119], v[84:87]
    ds_read_b128 v[104:107], v3 offset:20480
    s_waitcnt lgkmcnt(4)
    v_mfma_f32_16x16x32_bf16 v[72:75], a[20:23], v[120:123], v[72:75]
    ds_read_b128 v[108:111], v3 offset:34816
    v_mfma_f32_16x16x32_bf16 v[88:91], a[76:79], v[120:123], v[88:91]
    ds_read_b128 v[112:115], v3 offset:49152
    s_waitcnt lgkmcnt(5)
    v_mfma_f32_16x16x32_bf16 v[76:79], a[20:23], v[124:127], v[76:79]
    s_add_u32 s9, s9, 4096
    buffer_load_dwordx4 a[200:203], v3, s[4:7], s9 offen offset:0 sc1
    v_mfma_f32_16x16x32_bf16 v[92:95], a[76:79], v[124:127], v[92:95]
    s_waitcnt lgkmcnt(4)
    v_mfma_f32_16x16x32_bf16 v[80:83], a[20:23], v[128:131], v[80:83]
    v_mfma_f32_16x16x32_bf16 v[96:99], a[76:79], v[128:131], v[96:99]
    s_waitcnt lgkmcnt(3)
    v_mfma_f32_16x16x32_bf16 v[68:71], a[24:27], v[100:103], v[68:71]
    ds_read_b128 v[116:119], v3 offset:7168
    v_mfma_f32_16x16x32_bf16 v[84:87], a[80:83], v[100:103], v[84:87]
    ds_read_b128 v[120:123], v3 offset:21504
    s_waitcnt lgkmcnt(4)
    v_mfma_f32_16x16x32_bf16 v[72:75], a[24:27], v[104:107], v[72:75]
    ds_read_b128 v[124:127], v3 offset:35840
    v_mfma_f32_16x16x32_bf16 v[88:91], a[80:83], v[104:107], v[88:91]
    ds_read_b128 v[128:131], v3 offset:50176
    s_waitcnt lgkmcnt(5)
    v_mfma_f32_16x16x32_bf16 v[76:79], a[24:27], v[108:111], v[76:79]
    buffer_load_dwordx4 a[148:151], v3, s[4:7], s8 offen offset:1024 sc1
    v_mfma_f32_16x16x32_bf16 v[92:95], a[80:83], v[108:111], v[92:95]
    buffer_load_dwordx4 a[204:207], v3, s[4:7], s9 offen offset:1024 sc1
    s_waitcnt lgkmcnt(4)
    v_mfma_f32_16x16x32_bf16 v[80:83], a[24:27], v[112:115], v[80:83]
    v_mfma_f32_16x16x32_bf16 v[96:99], a[80:83], v[112:115], v[96:99]
    s_waitcnt lgkmcnt(3)
    v_mfma_f32_16x16x32_bf16 v[68:71], a[28:31], v[116:119], v[68:71]
    ds_read_b128 v[100:103], v3 offset:8192
    v_mfma_f32_16x16x32_bf16 v[84:87], a[84:87], v[116:119], v[84:87]
    ds_read_b128 v[104:107], v3 offset:22528
    s_waitcnt lgkmcnt(4)
    v_mfma_f32_16x16x32_bf16 v[72:75], a[28:31], v[120:123], v[72:75]
    ds_read_b128 v[108:111], v3 offset:36864
    v_mfma_f32_16x16x32_bf16 v[88:91], a[84:87], v[120:123], v[88:91]
    ds_read_b128 v[112:115], v3 offset:51200
    s_waitcnt lgkmcnt(5)
    v_mfma_f32_16x16x32_bf16 v[76:79], a[28:31], v[124:127], v[76:79]
    buffer_load_dwordx4 a[152:155], v3, s[4:7], s8 offen offset:2048 sc1
    v_mfma_f32_16x16x32_bf16 v[92:95], a[84:87], v[124:127], v[92:95]
    s_waitcnt lgkmcnt(4)
    v_mfma_f32_16x16x32_bf16 v[80:83], a[28:31], v[128:131], v[80:83]
    v_mfma_f32_16x16x32_bf16 v[96:99], a[84:87], v[128:131], v[96:99]
    s_waitcnt lgkmcnt(3)
    v_mfma_f32_16x16x32_bf16 v[68:71], a[32:35], v[100:103], v[68:71]
    ds_read_b128 v[116:119], v3 offset:9216
    v_mfma_f32_16x16x32_bf16 v[84:87], a[88:91], v[100:103], v[84:87]
    ds_read_b128 v[120:123], v3 offset:23552
    s_waitcnt lgkmcnt(4)
    v_mfma_f32_16x16x32_bf16 v[72:75], a[32:35], v[104:107], v[72:75]
    ds_read_b128 v[124:127], v3 offset:37888
    v_mfma_f32_16x16x32_bf16 v[88:91], a[88:91], v[104:107], v[88:91]
    ds_read_b128 v[128:131], v3 offset:52224
    s_waitcnt lgkmcnt(5)
    v_mfma_f32_16x16x32_bf16 v[76:79], a[32:35], v[108:111], v[76:79]
    buffer_load_dwordx4 a[208:211], v3, s[4:7], s9 offen offset:2048 sc1
    v_mfma_f32_16x16x32_bf16 v[92:95], a[88:91], v[108:111], v[92:95]
    s_waitcnt lgkmcnt(4)
    v_mfma_f32_16x16x32_bf16 v[80:83], a[32:35], v[112:115], v[80:83]
    v_mfma_f32_16x16x32_bf16 v[96:99], a[88:91], v[112:115], v[96:99]
    s_waitcnt lgkmcnt(3)
    v_mfma_f32_16x16x32_bf16 v[68:71], a[36:39], v[116:119], v[68:71]
    ds_read_b128 v[100:103], v3 offset:10240
    v_mfma_f32_16x16x32_bf16 v[84:87], a[92:95], v[116:119], v[84:87]
    ds_read_b128 v[104:107], v3 offset:24576
    s_waitcnt lgkmcnt(4)
    v_mfma_f32_16x16x32_bf16 v[72:75], a[36:39], v[120:123], v[72:75]
    ds_read_b128 v[108:111], v3 offset:38912
    v_mfma_f32_16x16x32_bf16 v[88:91], a[92:95], v[120:123], v[88:91]
    ds_read_b128 v[112:115], v3 offset:53248
    s_waitcnt lgkmcnt(5)
    v_mfma_f32_16x16x32_bf16 v[76:79], a[36:39], v[124:127], v[76:79]
    buffer_load_dwordx4 a[156:159], v3, s[4:7], s8 offen offset:3072 sc1
    v_mfma_f32_16x16x32_bf16 v[92:95], a[92:95], v[124:127], v[92:95]
    s_waitcnt lgkmcnt(4)
    v_mfma_f32_16x16x32_bf16 v[80:83], a[36:39], v[128:131], v[80:83]
    v_mfma_f32_16x16x32_bf16 v[96:99], a[92:95], v[128:131], v[96:99]
    s_waitcnt lgkmcnt(3)
    v_mfma_f32_16x16x32_bf16 v[68:71], a[40:43], v[100:103], v[68:71]
    ds_read_b128 v[116:119], v3 offset:11264
    v_mfma_f32_16x16x32_bf16 v[84:87], a[96:99], v[100:103], v[84:87]
    ds_read_b128 v[120:123], v3 offset:25600
    s_waitcnt lgkmcnt(4)
    v_mfma_f32_16x16x32_bf16 v[72:75], a[40:43], v[104:107], v[72:75]
    ds_read_b128 v[124:127], v3 offset:39936
    v_mfma_f32_16x16x32_bf16 v[88:91], a[96:99], v[104:107], v[88:91]
    ds_read_b128 v[128:131], v3 offset:54272
    s_waitcnt lgkmcnt(5)
    v_mfma_f32_16x16x32_bf16 v[76:79], a[40:43], v[108:111], v[76:79]
    buffer_load_dwordx4 a[212:215], v3, s[4:7], s9 offen offset:3072 sc1
    v_mfma_f32_16x16x32_bf16 v[92:95], a[96:99], v[108:111], v[92:95]
    s_waitcnt lgkmcnt(4)
    v_mfma_f32_16x16x32_bf16 v[80:83], a[40:43], v[112:115], v[80:83]
    v_mfma_f32_16x16x32_bf16 v[96:99], a[96:99], v[112:115], v[96:99]
    s_waitcnt lgkmcnt(3)
    v_mfma_f32_16x16x32_bf16 v[68:71], a[44:47], v[116:119], v[68:71]
    ds_read_b128 v[100:103], v3 offset:12288
    v_mfma_f32_16x16x32_bf16 v[84:87], a[100:103], v[116:119], v[84:87]
    ds_read_b128 v[104:107], v3 offset:26624
    s_waitcnt lgkmcnt(4)
    v_mfma_f32_16x16x32_bf16 v[72:75], a[44:47], v[120:123], v[72:75]
    ds_read_b128 v[108:111], v3 offset:40960
    v_mfma_f32_16x16x32_bf16 v[88:91], a[100:103], v[120:123], v[88:91]
    ds_read_b128 v[112:115], v3 offset:55296
    s_waitcnt lgkmcnt(5)
    v_mfma_f32_16x16x32_bf16 v[76:79], a[44:47], v[124:127], v[76:79]
    s_add_u32 s8, s8, 4096
    buffer_load_dwordx4 a[160:163], v3, s[4:7], s8 offen offset:0 sc1
    v_mfma_f32_16x16x32_bf16 v[92:95], a[100:103], v[124:127], v[92:95]
    s_waitcnt lgkmcnt(4)
    v_mfma_f32_16x16x32_bf16 v[80:83], a[44:47], v[128:131], v[80:83]
    v_mfma_f32_16x16x32_bf16 v[96:99], a[100:103], v[128:131], v[96:99]
    s_waitcnt lgkmcnt(3)
    v_mfma_f32_16x16x32_bf16 v[68:71], a[48:51], v[100:103], v[68:71]
    ds_read_b128 v[116:119], v3 offset:13312
    v_mfma_f32_16x16x32_bf16 v[84:87], a[104:107], v[100:103], v[84:87]
    ds_read_b128 v[120:123], v3 offset:27648
    s_waitcnt lgkmcnt(4)
    v_mfma_f32_16x16x32_bf16 v[72:75], a[48:51], v[104:107], v[72:75]
    ds_read_b128 v[124:127], v3 offset:41984
    v_mfma_f32_16x16x32_bf16 v[88:91], a[104:107], v[104:107], v[88:91]
    ds_read_b128 v[128:131], v3 offset:56320
    s_waitcnt lgkmcnt(5)
    v_mfma_f32_16x16x32_bf16 v[76:79], a[48:51], v[108:111], v[76:79]
    s_add_u32 s9, s9, 4096
    buffer_load_dwordx4 a[216:219], v3, s[4:7], s9 offen offset:0 sc1
    v_mfma_f32_16x16x32_bf16 v[92:95], a[104:107], v[108:111], v[92:95]
    s_waitcnt lgkmcnt(4)
    v_mfma_f32_16x16x32_bf16 v[80:83], a[48:51], v[112:115], v[80:83]
    v_mfma_f32_16x16x32_bf16 v[96:99], a[104:107], v[112:115], v[96:99]
    s_waitcnt lgkmcnt(3)
    v_mfma_f32_16x16x32_bf16 v[68:71], a[52:55], v[116:119], v[68:71]
    buffer_load_dwordx4 a[164:167], v3, s[4:7], s8 offen offset:1024 sc1
    v_mfma_f32_16x16x32_bf16 v[84:87], a[108:111], v[116:119], v[84:87]
    buffer_load_dwordx4 a[220:223], v3, s[4:7], s9 offen offset:1024 sc1
    s_waitcnt lgkmcnt(2)
    v_mfma_f32_16x16x32_bf16 v[72:75], a[52:55], v[120:123], v[72:75]
    v_mfma_f32_16x16x32_bf16 v[88:91], a[108:111], v[120:123], v[88:91]
    s_waitcnt lgkmcnt(1)
    v_mfma_f32_16x16x32_bf16 v[76:79], a[52:55], v[124:127], v[76:79]
    v_mfma_f32_16x16x32_bf16 v[92:95], a[108:111], v[124:127], v[92:95]
    s_waitcnt lgkmcnt(0)
    v_mfma_f32_16x16x32_bf16 v[80:83], a[52:55], v[128:131], v[80:83]
    v_mfma_f32_16x16x32_bf16 v[96:99], a[108:111], v[128:131], v[96:99]
    v_pk_fma_f32 v[68:69], v[52:53], v[24:25], v[68:69] op_sel:[0,1,0] op_sel_hi:[1,1,1]
    v_pk_fma_f32 v[70:71], v[54:55], v[24:25], v[70:71] op_sel:[0,1,0] op_sel_hi:[1,1,1]
    v_pk_fma_f32 v[72:73], v[52:53], v[26:27], v[72:73] op_sel:[0,1,0] op_sel_hi:[1,1,1]
    v_pk_fma_f32 v[74:75], v[54:55], v[26:27], v[74:75] op_sel:[0,1,0] op_sel_hi:[1,1,1]
    v_pk_fma_f32 v[76:77], v[52:53], v[28:29], v[76:77] op_sel:[0,1,0] op_sel_hi:[1,1,1]
    v_pk_fma_f32 v[78:79], v[54:55], v[28:29], v[78:79] op_sel:[0,1,0] op_sel_hi:[1,1,1]
    s_nop 0
    v_pk_fma_f32 v[80:81], v[52:53], v[30:31], v[80:81] op_sel:[0,1,0] op_sel_hi:[1,1,1]
    v_pk_fma_f32 v[82:83], v[54:55], v[30:31], v[82:83] op_sel:[0,1,0] op_sel_hi:[1,1,1]
    v_pk_fma_f32 v[84:85], v[56:57], v[24:25], v[84:85] op_sel:[0,1,0] op_sel_hi:[1,1,1]
    v_pk_fma_f32 v[86:87], v[58:59], v[24:25], v[86:87] op_sel:[0,1,0] op_sel_hi:[1,1,1]
    v_pk_fma_f32 v[88:89], v[56:57], v[26:27], v[88:89] op_sel:[0,1,0] op_sel_hi:[1,1,1]
    v_pk_fma_f32 v[90:91], v[58:59], v[26:27], v[90:91] op_sel:[0,1,0] op_sel_hi:[1,1,1]
    v_pk_fma_f32 v[92:93], v[56:57], v[28:29], v[92:93] op_sel:[0,1,0] op_sel_hi:[1,1,1]
    v_pk_fma_f32 v[94:95], v[58:59], v[28:29], v[94:95] op_sel:[0,1,0] op_sel_hi:[1,1,1]
    v_pk_fma_f32 v[96:97], v[56:57], v[30:31], v[96:97] op_sel:[0,1,0] op_sel_hi:[1,1,1]
    v_pk_fma_f32 v[98:99], v[58:59], v[30:31], v[98:99] op_sel:[0,1,0] op_sel_hi:[1,1,1]
    v_pk_fma_f32 v[68:69], v[68:69], v[24:25], v[60:61] op_sel_hi:[1,0,1]
    v_pk_fma_f32 v[70:71], v[70:71], v[24:25], v[62:63] op_sel_hi:[1,0,1]
    v_pk_fma_f32 v[72:73], v[72:73], v[26:27], v[60:61] op_sel_hi:[1,0,1]
    v_pk_fma_f32 v[74:75], v[74:75], v[26:27], v[62:63] op_sel_hi:[1,0,1]
    v_pk_fma_f32 v[76:77], v[76:77], v[28:29], v[60:61] op_sel_hi:[1,0,1]
    v_pk_fma_f32 v[78:79], v[78:79], v[28:29], v[62:63] op_sel_hi:[1,0,1]
    v_pk_fma_f32 v[80:81], v[80:81], v[30:31], v[60:61] op_sel_hi:[1,0,1]
    v_pk_fma_f32 v[82:83], v[82:83], v[30:31], v[62:63] op_sel_hi:[1,0,1]
    v_pk_fma_f32 v[84:85], v[84:85], v[24:25], v[64:65] op_sel_hi:[1,0,1]
    v_pk_fma_f32 v[86:87], v[86:87], v[24:25], v[66:67] op_sel_hi:[1,0,1]
    v_pk_fma_f32 v[88:89], v[88:89], v[26:27], v[64:65] op_sel_hi:[1,0,1]
    v_pk_fma_f32 v[90:91], v[90:91], v[26:27], v[66:67] op_sel_hi:[1,0,1]
    v_pk_fma_f32 v[92:93], v[92:93], v[28:29], v[64:65] op_sel_hi:[1,0,1]
    v_pk_fma_f32 v[94:95], v[94:95], v[28:29], v[66:67] op_sel_hi:[1,0,1]
    v_pk_fma_f32 v[96:97], v[96:97], v[30:31], v[64:65] op_sel_hi:[1,0,1]
    v_pk_fma_f32 v[98:99], v[98:99], v[30:31], v[66:67] op_sel_hi:[1,0,1]
    v_pk_mul_f32 v[116:117], v[68:69], v[68:69]
    v_pk_mul_f32 v[118:119], v[70:71], v[70:71]
    v_pk_mul_f32 v[120:121], v[72:73], v[72:73]
    v_pk_mul_f32 v[122:123], v[74:75], v[74:75]
    v_pk_mul_f32 v[124:125], v[76:77], v[76:77]
    v_pk_mul_f32 v[126:127], v[78:79], v[78:79]
    v_pk_mul_f32 v[128:129], v[80:81], v[80:81]
    v_pk_mul_f32 v[130:131], v[82:83], v[82:83]
    v_pk_mul_f32 v[132:133], v[84:85], v[84:85]
    s_add_u32 s39, s10, 640
    s_add_u32 m0, s18, 98304
    s_nop 0
    buffer_load_dwordx4 v18, s[12:15], s39 offen lds
    v_pk_mul_f32 v[134:135], v[86:87], v[86:87]
    v_pk_mul_f32 v[136:137], v[88:89], v[88:89]
    v_pk_mul_f32 v[138:139], v[90:91], v[90:91]
    v_pk_mul_f32 v[140:141], v[92:93], v[92:93]
    v_pk_mul_f32 v[142:143], v[94:95], v[94:95]
    v_pk_mul_f32 v[144:145], v[96:97], v[96:97]
    v_pk_mul_f32 v[146:147], v[98:99], v[98:99]
    v_pk_fma_f32 v[116:117], v[116:117], v[14:15], v[14:15] op_sel:[0,1,0] op_sel_hi:[1,1,0]
    v_pk_fma_f32 v[118:119], v[118:119], v[14:15], v[14:15] op_sel:[0,1,0] op_sel_hi:[1,1,0]
    s_add_u32 s39, s10, 33408
    s_add_u32 m0, s18, 99328
    s_nop 0
    buffer_load_dwordx4 v19, s[12:15], s39 offen lds
    v_pk_fma_f32 v[120:121], v[120:121], v[14:15], v[14:15] op_sel:[0,1,0] op_sel_hi:[1,1,0]
    v_pk_fma_f32 v[122:123], v[122:123], v[14:15], v[14:15] op_sel:[0,1,0] op_sel_hi:[1,1,0]
    v_pk_fma_f32 v[124:125], v[124:125], v[14:15], v[14:15] op_sel:[0,1,0] op_sel_hi:[1,1,0]
    v_pk_fma_f32 v[126:127], v[126:127], v[14:15], v[14:15] op_sel:[0,1,0] op_sel_hi:[1,1,0]
    v_pk_fma_f32 v[128:129], v[128:129], v[14:15], v[14:15] op_sel:[0,1,0] op_sel_hi:[1,1,0]
    v_pk_fma_f32 v[130:131], v[130:131], v[14:15], v[14:15] op_sel:[0,1,0] op_sel_hi:[1,1,0]
    v_pk_fma_f32 v[132:133], v[132:133], v[14:15], v[14:15] op_sel:[0,1,0] op_sel_hi:[1,1,0]
    v_pk_fma_f32 v[134:135], v[134:135], v[14:15], v[14:15] op_sel:[0,1,0] op_sel_hi:[1,1,0]
    v_pk_fma_f32 v[136:137], v[136:137], v[14:15], v[14:15] op_sel:[0,1,0] op_sel_hi:[1,1,0]
    s_add_u32 s39, s11, 640
    s_add_u32 m0, s18, 100352
    s_nop 0
    buffer_load_dwordx4 v18, s[12:15], s39 offen lds
    v_pk_fma_f32 v[138:139], v[138:139], v[14:15], v[14:15] op_sel:[0,1,0] op_sel_hi:[1,1,0]
    v_pk_fma_f32 v[140:141], v[140:141], v[14:15], v[14:15] op_sel:[0,1,0] op_sel_hi:[1,1,0]
    v_pk_fma_f32 v[142:143], v[142:143], v[14:15], v[14:15] op_sel:[0,1,0] op_sel_hi:[1,1,0]
    v_pk_fma_f32 v[144:145], v[144:145], v[14:15], v[14:15] op_sel:[0,1,0] op_sel_hi:[1,1,0]
    v_pk_fma_f32 v[146:147], v[146:147], v[14:15], v[14:15] op_sel:[0,1,0] op_sel_hi:[1,1,0]
    v_pk_mul_f32 v[116:117], v[116:117], v[68:69]
    v_pk_mul_f32 v[118:119], v[118:119], v[70:71]
    v_pk_mul_f32 v[120:121], v[120:121], v[72:73]
    v_pk_mul_f32 v[122:123], v[122:123], v[74:75]
    s_add_u32 s39, s11, 33408
    s_add_u32 m0, s18, 101376
    s_nop 0
    buffer_load_dwordx4 v19, s[12:15], s39 offen lds
    v_pk_mul_f32 v[124:125], v[124:125], v[76:77]
    v_pk_mul_f32 v[126:127], v[126:127], v[78:79]
    v_pk_mul_f32 v[128:129], v[128:129], v[80:81]
    v_pk_mul_f32 v[130:131], v[130:131], v[82:83]
    v_pk_mul_f32 v[132:133], v[132:133], v[84:85]
    v_pk_mul_f32 v[134:135], v[134:135], v[86:87]
    v_pk_mul_f32 v[136:137], v[136:137], v[88:89]
    v_pk_mul_f32 v[138:139], v[138:139], v[90:91]
    v_pk_mul_f32 v[140:141], v[140:141], v[92:93]
    s_add_u32 s39, s16, 640
    s_add_u32 m0, s18, 102400
    s_nop 0
    buffer_load_dwordx4 v18, s[12:15], s39 offen lds
    v_pk_mul_f32 v[142:143], v[142:143], v[94:95]
    v_pk_mul_f32 v[144:145], v[144:145], v[96:97]
    v_pk_mul_f32 v[146:147], v[146:147], v[98:99]
    v_exp_f32 v116, v116
    v_exp_f32 v117, v117
    v_exp_f32 v118, v118
    v_exp_f32 v119, v119
    v_exp_f32 v120, v120
    v_exp_f32 v121, v121
    s_add_u32 s39, s16, 33408
    s_add_u32 m0, s18, 103424
    s_nop 0
    buffer_load_dwordx4 v19, s[12:15], s39 offen lds
    v_exp_f32 v122, v122
    v_exp_f32 v123, v123
    v_exp_f32 v124, v124
    v_exp_f32 v125, v125
    v_exp_f32 v126, v126
    v_exp_f32 v127, v127
    v_exp_f32 v128, v128
    v_exp_f32 v129, v129
    v_exp_f32 v130, v130
    s_add_u32 s39, s17, 640
    s_add_u32 m0, s18, 104448
    s_nop 0
    buffer_load_dwordx4 v18, s[12:15], s39 offen lds
    v_exp_f32 v131, v131
    v_exp_f32 v132, v132
    v_exp_f32 v133, v133
    v_exp_f32 v134, v134
    v_exp_f32 v135, v135
    v_exp_f32 v136, v136
    v_exp_f32 v137, v137
    v_exp_f32 v138, v138
    v_exp_f32 v139, v139
    s_add_u32 s39, s17, 33408
    s_add_u32 m0, s18, 105472
    s_nop 0
    buffer_load_dwordx4 v19, s[12:15], s39 offen lds
    v_exp_f32 v140, v140
    v_exp_f32 v141, v141
    v_exp_f32 v142, v142
    v_exp_f32 v143, v143
    v_exp_f32 v144, v144
    v_exp_f32 v145, v145
    v_exp_f32 v146, v146
    v_exp_f32 v147, v147
    v_pk_add_f32 v[116:117], v[116:117], v[6:7]
    s_add_u32 s39, s10, 768
    s_add_u32 m0, s18, 106496
    s_nop 0
    buffer_load_dwordx4 v18, s[12:15], s39 offen lds
    v_pk_add_f32 v[118:119], v[118:119], v[6:7]
    v_pk_add_f32 v[120:121], v[120:121], v[6:7]
    v_pk_add_f32 v[122:123], v[122:123], v[6:7]
    v_pk_add_f32 v[124:125], v[124:125], v[6:7]
    v_pk_add_f32 v[126:127], v[126:127], v[6:7]
    v_pk_add_f32 v[128:129], v[128:129], v[6:7]
    v_pk_add_f32 v[130:131], v[130:131], v[6:7]
    v_pk_add_f32 v[132:133], v[132:133], v[6:7]
    v_pk_add_f32 v[134:135], v[134:135], v[6:7]
    s_add_u32 s39, s10, 33536
    s_add_u32 m0, s18, 107520
    s_nop 0
    buffer_load_dwordx4 v19, s[12:15], s39 offen lds
    v_pk_add_f32 v[136:137], v[136:137], v[6:7]
    v_pk_add_f32 v[138:139], v[138:139], v[6:7]
    v_pk_add_f32 v[140:141], v[140:141], v[6:7]
    v_pk_add_f32 v[142:143], v[142:143], v[6:7]
    v_pk_add_f32 v[144:145], v[144:145], v[6:7]
    v_pk_add_f32 v[146:147], v[146:147], v[6:7]
    v_rcp_f32 v116, v116
    v_rcp_f32 v117, v117
    v_rcp_f32 v118, v118
    s_add_u32 s39, s11, 768
    s_add_u32 m0, s18, 108544
    s_nop 0
    buffer_load_dwordx4 v18, s[12:15], s39 offen lds
    v_rcp_f32 v119, v119
    v_rcp_f32 v120, v120
    v_rcp_f32 v121, v121
    v_rcp_f32 v122, v122
    v_rcp_f32 v123, v123
    v_rcp_f32 v124, v124
    v_rcp_f32 v125, v125
    v_rcp_f32 v126, v126
    v_rcp_f32 v127, v127
    s_add_u32 s39, s11, 33536
    s_add_u32 m0, s18, 109568
    s_nop 0
    buffer_load_dwordx4 v19, s[12:15], s39 offen lds
    v_rcp_f32 v128, v128
    v_rcp_f32 v129, v129
    v_rcp_f32 v130, v130
    v_rcp_f32 v131, v131
    v_rcp_f32 v132, v132
    v_rcp_f32 v133, v133
    v_rcp_f32 v134, v134
    v_rcp_f32 v135, v135
    v_rcp_f32 v136, v136
    s_add_u32 s39, s16, 768
    s_add_u32 m0, s18, 110592
    s_nop 0
    buffer_load_dwordx4 v18, s[12:15], s39 offen lds
    v_rcp_f32 v137, v137
    v_rcp_f32 v138, v138
    v_rcp_f32 v139, v139
    v_rcp_f32 v140, v140
    v_rcp_f32 v141, v141
    v_rcp_f32 v142, v142
    v_rcp_f32 v143, v143
    v_rcp_f32 v144, v144
    v_rcp_f32 v145, v145
    s_add_u32 s39, s16, 33536
    s_add_u32 m0, s18, 111616
    s_nop 0
    buffer_load_dwordx4 v19, s[12:15], s39 offen lds
    v_rcp_f32 v146, v146
    v_rcp_f32 v147, v147
    v_pk_mul_f32 v[68:69], v[68:69], v[116:117]
    v_pk_mul_f32 v[70:71], v[70:71], v[118:119]
    v_pk_mul_f32 v[72:73], v[72:73], v[120:121]
    v_pk_mul_f32 v[74:75], v[74:75], v[122:123]
    v_pk_mul_f32 v[76:77], v[76:77], v[124:125]
    v_pk_mul_f32 v[78:79], v[78:79], v[126:127]
    v_pk_mul_f32 v[80:81], v[80:81], v[128:129]
    s_add_u32 s39, s17, 768
    s_add_u32 m0, s18, 112640
    s_nop 0
    buffer_load_dwordx4 v18, s[12:15], s39 offen lds
    v_pk_mul_f32 v[82:83], v[82:83], v[130:131]
    v_pk_mul_f32 v[84:85], v[84:85], v[132:133]
    v_pk_mul_f32 v[86:87], v[86:87], v[134:135]
    v_pk_mul_f32 v[88:89], v[88:89], v[136:137]
    v_pk_mul_f32 v[90:91], v[90:91], v[138:139]
    v_pk_mul_f32 v[92:93], v[92:93], v[140:141]
    v_pk_mul_f32 v[94:95], v[94:95], v[142:143]
    v_pk_mul_f32 v[96:97], v[96:97], v[144:145]
    v_pk_mul_f32 v[98:99], v[98:99], v[146:147]
    s_add_u32 s39, s17, 33536
    s_add_u32 m0, s18, 113664
    s_nop 0
    buffer_load_dwordx4 v19, s[12:15], s39 offen lds
    v_cvt_pk_bf16_f32 v100, v68, v69
    v_cvt_pk_bf16_f32 v101, v70, v71
    v_cvt_pk_bf16_f32 v102, v72, v73
    v_cvt_pk_bf16_f32 v103, v74, v75
    v_cvt_pk_bf16_f32 v104, v76, v77
    v_cvt_pk_bf16_f32 v105, v78, v79
    v_cvt_pk_bf16_f32 v106, v80, v81
    v_cvt_pk_bf16_f32 v107, v82, v83
    v_cvt_pk_bf16_f32 v108, v84, v85
    v_cvt_pk_bf16_f32 v109, v86, v87
    v_cvt_pk_bf16_f32 v110, v88, v89
    v_cvt_pk_bf16_f32 v111, v90, v91
    v_cvt_pk_bf16_f32 v112, v92, v93
    v_cvt_pk_bf16_f32 v113, v94, v95
    v_cvt_pk_bf16_f32 v114, v96, v97
    v_cvt_pk_bf16_f32 v115, v98, v99
    s_cmp_lt_u32 s30, 3
    s_cselect_b32 s39, -1, 0
    v_and_b32 v108, s39, v108
    v_and_b32 v109, s39, v109
    v_and_b32 v110, s39, v110
    v_and_b32 v111, s39, v111
    v_and_b32 v112, s39, v112
    v_and_b32 v113, s39, v113
    v_and_b32 v114, s39, v114
    v_and_b32 v115, s39, v115
    v_mov_b32 v34, 0
    v_mov_b32 v35, 0
    v_mov_b32 v36, 0
    v_mov_b32 v37, 0
    v_mov_b32 v38, 0
    v_mov_b32 v39, 0
    v_mov_b32 v40, 0
    v_mov_b32 v41, 0
    v_dot2_f32_bf16 v34, v100, s56, v34
    v_dot2_f32_bf16 v35, v100, v100, v35
    v_dot2_f32_bf16 v34, v101, s56, v34
    v_dot2_f32_bf16 v35, v101, v101, v35
    v_dot2_f32_bf16 v34, v108, s56, v34
    v_dot2_f32_bf16 v35, v108, v108, v35
    v_dot2_f32_bf16 v34, v109, s56, v34
    v_dot2_f32_bf16 v35, v109, v109, v35
    v_dot2_f32_bf16 v36, v102, s56, v36
    v_dot2_f32_bf16 v37, v102, v102, v37
    v_dot2_f32_bf16 v36, v103, s56, v36
    v_dot2_f32_bf16 v37, v103, v103, v37
    v_dot2_f32_bf16 v36, v110, s56, v36
    v_dot2_f32_bf16 v37, v110, v110, v37
    v_dot2_f32_bf16 v36, v111, s56, v36
    v_dot2_f32_bf16 v37, v111, v111, v37
    v_dot2_f32_bf16 v38, v104, s56, v38
    v_dot2_f32_bf16 v39, v104, v104, v39
    v_dot2_f32_bf16 v38, v105, s56, v38
    v_dot2_f32_bf16 v39, v105, v105, v39
    v_dot2_f32_bf16 v38, v112, s56, v38
    v_dot2_f32_bf16 v39, v112, v112, v39
    v_dot2_f32_bf16 v38, v113, s56, v38
    v_dot2_f32_bf16 v39, v113, v113, v39
    v_dot2_f32_bf16 v40, v106, s56, v40
    v_dot2_f32_bf16 v41, v106, v106, v41
    v_dot2_f32_bf16 v40, v107, s56, v40
    v_dot2_f32_bf16 v41, v107, v107, v41
    v_dot2_f32_bf16 v40, v114, s56, v40
    v_dot2_f32_bf16 v41, v114, v114, v41
    v_dot2_f32_bf16 v40, v115, s56, v40
    v_dot2_f32_bf16 v41, v115, v115, v41
    v_permlane32_swap_b32 v34, v35
    v_permlane32_swap_b32 v36, v37
    v_permlane32_swap_b32 v38, v39
    v_permlane32_swap_b32 v40, v41
    v_add_f32 v34, v34, v35
    v_add_f32 v36, v36, v37
    v_add_f32 v38, v38, v39
    v_add_f32 v40, v40, v41
    v_permlane16_swap_b32 v34, v36
    s_nop 0
    v_permlane16_swap_b32 v38, v40
    v_add_f32 v34, v34, v36
    v_add_f32 v35, v38, v40
    v_and_b32 v10, 15, v1
    v_bfe_u32 v11, v1, 4, 1
    v_lshl_add_u32 v10, v11, 4, v10
    v_lshrrev_b32 v11, 5, v1
    v_lshl_add_u32 v10, v11, 6, v10
    v_lshlrev_b32 v10, 2, v10
    s_lshl_b32 s39, s30, 9
    s_add_u32 s39, s39, 60544
    v_add_u32 v10, s39, v10
    ds_write_b32 v10, v34
    ds_write_b32 v10, v35 offset:128
    s_waitcnt lgkmcnt(0)
    s_barrier
    v_and_b32 v10, 15, v1
    s_lshl_b32 s39, s30, 4
    v_add_u32 v10, s39, v10
    v_lshlrev_b32 v10, 2, v10
    v_bfe_u32 v11, v1, 4, 2
    v_lshl_add_u32 v10, v11, 9, v10
    s_mov_b32 s39, 60544
    v_add_u32 v10, s39, v10
    ds_read_b32 v34, v10
    ds_read_b32 v35, v10 offset:256
    s_waitcnt lgkmcnt(0)
    v_permlane32_swap_b32 v34, v35
    v_add_f32 v34, v34, v35
    v_mov_b32 v35, v34
    s_nop 1
    v_permlane16_swap_b32 v34, v35
    v_add_f32 v34, v34, v35
    v_mov_b32 v35, v34
    s_nop 1
    v_permlane32_swap_b32 v34, v35
    v_mov_b32 v36, v4
    v_mov_b32 v37, v5
    v_and_b32 v10, 15, v1
    v_lshlrev_b32 v10, 4, v10
    s_lshl_b32 s39, s30, 8
    v_add_u32 v10, s39, v10
    s_lshl_b32 s8, s35, 13
    s_add_u32 s8, s8, 720896
    s_lshl_b32 s39, s36, 10
    s_add_u32 s39, s39, s8
    s_mov_b32 s44, 0xffff
    s_mov_b32 s45, 0
    s_mov_b64 exec, s[44:45]
    buffer_store_dwordx4 v[34:37], v10, s[4:7], s39 offen sc1
    s_mov_b64 exec, -1
    v_and_b32 v16, 15, v1
    v_min_u32 v16, 2, v16
    v_mul_u32_u24 v17, 896, v16
    v_lshrrev_b32 v16, 4, v1
    v_lshl_add_u32 v17, v16, 4, v17
    s_mov_b32 s39, 57344
    v_add_u32 v17, s39, v17
    ds_read_b128 v[60:63], v17 offset:0
    ds_read_b128 v[64:67], v17 offset:64
    ds_read_b128 v[116:119], v17 offset:128
    s_waitcnt lgkmcnt(2)
    v_mfma_f32_16x16x32_bf16 v[52:55], a[112:115], v[60:63], 0
    v_mfma_f32_16x16x32_bf16 v[56:59], a[168:171], v[60:63], 0
    ds_read_b128 v[60:63], v17 offset:192
    s_waitcnt lgkmcnt(2)
    v_mfma_f32_16x16x32_bf16 v[52:55], a[116:119], v[64:67], v[52:55]
    v_mfma_f32_16x16x32_bf16 v[56:59], a[172:175], v[64:67], v[56:59]
    ds_read_b128 v[64:67], v17 offset:256
    s_waitcnt lgkmcnt(2)
    v_mfma_f32_16x16x32_bf16 v[52:55], a[120:123], v[116:119], v[52:55]
    v_mfma_f32_16x16x32_bf16 v[56:59], a[176:179], v[116:119], v[56:59]
    ds_read_b128 v[116:119], v17 offset:320
    s_waitcnt lgkmcnt(2)
    v_mfma_f32_16x16x32_bf16 v[52:55], a[124:127], v[60:63], v[52:55]
    v_mfma_f32_16x16x32_bf16 v[56:59], a[180:183], v[60:63], v[56:59]
    ds_read_b128 v[60:63], v17 offset:384
    s_waitcnt lgkmcnt(2)
    v_mfma_f32_16x16x32_bf16 v[52:55], a[128:131], v[64:67], v[52:55]
    v_mfma_f32_16x16x32_bf16 v[56:59], a[184:187], v[64:67], v[56:59]
    ds_read_b128 v[64:67], v17 offset:448
    s_waitcnt lgkmcnt(2)
    v_mfma_f32_16x16x32_bf16 v[52:55], a[132:135], v[116:119], v[52:55]
    v_mfma_f32_16x16x32_bf16 v[56:59], a[188:191], v[116:119], v[56:59]
    ds_read_b128 v[116:119], v17 offset:512
    s_waitcnt vmcnt(32) lgkmcnt(2)
    v_mfma_f32_16x16x32_bf16 v[52:55], a[136:139], v[60:63], v[52:55]
    s_waitcnt vmcnt(31)
    v_mfma_f32_16x16x32_bf16 v[56:59], a[192:195], v[60:63], v[56:59]
    ds_read_b128 v[60:63], v17 offset:576
    s_waitcnt vmcnt(30) lgkmcnt(2)
    v_mfma_f32_16x16x32_bf16 v[52:55], a[140:143], v[64:67], v[52:55]
    s_waitcnt vmcnt(29)
    v_mfma_f32_16x16x32_bf16 v[56:59], a[196:199], v[64:67], v[56:59]
    ds_read_b128 v[64:67], v17 offset:640
    s_waitcnt vmcnt(28) lgkmcnt(2)
    v_mfma_f32_16x16x32_bf16 v[52:55], a[144:147], v[116:119], v[52:55]
    s_waitcnt vmcnt(27)
    v_mfma_f32_16x16x32_bf16 v[56:59], a[200:203], v[116:119], v[56:59]
    ds_read_b128 v[116:119], v17 offset:704
    s_waitcnt vmcnt(26) lgkmcnt(2)
    v_mfma_f32_16x16x32_bf16 v[52:55], a[148:151], v[60:63], v[52:55]
    s_waitcnt vmcnt(25)
    v_mfma_f32_16x16x32_bf16 v[56:59], a[204:207], v[60:63], v[56:59]
    ds_read_b128 v[60:63], v17 offset:768
    s_waitcnt vmcnt(24) lgkmcnt(2)
    v_mfma_f32_16x16x32_bf16 v[52:55], a[152:155], v[64:67], v[52:55]
    s_waitcnt vmcnt(23)
    v_mfma_f32_16x16x32_bf16 v[56:59], a[208:211], v[64:67], v[56:59]
    ds_read_b128 v[64:67], v17 offset:832
    s_waitcnt vmcnt(22) lgkmcnt(2)
    v_mfma_f32_16x16x32_bf16 v[52:55], a[156:159], v[116:119], v[52:55]
    s_waitcnt vmcnt(21)
    v_mfma_f32_16x16x32_bf16 v[56:59], a[212:215], v[116:119], v[56:59]
    s_waitcnt vmcnt(20) lgkmcnt(1)
    v_mfma_f32_16x16x32_bf16 v[52:55], a[160:163], v[60:63], v[52:55]
    s_waitcnt vmcnt(19)
    v_mfma_f32_16x16x32_bf16 v[56:59], a[216:219], v[60:63], v[56:59]
    s_waitcnt vmcnt(18) lgkmcnt(0)
    v_mfma_f32_16x16x32_bf16 v[52:55], a[164:167], v[64:67], v[52:55]
    s_waitcnt vmcnt(17)
    v_mfma_f32_16x16x32_bf16 v[56:59], a[220:223], v[64:67], v[56:59]
    s_nop 5
    v_mov_b32_dpp v120, v52 row_newbcast:0 row_mask:0xf bank_mask:0xf
    v_mov_b32_dpp v128, v52 row_newbcast:1 row_mask:0xf bank_mask:0xf
    v_mov_b32_dpp v121, v53 row_newbcast:0 row_mask:0xf bank_mask:0xf
    v_mov_b32_dpp v129, v53 row_newbcast:1 row_mask:0xf bank_mask:0xf
    v_mov_b32_dpp v122, v54 row_newbcast:0 row_mask:0xf bank_mask:0xf
    v_mov_b32_dpp v130, v54 row_newbcast:1 row_mask:0xf bank_mask:0xf
    v_mov_b32_dpp v123, v55 row_newbcast:0 row_mask:0xf bank_mask:0xf
    v_mov_b32_dpp v131, v55 row_newbcast:1 row_mask:0xf bank_mask:0xf
    v_mov_b32_dpp v124, v56 row_newbcast:0 row_mask:0xf bank_mask:0xf
    v_mov_b32_dpp v132, v56 row_newbcast:1 row_mask:0xf bank_mask:0xf
    v_mov_b32_dpp v125, v57 row_newbcast:0 row_mask:0xf bank_mask:0xf
    v_mov_b32_dpp v133, v57 row_newbcast:1 row_mask:0xf bank_mask:0xf
    v_mov_b32_dpp v126, v58 row_newbcast:0 row_mask:0xf bank_mask:0xf
    v_mov_b32_dpp v134, v58 row_newbcast:1 row_mask:0xf bank_mask:0xf
    v_mov_b32_dpp v127, v59 row_newbcast:0 row_mask:0xf bank_mask:0xf
    v_mov_b32_dpp v135, v59 row_newbcast:1 row_mask:0xf bank_mask:0xf
    s_waitcnt vmcnt(1)
    ds_read_b128 a[0:3], v20 offset:0
    ds_read_b128 a[4:7], v20 offset:2048
    ds_read_b128 a[8:11], v20 offset:4096
    ds_read_b128 a[12:15], v20 offset:6144
    ds_read_b128 a[16:19], v21 offset:0
    ds_read_b128 a[20:23], v21 offset:2048
    ds_read_b128 a[24:27], v21 offset:4096
    ds_read_b128 a[28:31], v21 offset:6144
    ds_read_b128 a[32:35], v20 offset:8192
    ds_read_b128 a[36:39], v20 offset:10240
    ds_read_b128 a[40:43], v20 offset:12288
    ds_read_b128 a[44:47], v20 offset:14336
    ds_read_b128 a[48:51], v21 offset:8192
    ds_read_b128 a[52:55], v21 offset:10240
    ds_read_b128 a[56:59], v21 offset:12288
    ds_read_b128 a[60:63], v21 offset:14336
    s_waitcnt lgkmcnt(0)
    s_min_u32 s9, s57, 13
    s_mul_i32 s9, s9, 57344
    s_add_u32 s9, s9, 17825792
    s_cmp_lt_u32 s57, 14
    s_cselect_b32 s9, s9, 2130706432
    ds_read_b128 v[52:55], v3 offset:0
    ds_read_b128 v[56:59], v3 offset:14336
    ds_read_b128 v[60:63], v3 offset:28672
    ds_read_b128 v[64:67], v3 offset:43008
    s_waitcnt lgkmcnt(3)
    v_mfma_f32_16x16x32_bf16 v[136:139], a[112:115], v[52:55], 0
    ds_read_b128 v[168:171], v3 offset:1024
    v_mfma_f32_16x16x32_bf16 v[152:155], a[168:171], v[52:55], 0
    ds_read_b128 v[172:175], v3 offset:15360
    s_waitcnt lgkmcnt(4)
    v_mfma_f32_16x16x32_bf16 v[140:143], a[112:115], v[56:59], 0
    ds_read_b128 v[176:179], v3 offset:29696
    v_mfma_f32_16x16x32_bf16 v[156:159], a[168:171], v[56:59], 0
    ds_read_b128 v[180:183], v3 offset:44032
    s_waitcnt lgkmcnt(5)
    v_mfma_f32_16x16x32_bf16 v[144:147], a[112:115], v[60:63], 0
    s_add_u32 s39, s10, 896
    s_add_u32 m0, s18, 98304
    s_nop 0
    buffer_load_dwordx4 v18, s[12:15], s39 offen lds
    v_mfma_f32_16x16x32_bf16 v[160:163], a[168:171], v[60:63], 0
    s_waitcnt lgkmcnt(4)
    v_mfma_f32_16x16x32_bf16 v[148:151], a[112:115], v[64:67], 0
    v_mfma_f32_16x16x32_bf16 v[164:167], a[168:171], v[64:67], 0
    s_waitcnt lgkmcnt(3)
    v_mfma_f32_16x16x32_bf16 v[136:139], a[116:119], v[168:171], v[136:139]
    ds_read_b128 v[52:55], v3 offset:2048
    v_mfma_f32_16x16x32_bf16 v[152:155], a[172:175], v[168:171], v[152:155]
    ds_read_b128 v[56:59], v3 offset:16384
    s_waitcnt lgkmcnt(4)
    v_mfma_f32_16x16x32_bf16 v[140:143], a[116:119], v[172:175], v[140:143]
    ds_read_b128 v[60:63], v3 offset:30720
    v_mfma_f32_16x16x32_bf16 v[156:159], a[172:175], v[172:175], v[156:159]
    ds_read_b128 v[64:67], v3 offset:45056
    s_waitcnt lgkmcnt(5)
    v_mfma_f32_16x16x32_bf16 v[144:147], a[116:119], v[176:179], v[144:147]
    s_add_u32 s39, s10, 33664
    s_add_u32 m0, s18, 99328
    s_nop 0
    buffer_load_dwordx4 v19, s[12:15], s39 offen lds
    v_mfma_f32_16x16x32_bf16 v[160:163], a[172:175], v[176:179], v[160:163]
    s_waitcnt lgkmcnt(4)
    v_mfma_f32_16x16x32_bf16 v[148:151], a[116:119], v[180:183], v[148:151]
    v_mfma_f32_16x16x32_bf16 v[164:167], a[172:175], v[180:183], v[164:167]
    s_waitcnt lgkmcnt(3)
    v_mfma_f32_16x16x32_bf16 v[136:139], a[120:123], v[52:55], v[136:139]
    ds_read_b128 v[168:171], v3 offset:3072
    v_mfma_f32_16x16x32_bf16 v[152:155], a[176:179], v[52:55], v[152:155]
    ds_read_b128 v[172:175], v3 offset:17408
    s_waitcnt lgkmcnt(4)
    v_mfma_f32_16x16x32_bf16 v[140:143], a[120:123], v[56:59], v[140:143]
    ds_read_b128 v[176:179], v3 offset:31744
    v_mfma_f32_16x16x32_bf16 v[156:159], a[176:179], v[56:59], v[156:159]
    ds_read_b128 v[180:183], v3 offset:46080
    s_waitcnt lgkmcnt(5)
    v_mfma_f32_16x16x32_bf16 v[144:147], a[120:123], v[60:63], v[144:147]
    s_add_u32 s39, s11, 896
    s_add_u32 m0, s18, 100352
    s_nop 0
    buffer_load_dwordx4 v18, s[12:15], s39 offen lds
    v_mfma_f32_16x16x32_bf16 v[160:163], a[176:179], v[60:63], v[160:163]
    s_add_u32 s39, s11, 33664
    s_add_u32 m0, s18, 101376
    s_nop 0
    buffer_load_dwordx4 v19, s[12:15], s39 offen lds
    s_waitcnt lgkmcnt(4)
    v_mfma_f32_16x16x32_bf16 v[148:151], a[120:123], v[64:67], v[148:151]
    v_mfma_f32_16x16x32_bf16 v[164:167], a[176:179], v[64:67], v[164:167]
    s_waitcnt lgkmcnt(3)
    v_mfma_f32_16x16x32_bf16 v[136:139], a[124:127], v[168:171], v[136:139]
    ds_read_b128 v[52:55], v3 offset:4096
    v_mfma_f32_16x16x32_bf16 v[152:155], a[180:183], v[168:171], v[152:155]
    ds_read_b128 v[56:59], v3 offset:18432
    s_waitcnt lgkmcnt(4)
    v_mfma_f32_16x16x32_bf16 v[140:143], a[124:127], v[172:175], v[140:143]
    ds_read_b128 v[60:63], v3 offset:32768
    v_mfma_f32_16x16x32_bf16 v[156:159], a[180:183], v[172:175], v[156:159]
    ds_read_b128 v[64:67], v3 offset:47104
    s_waitcnt lgkmcnt(5)
    v_mfma_f32_16x16x32_bf16 v[144:147], a[124:127], v[176:179], v[144:147]
    s_add_u32 s39, s16, 896
    s_add_u32 m0, s18, 102400
    s_nop 0
    buffer_load_dwordx4 v18, s[12:15], s39 offen lds
    v_mfma_f32_16x16x32_bf16 v[160:163], a[180:183], v[176:179], v[160:163]
    s_waitcnt lgkmcnt(4)
    v_mfma_f32_16x16x32_bf16 v[148:151], a[124:127], v[180:183], v[148:151]
    v_mfma_f32_16x16x32_bf16 v[164:167], a[180:183], v[180:183], v[164:167]
    s_waitcnt lgkmcnt(3)
    v_mfma_f32_16x16x32_bf16 v[136:139], a[128:131], v[52:55], v[136:139]
    ds_read_b128 v[168:171], v3 offset:5120
    v_mfma_f32_16x16x32_bf16 v[152:155], a[184:187], v[52:55], v[152:155]
    ds_read_b128 v[172:175], v3 offset:19456
    s_waitcnt lgkmcnt(4)
    v_mfma_f32_16x16x32_bf16 v[140:143], a[128:131], v[56:59], v[140:143]
    ds_read_b128 v[176:179], v3 offset:33792
    v_mfma_f32_16x16x32_bf16 v[156:159], a[184:187], v[56:59], v[156:159]
    ds_read_b128 v[180:183], v3 offset:48128
    s_waitcnt lgkmcnt(5)
    v_mfma_f32_16x16x32_bf16 v[144:147], a[128:131], v[60:63], v[144:147]
    s_add_u32 s39, s16, 33664
    s_add_u32 m0, s18, 103424
    s_nop 0
    buffer_load_dwordx4 v19, s[12:15], s39 offen lds
    v_mfma_f32_16x16x32_bf16 v[160:163], a[184:187], v[60:63], v[160:163]
    s_add_u32 s39, s17, 896
    s_add_u32 m0, s18, 104448
    s_nop 0
    buffer_load_dwordx4 v18, s[12:15], s39 offen lds
    s_waitcnt lgkmcnt(4)
    v_mfma_f32_16x16x32_bf16 v[148:151], a[128:131], v[64:67], v[148:151]
    v_mfma_f32_16x16x32_bf16 v[164:167], a[184:187], v[64:67], v[164:167]
    s_waitcnt lgkmcnt(3)
    v_mfma_f32_16x16x32_bf16 v[136:139], a[132:135], v[168:171], v[136:139]
    ds_read_b128 v[52:55], v3 offset:6144
    v_mfma_f32_16x16x32_bf16 v[152:155], a[188:191], v[168:171], v[152:155]
    ds_read_b128 v[56:59], v3 offset:20480
    s_waitcnt lgkmcnt(4)
    v_mfma_f32_16x16x32_bf16 v[140:143], a[132:135], v[172:175], v[140:143]
    ds_read_b128 v[60:63], v3 offset:34816
    v_mfma_f32_16x16x32_bf16 v[156:159], a[188:191], v[172:175], v[156:159]
    ds_read_b128 v[64:67], v3 offset:49152
    s_waitcnt lgkmcnt(5)
    v_mfma_f32_16x16x32_bf16 v[144:147], a[132:135], v[176:179], v[144:147]
    s_add_u32 s39, s17, 33664
    s_add_u32 m0, s18, 105472
    s_nop 0
    buffer_load_dwordx4 v19, s[12:15], s39 offen lds
    v_mfma_f32_16x16x32_bf16 v[160:163], a[188:191], v[176:179], v[160:163]
    s_waitcnt lgkmcnt(4)
    v_mfma_f32_16x16x32_bf16 v[148:151], a[132:135], v[180:183], v[148:151]
    v_mfma_f32_16x16x32_bf16 v[164:167], a[188:191], v[180:183], v[164:167]
    s_waitcnt lgkmcnt(3)
    v_mfma_f32_16x16x32_bf16 v[136:139], a[136:139], v[52:55], v[136:139]
    ds_read_b128 v[168:171], v3 offset:7168
    v_mfma_f32_16x16x32_bf16 v[152:155], a[192:195], v[52:55], v[152:155]
    ds_read_b128 v[172:175], v3 offset:21504
    s_waitcnt lgkmcnt(4)
    v_mfma_f32_16x16x32_bf16 v[140:143], a[136:139], v[56:59], v[140:143]
    ds_read_b128 v[176:179], v3 offset:35840
    v_mfma_f32_16x16x32_bf16 v[156:159], a[192:195], v[56:59], v[156:159]
    ds_read_b128 v[180:183], v3 offset:50176
    s_waitcnt lgkmcnt(5)
    v_mfma_f32_16x16x32_bf16 v[144:147], a[136:139], v[60:63], v[144:147]
    s_add_u32 s39, s10, 128
    s_add_u32 m0, s18, 106496
    s_nop 0
    buffer_load_dwordx4 v18, s[12:15], s39 offen lds
    v_mfma_f32_16x16x32_bf16 v[160:163], a[192:195], v[60:63], v[160:163]
    s_add_u32 s39, s10, 32896
    s_add_u32 m0, s18, 107520
    s_nop 0
    buffer_load_dwordx4 v19, s[12:15], s39 offen lds
    s_waitcnt lgkmcnt(4)
    v_mfma_f32_16x16x32_bf16 v[148:151], a[136:139], v[64:67], v[148:151]
    v_mfma_f32_16x16x32_bf16 v[164:167], a[192:195], v[64:67], v[164:167]
    s_waitcnt lgkmcnt(3)
    v_mfma_f32_16x16x32_bf16 v[136:139], a[140:143], v[168:171], v[136:139]
    ds_read_b128 v[52:55], v3 offset:8192
    v_mfma_f32_16x16x32_bf16 v[152:155], a[196:199], v[168:171], v[152:155]
    ds_read_b128 v[56:59], v3 offset:22528
    s_waitcnt lgkmcnt(4)
    v_mfma_f32_16x16x32_bf16 v[140:143], a[140:143], v[172:175], v[140:143]
    ds_read_b128 v[60:63], v3 offset:36864
    v_mfma_f32_16x16x32_bf16 v[156:159], a[196:199], v[172:175], v[156:159]
    ds_read_b128 v[64:67], v3 offset:51200
    s_waitcnt lgkmcnt(5)
    v_mfma_f32_16x16x32_bf16 v[144:147], a[140:143], v[176:179], v[144:147]
    s_add_u32 s39, s11, 128
    s_add_u32 m0, s18, 108544
    s_nop 0
    buffer_load_dwordx4 v18, s[12:15], s39 offen lds
    v_mfma_f32_16x16x32_bf16 v[160:163], a[196:199], v[176:179], v[160:163]
    s_waitcnt lgkmcnt(4)
    v_mfma_f32_16x16x32_bf16 v[148:151], a[140:143], v[180:183], v[148:151]
    v_mfma_f32_16x16x32_bf16 v[164:167], a[196:199], v[180:183], v[164:167]
    s_waitcnt lgkmcnt(3)
    v_mfma_f32_16x16x32_bf16 v[136:139], a[144:147], v[52:55], v[136:139]
    ds_read_b128 v[168:171], v3 offset:9216
    v_mfma_f32_16x16x32_bf16 v[152:155], a[200:203], v[52:55], v[152:155]
    ds_read_b128 v[172:175], v3 offset:23552
    s_waitcnt lgkmcnt(4)
    v_mfma_f32_16x16x32_bf16 v[140:143], a[144:147], v[56:59], v[140:143]
    ds_read_b128 v[176:179], v3 offset:37888
    v_mfma_f32_16x16x32_bf16 v[156:159], a[200:203], v[56:59], v[156:159]
    ds_read_b128 v[180:183], v3 offset:52224
    s_waitcnt lgkmcnt(5)
    v_mfma_f32_16x16x32_bf16 v[144:147], a[144:147], v[60:63], v[144:147]
    s_add_u32 s39, s11, 32896
    s_add_u32 m0, s18, 109568
    s_nop 0
    buffer_load_dwordx4 v19, s[12:15], s39 offen lds
    v_mfma_f32_16x16x32_bf16 v[160:163], a[200:203], v[60:63], v[160:163]
    s_waitcnt lgkmcnt(4)
    v_mfma_f32_16x16x32_bf16 v[148:151], a[144:147], v[64:67], v[148:151]
    v_mfma_f32_16x16x32_bf16 v[164:167], a[200:203], v[64:67], v[164:167]
    s_waitcnt lgkmcnt(3)
    v_mfma_f32_16x16x32_bf16 v[136:139], a[148:151], v[168:171], v[136:139]
    ds_read_b128 v[52:55], v3 offset:10240
    v_mfma_f32_16x16x32_bf16 v[152:155], a[204:207], v[168:171], v[152:155]
    ds_read_b128 v[56:59], v3 offset:24576
    s_waitcnt lgkmcnt(4)
    v_mfma_f32_16x16x32_bf16 v[140:143], a[148:151], v[172:175], v[140:143]
    ds_read_b128 v[60:63], v3 offset:38912
    v_mfma_f32_16x16x32_bf16 v[156:159], a[204:207], v[172:175], v[156:159]
    ds_read_b128 v[64:67], v3 offset:53248
    s_waitcnt lgkmcnt(5)
    v_mfma_f32_16x16x32_bf16 v[144:147], a[148:151], v[176:179], v[144:147]
    s_add_u32 s39, s16, 128
    s_add_u32 m0, s18, 110592
    s_nop 0
    buffer_load_dwordx4 v18, s[12:15], s39 offen lds
    v_mfma_f32_16x16x32_bf16 v[160:163], a[204:207], v[176:179], v[160:163]
    s_add_u32 s39, s16, 32896
    s_add_u32 m0, s18, 111616
    s_nop 0
    buffer_load_dwordx4 v19, s[12:15], s39 offen lds
    s_waitcnt lgkmcnt(4)
    v_mfma_f32_16x16x32_bf16 v[148:151], a[148:151], v[180:183], v[148:151]
    v_mfma_f32_16x16x32_bf16 v[164:167], a[204:207], v[180:183], v[164:167]
    s_waitcnt lgkmcnt(3)
    v_mfma_f32_16x16x32_bf16 v[136:139], a[152:155], v[52:55], v[136:139]
    ds_read_b128 v[168:171], v3 offset:11264
    v_mfma_f32_16x16x32_bf16 v[152:155], a[208:211], v[52:55], v[152:155]
    ds_read_b128 v[172:175], v3 offset:25600
    s_waitcnt lgkmcnt(4)
    v_mfma_f32_16x16x32_bf16 v[140:143], a[152:155], v[56:59], v[140:143]
    ds_read_b128 v[176:179], v3 offset:39936
    v_mfma_f32_16x16x32_bf16 v[156:159], a[208:211], v[56:59], v[156:159]
    ds_read_b128 v[180:183], v3 offset:54272
    s_waitcnt lgkmcnt(5)
    v_mfma_f32_16x16x32_bf16 v[144:147], a[152:155], v[60:63], v[144:147]
    s_add_u32 s39, s17, 128
    s_add_u32 m0, s18, 112640
    s_nop 0
    buffer_load_dwordx4 v18, s[12:15], s39 offen lds
    v_mfma_f32_16x16x32_bf16 v[160:163], a[208:211], v[60:63], v[160:163]
    s_waitcnt lgkmcnt(4)
    v_mfma_f32_16x16x32_bf16 v[148:151], a[152:155], v[64:67], v[148:151]
    v_mfma_f32_16x16x32_bf16 v[164:167], a[208:211], v[64:67], v[164:167]
    s_waitcnt lgkmcnt(3)
    v_mfma_f32_16x16x32_bf16 v[136:139], a[156:159], v[168:171], v[136:139]
    ds_read_b128 v[52:55], v3 offset:12288
    v_mfma_f32_16x16x32_bf16 v[152:155], a[212:215], v[168:171], v[152:155]
    ds_read_b128 v[56:59], v3 offset:26624
    s_waitcnt lgkmcnt(4)
    v_mfma_f32_16x16x32_bf16 v[140:143], a[156:159], v[172:175], v[140:143]
    ds_read_b128 v[60:63], v3 offset:40960
    v_mfma_f32_16x16x32_bf16 v[156:159], a[212:215], v[172:175], v[156:159]
    ds_read_b128 v[64:67], v3 offset:55296
    s_waitcnt lgkmcnt(5)
    v_mfma_f32_16x16x32_bf16 v[144:147], a[156:159], v[176:179], v[144:147]
    s_add_u32 s39, s17, 32896
    s_add_u32 m0, s18, 113664
    s_nop 0
    buffer_load_dwordx4 v19, s[12:15], s39 offen lds
    v_mfma_f32_16x16x32_bf16 v[160:163], a[212:215], v[176:179], v[160:163]
    buffer_load_dwordx4 a[96:99], v3, s[4:7], s9 offen offset:0 sc1
    s_waitcnt lgkmcnt(4)
    v_mfma_f32_16x16x32_bf16 v[148:151], a[156:159], v[180:183], v[148:151]
    v_mfma_f32_16x16x32_bf16 v[164:167], a[212:215], v[180:183], v[164:167]
    s_waitcnt lgkmcnt(3)
    v_mfma_f32_16x16x32_bf16 v[136:139], a[160:163], v[52:55], v[136:139]
    ds_read_b128 v[168:171], v3 offset:13312
    v_mfma_f32_16x16x32_bf16 v[152:155], a[216:219], v[52:55], v[152:155]
    ds_read_b128 v[172:175], v3 offset:27648
    s_waitcnt lgkmcnt(4)
    v_mfma_f32_16x16x32_bf16 v[140:143], a[160:163], v[56:59], v[140:143]
    ds_read_b128 v[176:179], v3 offset:41984
    v_mfma_f32_16x16x32_bf16 v[156:159], a[216:219], v[56:59], v[156:159]
    ds_read_b128 v[180:183], v3 offset:56320
    s_waitcnt lgkmcnt(5)
    v_mfma_f32_16x16x32_bf16 v[144:147], a[160:163], v[60:63], v[144:147]
    buffer_load_dwordx4 a[100:103], v3, s[4:7], s9 offen offset:1024 sc1
    v_mfma_f32_16x16x32_bf16 v[160:163], a[216:219], v[60:63], v[160:163]
    s_waitcnt lgkmcnt(4)
    v_mfma_f32_16x16x32_bf16 v[148:151], a[160:163], v[64:67], v[148:151]
    v_mfma_f32_16x16x32_bf16 v[164:167], a[216:219], v[64:67], v[164:167]
    s_waitcnt lgkmcnt(3)
    v_mfma_f32_16x16x32_bf16 v[136:139], a[164:167], v[168:171], v[136:139]
    buffer_load_dwordx4 a[104:107], v3, s[4:7], s9 offen offset:2048 sc1
    v_mfma_f32_16x16x32_bf16 v[152:155], a[220:223], v[168:171], v[152:155]
    buffer_load_dwordx4 a[108:111], v3, s[4:7], s9 offen offset:3072 sc1
    s_waitcnt lgkmcnt(2)
    v_mfma_f32_16x16x32_bf16 v[140:143], a[164:167], v[172:175], v[140:143]
    v_mfma_f32_16x16x32_bf16 v[156:159], a[220:223], v[172:175], v[156:159]
    s_waitcnt lgkmcnt(1)
    v_mfma_f32_16x16x32_bf16 v[144:147], a[164:167], v[176:179], v[144:147]
    v_mfma_f32_16x16x32_bf16 v[160:163], a[220:223], v[176:179], v[160:163]
    s_waitcnt lgkmcnt(0)
    v_mfma_f32_16x16x32_bf16 v[148:151], a[164:167], v[180:183], v[148:151]
    v_mfma_f32_16x16x32_bf16 v[164:167], a[220:223], v[180:183], v[164:167]
    s_waitcnt vmcnt(12)
    ds_read_b128 a[64:67], v20 offset:0
    ds_read_b128 a[68:71], v20 offset:2048
    ds_read_b128 a[72:75], v20 offset:4096
    ds_read_b128 a[76:79], v20 offset:6144
    ds_read_b128 a[80:83], v21 offset:0
    ds_read_b128 a[84:87], v21 offset:2048
    ds_read_b128 a[88:91], v21 offset:4096
    ds_read_b128 a[92:95], v21 offset:6144
    s_waitcnt lgkmcnt(0)
    s_min_u32 s9, s57, 13
    s_mul_i32 s9, s9, 57344
    s_add_u32 s9, s9, 17829888
    s_cmp_lt_u32 s57, 14
    s_cselect_b32 s9, s9, 2130706432
    v_lshrrev_b32 v11, 4, v1
    v_lshl_add_u32 v10, v11, 10, v10
    s_mov_b32 s43, 400000
    s_add_u32 s41, s8, 4096
    s_nop 0
L_sp_31:
    buffer_load_dwordx4 v[52:55], v10, s[4:7], s8 offen sc1
    buffer_load_dwordx4 v[56:59], v10, s[4:7], s41 offen sc1
    s_waitcnt vmcnt(0)
    v_cmp_eq_u32 vcc, s37, v54
    v_cmp_eq_u32 s[44:45], s38, v55
    v_cmp_eq_u32 s[20:21], s37, v58
    s_nop 2
    s_and_b64 vcc, vcc, s[44:45]
    v_cmp_eq_u32 s[44:45], s38, v59
    s_and_b64 vcc, vcc, s[20:21]
    s_nop 2
    s_and_b64 vcc, vcc, s[44:45]
    s_cmp_eq_u64 vcc, -1
    s_nop 0
    s_cbranch_scc1 L_spd_32
    s_sub_u32 s43, s43, 1
    s_cmp_lg_u32 s43, 0
    s_nop 0
    s_cbranch_scc1 L_sp_31
    v_mov_b32 v11, 7
    s_mov_b32 s39, 0
    buffer_store_dword v11, v2, s[24:27], s39 offen
    s_nop 1
L_spd_32:
    v_add_f32 v52, v52, v56
    v_add_f32 v53, v53, v57
    s_nop 1
    v_permlane32_swap_b32 v52, v53
    v_add_f32 v52, v52, v53
    v_mov_b32 v53, v52
    s_nop 1
    v_permlane16_swap_b32 v52, v53
    v_add_f32 v52, v52, v53
    v_mov_b32 v53, v52
    s_nop 1
    v_permlane32_swap_b32 v52, v53
    v_mul_f32 v52, 0x3a924925, v52
    v_mul_f32 v53, 0x3a924925, v53
    v_fma_f32 v11, -v52, v52, v53
    v_max_f32 v11, 0, v11
    v_add_f32 v53, 0x3727c5ac, v11
    v_rsq_f32 v54, v53
    s_nop 0
    v_mul_f32 v55, v52, v54
    v_sub_f32 v55, 0, v55
    s_lshl_b32 s39, s30, 7
    s_add_u32 s39, s39, 62592
    v_add_u32 v10, s39, v8
    ds_write_b64 v10, v[54:55]
    s_waitcnt lgkmcnt(0)
    s_barrier
    s_mov_b32 s39, 62592
    v_add_u32 v10, s39, v8
    ds_read_b64 v[34:35], v10 offset:0
    ds_read_b64 v[36:37], v10 offset:128
    ds_read_b64 v[38:39], v10 offset:256
    ds_read_b64 v[40:41], v10 offset:384
    v_lshlrev_b32 v68, 16, v100
    v_and_b32 v69, s46, v100
    s_add_u32 s39, s10, 0
    s_add_u32 m0, s18, 98304
    s_nop 0
    buffer_load_dwordx4 v18, s[12:15], s39 offen lds
    v_lshlrev_b32 v70, 16, v101
    v_and_b32 v71, s46, v101
    v_lshlrev_b32 v72, 16, v102
    v_and_b32 v73, s46, v102
    v_lshlrev_b32 v74, 16, v103
    v_and_b32 v75, s46, v103
    s_add_u32 s39, s10, 32768
    s_add_u32 m0, s18, 99328
    s_nop 0
    buffer_load_dwordx4 v19, s[12:15], s39 offen lds
    v_lshlrev_b32 v76, 16, v104
    v_and_b32 v77, s46, v104
    v_lshlrev_b32 v78, 16, v105
    v_and_b32 v79, s46, v105
    v_lshlrev_b32 v80, 16, v106
    v_and_b32 v81, s46, v106
    s_add_u32 s39, s11, 0
    s_add_u32 m0, s18, 100352
    s_nop 0
    buffer_load_dwordx4 v18, s[12:15], s39 offen lds
    v_lshlrev_b32 v82, 16, v107
    v_and_b32 v83, s46, v107
    v_lshlrev_b32 v84, 16, v108
    v_and_b32 v85, s46, v108
    v_lshlrev_b32 v86, 16, v109
    v_and_b32 v87, s46, v109
    s_add_u32 s39, s11, 32768
    s_add_u32 m0, s18, 101376
    s_nop 0
    buffer_load_dwordx4 v19, s[12:15], s39 offen lds
    v_lshlrev_b32 v88, 16, v110
    v_and_b32 v89, s46, v110
    v_lshlrev_b32 v90, 16, v111
    v_and_b32 v91, s46, v111
    v_lshlrev_b32 v92, 16, v112
    v_and_b32 v93, s46, v112
    s_add_u32 s39, s16, 0
    s_add_u32 m0, s18, 102400
    s_nop 0
    buffer_load_dwordx4 v18, s[12:15], s39 offen lds
    v_lshlrev_b32 v94, 16, v113
    v_and_b32 v95, s46, v113
    v_lshlrev_b32 v96, 16, v114
    v_and_b32 v97, s46, v114
    v_lshlrev_b32 v98, 16, v115
    v_and_b32 v99, s46, v115
    s_add_u32 s39, s16, 32768
    s_add_u32 m0, s18, 103424
    s_nop 0
    buffer_load_dwordx4 v19, s[12:15], s39 offen lds
    s_waitcnt lgkmcnt(3)
    v_pk_fma_f32 v[68:69], v[68:69], v[34:35], v[34:35] op_sel:[0,0,1] op_sel_hi:[1,0,1]
    v_pk_fma_f32 v[70:71], v[70:71], v[34:35], v[34:35] op_sel:[0,0,1] op_sel_hi:[1,0,1]
    s_waitcnt lgkmcnt(2)
    v_pk_fma_f32 v[72:73], v[72:73], v[36:37], v[36:37] op_sel:[0,0,1] op_sel_hi:[1,0,1]
    v_pk_fma_f32 v[74:75], v[74:75], v[36:37], v[36:37] op_sel:[0,0,1] op_sel_hi:[1,0,1]
    s_waitcnt lgkmcnt(1)
    v_pk_fma_f32 v[76:77], v[76:77], v[38:39], v[38:39] op_sel:[0,0,1] op_sel_hi:[1,0,1]
    v_pk_fma_f32 v[78:79], v[78:79], v[38:39], v[38:39] op_sel:[0,0,1] op_sel_hi:[1,0,1]
    s_waitcnt lgkmcnt(0)
    v_pk_fma_f32 v[80:81], v[80:81], v[40:41], v[40:41] op_sel:[0,0,1] op_sel_hi:[1,0,1]
    v_pk_fma_f32 v[82:83], v[82:83], v[40:41], v[40:41] op_sel:[0,0,1] op_sel_hi:[1,0,1]
    v_pk_fma_f32 v[84:85], v[84:85], v[34:35], v[34:35] op_sel:[0,0,1] op_sel_hi:[1,0,1]
    v_pk_fma_f32 v[86:87], v[86:87], v[34:35], v[34:35] op_sel:[0,0,1] op_sel_hi:[1,0,1]
    v_pk_fma_f32 v[88:89], v[88:89], v[36:37], v[36:37] op_sel:[0,0,1] op_sel_hi:[1,0,1]
    v_pk_fma_f32 v[90:91], v[90:91], v[36:37], v[36:37] op_sel:[0,0,1] op_sel_hi:[1,0,1]
    v_pk_fma_f32 v[92:93], v[92:93], v[38:39], v[38:39] op_sel:[0,0,1] op_sel_hi:[1,0,1]
    v_pk_fma_f32 v[94:95], v[94:95], v[38:39], v[38:39] op_sel:[0,0,1] op_sel_hi:[1,0,1]
    v_pk_fma_f32 v[96:97], v[96:97], v[40:41], v[40:41] op_sel:[0,0,1] op_sel_hi:[1,0,1]
    v_pk_fma_f32 v[98:99], v[98:99], v[40:41], v[40:41] op_sel:[0,0,1] op_sel_hi:[1,0,1]
    v_cvt_pk_bf16_f32 v100, v68, v69
    s_add_u32 s39, s17, 0
    s_add_u32 m0, s18, 104448
    s_nop 0
    buffer_load_dwordx4 v18, s[12:15], s39 offen lds
    v_cvt_pk_bf16_f32 v101, v70, v71
    v_cvt_pk_bf16_f32 v102, v72, v73
    v_cvt_pk_bf16_f32 v103, v74, v75
    s_add_u32 s39, s17, 32768
    s_add_u32 m0, s18, 105472
    s_nop 0
    buffer_load_dwordx4 v19, s[12:15], s39 offen lds
    v_cvt_pk_bf16_f32 v104, v76, v77
    v_cvt_pk_bf16_f32 v105, v78, v79
    v_cvt_pk_bf16_f32 v106, v80, v81
    buffer_load_dwordx4 a[196:199], v3, s[4:7], s9 offen offset:0 sc1
    v_cvt_pk_bf16_f32 v107, v82, v83
    v_cvt_pk_bf16_f32 v108, v84, v85
    v_cvt_pk_bf16_f32 v109, v86, v87
    buffer_load_dwordx4 a[200:203], v3, s[4:7], s9 offen offset:1024 sc1
    v_cvt_pk_bf16_f32 v110, v88, v89
    v_cvt_pk_bf16_f32 v111, v90, v91
    v_cvt_pk_bf16_f32 v112, v92, v93
    buffer_load_dwordx4 a[204:207], v3, s[4:7], s9 offen offset:2048 sc1
    v_cvt_pk_bf16_f32 v113, v94, v95
    v_cvt_pk_bf16_f32 v114, v96, v97
    v_cvt_pk_bf16_f32 v115, v98, v99
    buffer_load_dwordx4 a[208:211], v3, s[4:7], s9 offen offset:3072 sc1
    v_and_b32 v10, 15, v1
    v_mul_u32_u24 v10, 72, v10
    v_lshrrev_b32 v11, 4, v1
    v_lshl_add_u32 v10, v11, 3, v10
    s_mul_i32 s39, s30, 4608
    s_add_u32 s39, s39, 63104
    v_add_u32 v10, s39, v10
    ds_write_b64 v10, v[100:101] offset:0
    ds_write_b64 v10, v[102:103] offset:1152
    ds_write_b64 v10, v[104:105] offset:2304
    ds_write_b64 v10, v[106:107] offset:3456
    ds_write_b64 v10, v[108:109] offset:32
    ds_write_b64 v10, v[110:111] offset:1184
    ds_write_b64 v10, v[112:113] offset:2336
    ds_write_b64 v10, v[114:115] offset:3488
    v_lshrrev_b32 v11, 4, v1
    v_lshlrev_b32 v11, 3, v11
    v_bfe_u32 v12, v1, 2, 2
    v_add_u32 v11, v11, v12
    v_mul_u32_u24 v11, 72, v11
    v_and_b32 v12, 3, v1
    v_lshl_add_u32 v11, v12, 3, v11
    v_add_u32 v11, s39, v11
    ds_read_b64_tr_b16 v[68:69], v11 offset:0
    ds_read_b64_tr_b16 v[70:71], v11 offset:288
    ds_read_b64_tr_b16 v[72:73], v11 offset:2304
    ds_read_b64_tr_b16 v[74:75], v11 offset:2592
    ds_read_b64_tr_b16 v[76:77], v11 offset:32
    ds_read_b64_tr_b16 v[78:79], v11 offset:320
    ds_read_b64_tr_b16 v[80:81], v11 offset:2336
    ds_read_b64_tr_b16 v[82:83], v11 offset:2624
    s_mul_i32 s39, s36, 448
    s_mul_i32 s40, s35, 14
    s_add_u32 s39, s39, s40
    s_lshl_b32 s40, s30, 1
    s_add_u32 s39, s39, s40
    s_lshl_b32 s39, s39, 10
    s_add_u32 s41, s39, 9437184
    s_add_u32 s40, s41, 0
    s_waitcnt lgkmcnt(6)
    buffer_store_dwordx4 v[68:71], v3, s[4:7], s40 offen sc1
    s_add_u32 s40, s41, 7168
    s_waitcnt lgkmcnt(4)
    buffer_store_dwordx4 v[72:75], v3, s[4:7], s40 offen sc1
    s_add_u32 s40, s41, 1024
    s_cmp_lt_u32 s30, 3
    s_cselect_b32 s40, s40, 2130706432
    s_waitcnt lgkmcnt(2)
    buffer_store_dwordx4 v[76:79], v3, s[4:7], s40 offen sc1
    s_add_u32 s40, s41, 8192
    s_cmp_lt_u32 s30, 3
    s_cselect_b32 s40, s40, 2130706432
    s_waitcnt lgkmcnt(0)
    buffer_store_dwordx4 v[80:83], v3, s[4:7], s40 offen sc1
    s_lshl_b32 s39, s36, 5
    s_add_u32 s39, s39, s35
    s_lshl_b32 s39, s39, 2
    s_add_u32 s39, s39, s30
    s_lshl_b32 s39, s39, 7
    s_add_u32 s8, s39, 458752
    s_waitcnt lgkmcnt(0)
    s_barrier
    v_pk_fma_f32 v[136:137], v[120:121], v[24:25], v[136:137] op_sel:[0,1,0] op_sel_hi:[1,1,1]
    v_pk_fma_f32 v[138:139], v[122:123], v[24:25], v[138:139] op_sel:[0,1,0] op_sel_hi:[1,1,1]
    v_pk_fma_f32 v[140:141], v[120:121], v[26:27], v[140:141] op_sel:[0,1,0] op_sel_hi:[1,1,1]
    v_pk_fma_f32 v[142:143], v[122:123], v[26:27], v[142:143] op_sel:[0,1,0] op_sel_hi:[1,1,1]
    v_pk_fma_f32 v[144:145], v[120:121], v[28:29], v[144:145] op_sel:[0,1,0] op_sel_hi:[1,1,1]
    v_pk_fma_f32 v[146:147], v[122:123], v[28:29], v[146:147] op_sel:[0,1,0] op_sel_hi:[1,1,1]
    v_pk_fma_f32 v[148:149], v[120:121], v[30:31], v[148:149] op_sel:[0,1,0] op_sel_hi:[1,1,1]
    v_pk_fma_f32 v[150:151], v[122:123], v[30:31], v[150:151] op_sel:[0,1,0] op_sel_hi:[1,1,1]
    v_pk_fma_f32 v[152:153], v[124:125], v[24:25], v[152:153] op_sel:[0,1,0] op_sel_hi:[1,1,1]
    v_pk_fma_f32 v[154:155], v[126:127], v[24:25], v[154:155] op_sel:[0,1,0] op_sel_hi:[1,1,1]
    v_pk_fma_f32 v[156:157], v[124:125], v[26:27], v[156:157] op_sel:[0,1,0] op_sel_hi:[1,1,1]
    v_pk_fma_f32 v[158:159], v[126:127], v[26:27], v[158:159] op_sel:[0,1,0] op_sel_hi:[1,1,1]
    v_pk_fma_f32 v[160:161], v[124:125], v[28:29], v[160:161] op_sel:[0,1,0] op_sel_hi:[1,1,1]
    v_pk_fma_f32 v[162:163], v[126:127], v[28:29], v[162:163] op_sel:[0,1,0] op_sel_hi:[1,1,1]
    v_pk_fma_f32 v[164:165], v[124:125], v[30:31], v[164:165] op_sel:[0,1,0] op_sel_hi:[1,1,1]
    v_pk_fma_f32 v[166:167], v[126:127], v[30:31], v[166:167] op_sel:[0,1,0] op_sel_hi:[1,1,1]
    v_pk_fma_f32 v[136:137], v[136:137], v[24:25], v[128:129] op_sel_hi:[1,0,1]
    v_pk_fma_f32 v[138:139], v[138:139], v[24:25], v[130:131] op_sel_hi:[1,0,1]
    v_pk_fma_f32 v[140:141], v[140:141], v[26:27], v[128:129] op_sel_hi:[1,0,1]
    v_pk_fma_f32 v[142:143], v[142:143], v[26:27], v[130:131] op_sel_hi:[1,0,1]
    v_pk_fma_f32 v[144:145], v[144:145], v[28:29], v[128:129] op_sel_hi:[1,0,1]
    v_pk_fma_f32 v[146:147], v[146:147], v[28:29], v[130:131] op_sel_hi:[1,0,1]
    v_pk_fma_f32 v[148:149], v[148:149], v[30:31], v[128:129] op_sel_hi:[1,0,1]
    v_pk_fma_f32 v[150:151], v[150:151], v[30:31], v[130:131] op_sel_hi:[1,0,1]
    v_pk_fma_f32 v[152:153], v[152:153], v[24:25], v[132:133] op_sel_hi:[1,0,1]
    v_pk_fma_f32 v[154:155], v[154:155], v[24:25], v[134:135] op_sel_hi:[1,0,1]
    v_pk_fma_f32 v[156:157], v[156:157], v[26:27], v[132:133] op_sel_hi:[1,0,1]
    v_pk_fma_f32 v[158:159], v[158:159], v[26:27], v[134:135] op_sel_hi:[1,0,1]
    v_pk_fma_f32 v[160:161], v[160:161], v[28:29], v[132:133] op_sel_hi:[1,0,1]
    v_pk_fma_f32 v[162:163], v[162:163], v[28:29], v[134:135] op_sel_hi:[1,0,1]
    v_pk_fma_f32 v[164:165], v[164:165], v[30:31], v[132:133] op_sel_hi:[1,0,1]
    v_pk_fma_f32 v[166:167], v[166:167], v[30:31], v[134:135] op_sel_hi:[1,0,1]
    v_pk_mul_f32 v[168:169], v[136:137], v[136:137]
    v_pk_mul_f32 v[170:171], v[138:139], v[138:139]
    v_pk_mul_f32 v[172:173], v[140:141], v[140:141]
    v_pk_mul_f32 v[174:175], v[142:143], v[142:143]
    v_pk_mul_f32 v[176:177], v[144:145], v[144:145]
    v_pk_mul_f32 v[178:179], v[146:147], v[146:147]
    v_pk_mul_f32 v[180:181], v[148:149], v[148:149]
    v_pk_mul_f32 v[182:183], v[150:151], v[150:151]
    v_pk_mul_f32 v[184:185], v[152:153], v[152:153]
    v_pk_mul_f32 v[186:187], v[154:155], v[154:155]
    v_pk_mul_f32 v[188:189], v[156:157], v[156:157]
    v_pk_mul_f32 v[190:191], v[158:159], v[158:159]
    v_pk_mul_f32 v[192:193], v[160:161], v[160:161]
    v_pk_mul_f32 v[194:195], v[162:163], v[162:163]
    s_add_u32 s9, s9, 4096
    buffer_load_dwordx4 a[212:215], v3, s[4:7], s9 offen offset:0 sc1
    v_pk_mul_f32 v[196:197], v[164:165], v[164:165]
    v_pk_mul_f32 v[198:199], v[166:167], v[166:167]
    v_pk_fma_f32 v[168:169], v[168:169], v[14:15], v[14:15] op_sel:[0,1,0] op_sel_hi:[1,1,0]
    v_pk_fma_f32 v[170:171], v[170:171], v[14:15], v[14:15] op_sel:[0,1,0] op_sel_hi:[1,1,0]
    v_pk_fma_f32 v[172:173], v[172:173], v[14:15], v[14:15] op_sel:[0,1,0] op_sel_hi:[1,1,0]
    v_pk_fma_f32 v[174:175], v[174:175], v[14:15], v[14:15] op_sel:[0,1,0] op_sel_hi:[1,1,0]
    v_pk_fma_f32 v[176:177], v[176:177], v[14:15], v[14:15] op_sel:[0,1,0] op_sel_hi:[1,1,0]
    v_pk_fma_f32 v[178:179], v[178:179], v[14:15], v[14:15] op_sel:[0,1,0] op_sel_hi:[1,1,0]
    v_pk_fma_f32 v[180:181], v[180:181], v[14:15], v[14:15] op_sel:[0,1,0] op_sel_hi:[1,1,0]
    v_pk_fma_f32 v[182:183], v[182:183], v[14:15], v[14:15] op_sel:[0,1,0] op_sel_hi:[1,1,0]
    v_pk_fma_f32 v[184:185], v[184:185], v[14:15], v[14:15] op_sel:[0,1,0] op_sel_hi:[1,1,0]
    v_pk_fma_f32 v[186:187], v[186:187], v[14:15], v[14:15] op_sel:[0,1,0] op_sel_hi:[1,1,0]
    v_pk_fma_f32 v[188:189], v[188:189], v[14:15], v[14:15] op_sel:[0,1,0] op_sel_hi:[1,1,0]
    v_pk_fma_f32 v[190:191], v[190:191], v[14:15], v[14:15] op_sel:[0,1,0] op_sel_hi:[1,1,0]
    buffer_load_dwordx4 a[216:219], v3, s[4:7], s9 offen offset:1024 sc1
    v_pk_fma_f32 v[192:193], v[192:193], v[14:15], v[14:15] op_sel:[0,1,0] op_sel_hi:[1,1,0]
    v_pk_fma_f32 v[194:195], v[194:195], v[14:15], v[14:15] op_sel:[0,1,0] op_sel_hi:[1,1,0]
    v_pk_fma_f32 v[196:197], v[196:197], v[14:15], v[14:15] op_sel:[0,1,0] op_sel_hi:[1,1,0]
    v_pk_fma_f32 v[198:199], v[198:199], v[14:15], v[14:15] op_sel:[0,1,0] op_sel_hi:[1,1,0]
    v_pk_mul_f32 v[168:169], v[168:169], v[136:137]
    v_pk_mul_f32 v[170:171], v[170:171], v[138:139]
    v_pk_mul_f32 v[172:173], v[172:173], v[140:141]
    v_pk_mul_f32 v[174:175], v[174:175], v[142:143]
    v_pk_mul_f32 v[176:177], v[176:177], v[144:145]
    v_pk_mul_f32 v[178:179], v[178:179], v[146:147]
    v_pk_mul_f32 v[180:181], v[180:181], v[148:149]
    v_pk_mul_f32 v[182:183], v[182:183], v[150:151]
    v_pk_mul_f32 v[184:185], v[184:185], v[152:153]
    v_pk_mul_f32 v[186:187], v[186:187], v[154:155]
    buffer_load_dwordx4 a[220:223], v3, s[4:7], s9 offen offset:2048 sc1
    v_pk_mul_f32 v[188:189], v[188:189], v[156:157]
    v_pk_mul_f32 v[190:191], v[190:191], v[158:159]
    v_pk_mul_f32 v[192:193], v[192:193], v[160:161]
    v_pk_mul_f32 v[194:195], v[194:195], v[162:163]
    v_pk_mul_f32 v[196:197], v[196:197], v[164:165]
    v_pk_mul_f32 v[198:199], v[198:199], v[166:167]
    v_exp_f32 v168, v168
    v_exp_f32 v169, v169
    v_exp_f32 v170, v170
    v_exp_f32 v171, v171
    v_exp_f32 v172, v172
    v_exp_f32 v173, v173
    v_exp_f32 v174, v174
    v_exp_f32 v175, v175
    buffer_load_dwordx4 a[224:227], v3, s[4:7], s9 offen offset:3072 sc1
    v_exp_f32 v176, v176
    v_exp_f32 v177, v177
    v_exp_f32 v178, v178
    v_exp_f32 v179, v179
    v_exp_f32 v180, v180
    v_exp_f32 v181, v181
    v_exp_f32 v182, v182
    v_exp_f32 v183, v183
    v_exp_f32 v184, v184
    v_exp_f32 v185, v185
    v_exp_f32 v186, v186
    v_exp_f32 v187, v187
    v_exp_f32 v188, v188
    v_exp_f32 v189, v189
    s_add_u32 s9, s9, 4096
    buffer_load_dwordx4 a[228:231], v3, s[4:7], s9 offen offset:0 sc1
    v_exp_f32 v190, v190
    v_exp_f32 v191, v191
    v_exp_f32 v192, v192
    v_exp_f32 v193, v193
    v_exp_f32 v194, v194
    v_exp_f32 v195, v195
    v_exp_f32 v196, v196
    v_exp_f32 v197, v197
    v_exp_f32 v198, v198
    v_exp_f32 v199, v199
    s_waitcnt vmcnt(5)
    buffer_store_dwordx2 v[4:5], v2, s[4:7], s8 offen sc1
    v_pk_add_f32 v[168:169], v[168:169], v[6:7]
    v_pk_add_f32 v[170:171], v[170:171], v[6:7]
    v_pk_add_f32 v[172:173], v[172:173], v[6:7]
    v_pk_add_f32 v[174:175], v[174:175], v[6:7]
    buffer_load_dwordx4 a[232:235], v3, s[4:7], s9 offen offset:1024 sc1
    v_pk_add_f32 v[176:177], v[176:177], v[6:7]
    v_pk_add_f32 v[178:179], v[178:179], v[6:7]
    v_pk_add_f32 v[180:181], v[180:181], v[6:7]
    v_pk_add_f32 v[182:183], v[182:183], v[6:7]
    v_pk_add_f32 v[184:185], v[184:185], v[6:7]
    v_pk_add_f32 v[186:187], v[186:187], v[6:7]
    v_pk_add_f32 v[188:189], v[188:189], v[6:7]
    v_pk_add_f32 v[190:191], v[190:191], v[6:7]
    v_pk_add_f32 v[192:193], v[192:193], v[6:7]
    v_pk_add_f32 v[194:195], v[194:195], v[6:7]
    v_pk_add_f32 v[196:197], v[196:197], v[6:7]
    v_pk_add_f32 v[198:199], v[198:199], v[6:7]
    v_rcp_f32 v168, v168
    v_rcp_f32 v169, v169
    buffer_load_dwordx4 a[236:239], v3, s[4:7], s9 offen offset:2048 sc1
    v_rcp_f32 v170, v170
    v_rcp_f32 v171, v171
    v_rcp_f32 v172, v172
    v_rcp_f32 v173, v173
    v_rcp_f32 v174, v174
    v_rcp_f32 v175, v175
    v_rcp_f32 v176, v176
    v_rcp_f32 v177, v177
    v_rcp_f32 v178, v178
    v_rcp_f32 v179, v179
    v_rcp_f32 v180, v180
    v_rcp_f32 v181, v181
    v_rcp_f32 v182, v182
    v_rcp_f32 v183, v183
    s_add_u32 s39, s10, 256
    s_add_u32 m0, s19, 0
    s_nop 0
    buffer_load_dwordx4 v18, s[12:15], s39 offen lds
    v_rcp_f32 v184, v184
    v_rcp_f32 v185, v185
    v_rcp_f32 v186, v186
    v_rcp_f32 v187, v187
    v_rcp_f32 v188, v188
    v_rcp_f32 v189, v189
    v_rcp_f32 v190, v190
    v_rcp_f32 v191, v191
    v_rcp_f32 v192, v192
    v_rcp_f32 v193, v193
    v_rcp_f32 v194, v194
    v_rcp_f32 v195, v195
    v_rcp_f32 v196, v196
    v_rcp_f32 v197, v197
    s_add_u32 s39, s10, 33024
    s_add_u32 m0, s19, 1024
    s_nop 0
    buffer_load_dwordx4 v19, s[12:15], s39 offen lds
    v_rcp_f32 v198, v198
    v_rcp_f32 v199, v199
    v_pk_mul_f32 v[136:137], v[136:137], v[168:169]
    v_pk_mul_f32 v[138:139], v[138:139], v[170:171]
    v_pk_mul_f32 v[140:141], v[140:141], v[172:173]
    v_pk_mul_f32 v[142:143], v[142:143], v[174:175]
    v_pk_mul_f32 v[144:145], v[144:145], v[176:177]
    v_pk_mul_f32 v[146:147], v[146:147], v[178:179]
    v_pk_mul_f32 v[148:149], v[148:149], v[180:181]
    v_pk_mul_f32 v[150:151], v[150:151], v[182:183]
    v_pk_mul_f32 v[152:153], v[152:153], v[184:185]
    v_pk_mul_f32 v[154:155], v[154:155], v[186:187]
    v_pk_mul_f32 v[156:157], v[156:157], v[188:189]
    v_pk_mul_f32 v[158:159], v[158:159], v[190:191]
    s_add_u32 s39, s11, 256
    s_add_u32 m0, s19, 2048
    s_nop 0
    buffer_load_dwordx4 v18, s[12:15], s39 offen lds
    v_pk_mul_f32 v[160:161], v[160:161], v[192:193]
    v_pk_mul_f32 v[162:163], v[162:163], v[194:195]
    v_pk_mul_f32 v[164:165], v[164:165], v[196:197]
    v_pk_mul_f32 v[166:167], v[166:167], v[198:199]
    v_cvt_pk_bf16_f32 v52, v136, v137
    v_cvt_pk_bf16_f32 v53, v138, v139
    v_cvt_pk_bf16_f32 v54, v140, v141
    v_cvt_pk_bf16_f32 v55, v142, v143
    v_cvt_pk_bf16_f32 v56, v144, v145
    v_cvt_pk_bf16_f32 v57, v146, v147
    v_cvt_pk_bf16_f32 v58, v148, v149
    v_cvt_pk_bf16_f32 v59, v150, v151
    v_cvt_pk_bf16_f32 v60, v152, v153
    v_cvt_pk_bf16_f32 v61, v154, v155
    v_cvt_pk_bf16_f32 v62, v156, v157
    v_cvt_pk_bf16_f32 v63, v158, v159
    v_cvt_pk_bf16_f32 v64, v160, v161
    v_cvt_pk_bf16_f32 v65, v162, v163
    v_cvt_pk_bf16_f32 v66, v164, v165
    v_cvt_pk_bf16_f32 v67, v166, v167
    s_add_u32 s39, s11, 33024
    s_add_u32 m0, s19, 3072
    s_nop 0
    buffer_load_dwordx4 v19, s[12:15], s39 offen lds
    s_add_u32 s39, s16, 256
    s_add_u32 m0, s19, 4096
    s_nop 0
    buffer_load_dwordx4 v18, s[12:15], s39 offen lds
    s_add_u32 s39, s16, 33024
    s_add_u32 m0, s19, 5120
    s_nop 0
    buffer_load_dwordx4 v19, s[12:15], s39 offen lds
    s_add_u32 s39, s17, 256
    s_add_u32 m0, s19, 6144
    s_nop 0
    buffer_load_dwordx4 v18, s[12:15], s39 offen lds
    s_add_u32 s39, s17, 33024
    s_add_u32 m0, s19, 7168
    s_nop 0
    buffer_load_dwordx4 v19, s[12:15], s39 offen lds
    s_add_u32 s39, s10, 384
    s_add_u32 m0, s19, 8192
    s_nop 0
    buffer_load_dwordx4 v18, s[12:15], s39 offen lds
    s_add_u32 s39, s10, 33152
    s_add_u32 m0, s19, 9216
    s_nop 0
    buffer_load_dwordx4 v19, s[12:15], s39 offen lds
    s_add_u32 s39, s11, 384
    s_add_u32 m0, s19, 10240
    s_nop 0
    buffer_load_dwordx4 v18, s[12:15], s39 offen lds
    s_add_u32 s39, s11, 33152
    s_add_u32 m0, s19, 11264
    s_nop 0
    buffer_load_dwordx4 v19, s[12:15], s39 offen lds
    s_add_u32 s39, s16, 384
    s_add_u32 m0, s19, 12288
    s_nop 0
    buffer_load_dwordx4 v18, s[12:15], s39 offen lds
    s_add_u32 s39, s16, 33152
    s_add_u32 m0, s19, 13312
    s_nop 0
    buffer_load_dwordx4 v19, s[12:15], s39 offen lds
    s_add_u32 s39, s17, 384
    s_add_u32 m0, s19, 14336
    s_nop 0
    buffer_load_dwordx4 v18, s[12:15], s39 offen lds
    s_add_u32 s39, s17, 33152
    s_add_u32 m0, s19, 15360
    s_nop 0
    buffer_load_dwordx4 v19, s[12:15], s39 offen lds
    s_add_u32 s39, s10, 512
    s_add_u32 m0, s19, 16384
    s_nop 0
    buffer_load_dwordx4 v18, s[12:15], s39 offen lds
    s_add_u32 s39, s10, 33280
    s_add_u32 m0, s19, 17408
    s_nop 0
    buffer_load_dwordx4 v19, s[12:15], s39 offen lds
    s_add_u32 s39, s11, 512
    s_add_u32 m0, s19, 18432
    s_nop 0
    buffer_load_dwordx4 v18, s[12:15], s39 offen lds
    s_add_u32 s39, s11, 33280
    s_add_u32 m0, s19, 19456
    s_nop 0
    buffer_load_dwordx4 v19, s[12:15], s39 offen lds
    s_add_u32 s39, s16, 512
    s_add_u32 m0, s19, 20480
    s_nop 0
    buffer_load_dwordx4 v18, s[12:15], s39 offen lds
    s_add_u32 s39, s16, 33280
    s_add_u32 m0, s19, 21504
    s_nop 0
    buffer_load_dwordx4 v19, s[12:15], s39 offen lds
    s_add_u32 s39, s17, 512
    s_add_u32 m0, s19, 22528
    s_nop 0
    buffer_load_dwordx4 v18, s[12:15], s39 offen lds
    s_add_u32 s39, s17, 33280
    s_add_u32 m0, s19, 23552
    s_nop 0
    buffer_load_dwordx4 v19, s[12:15], s39 offen lds
    s_load_dwordx2 s[20:21], s[0:1], 48
    s_load_dwordx2 s[60:61], s[0:1], 80
    s_waitcnt lgkmcnt(0)
    s_mov_b32 s22, 4096
    s_mov_b32 s23, 0x20000
    s_mov_b32 s62, 1835008
    s_mov_b32 s63, 0x20000
    v_and_b32 v6, 15, v1
    v_lshlrev_b32 v6, 1, v6
    s_lshl_b32 s39, s35, 2
    s_add_u32 s39, s39, s30
    s_lshl_b32 s39, s39, 5
    buffer_load_ushort v10, v6, s[20:23], s39 offen
    v_and_b32 v6, 31, v1
    v_lshlrev_b32 v6, 7, v6
    s_lshl_b32 s39, s36, 7
    s_lshl_b32 s40, s30, 5
    s_add_u32 s39, s39, s40
    s_lshl_b32 s39, s39, 7
    s_add_u32 s42, s39, 458752
    s_mov_b32 s43, 400000
    s_nop 0
L_poll_33:
    buffer_load_dwordx2 v[12:13], v6, s[4:7], s42 offen sc1
    s_waitcnt vmcnt(0)
    v_cmp_eq_u32 vcc, s37, v12
    v_cmp_eq_u32 s[44:45], s38, v13
    s_nop 3
    s_and_b64 vcc, vcc, s[44:45]
    s_cmp_eq_u64 vcc, -1
    s_nop 0
    s_cbranch_scc1 L_polld_34
    s_sub_u32 s43, s43, 1
    s_cmp_lg_u32 s43, 0
    s_nop 0
    s_cbranch_scc1 L_poll_33
    v_mov_b32 v12, 8
    s_mov_b32 s39, 0
    buffer_store_dword v12, v2, s[24:27], s39 offen
    s_nop 1
L_polld_34:
    s_mul_i32 s8, s36, 458752
    s_mul_i32 s39, s30, 114688
    s_add_u32 s8, s8, s39
    s_add_u32 s8, s8, 9437184
    s_add_u32 s40, s8, 0
    buffer_load_dwordx4 v[96:99], v3, s[4:7], s40 offen offset:0 sc1
    buffer_load_dwordx4 v[100:103], v3, s[4:7], s40 offen offset:1024 sc1
    buffer_load_dwordx4 v[104:107], v3, s[4:7], s40 offen offset:2048 sc1
    buffer_load_dwordx4 v[108:111], v3, s[4:7], s40 offen offset:3072 sc1
    s_add_u32 s40, s8, 4096
    buffer_load_dwordx4 v[112:115], v3, s[4:7], s40 offen offset:0 sc1
    buffer_load_dwordx4 v[116:119], v3, s[4:7], s40 offen offset:1024 sc1
    buffer_load_dwordx4 v[120:123], v3, s[4:7], s40 offen offset:2048 sc1
    s_add_u32 s40, s8, 7168
    buffer_load_dwordx4 v[124:127], v3, s[4:7], s40 offen offset:0 sc1
    buffer_load_dwordx4 v[128:131], v3, s[4:7], s40 offen offset:1024 sc1
    buffer_load_dwordx4 v[132:135], v3, s[4:7], s40 offen offset:2048 sc1
    buffer_load_dwordx4 v[136:139], v3, s[4:7], s40 offen offset:3072 sc1
    s_add_u32 s40, s8, 11264
    buffer_load_dwordx4 v[140:143], v3, s[4:7], s40 offen offset:0 sc1
    buffer_load_dwordx4 v[144:147], v3, s[4:7], s40 offen offset:1024 sc1
    buffer_load_dwordx4 v[148:151], v3, s[4:7], s40 offen offset:2048 sc1
    s_add_u32 s40, s8, 14336
    buffer_load_dwordx4 v[152:155], v3, s[4:7], s40 offen offset:0 sc1
    buffer_load_dwordx4 v[156:159], v3, s[4:7], s40 offen offset:1024 sc1
    buffer_load_dwordx4 v[160:163], v3, s[4:7], s40 offen offset:2048 sc1
    buffer_load_dwordx4 v[164:167], v3, s[4:7], s40 offen offset:3072 sc1
    s_add_u32 s40, s8, 18432
    buffer_load_dwordx4 v[168:171], v3, s[4:7], s40 offen offset:0 sc1
    buffer_load_dwordx4 v[172:175], v3, s[4:7], s40 offen offset:1024 sc1
    buffer_load_dwordx4 v[176:179], v3, s[4:7], s40 offen offset:2048 sc1
    ds_read_b128 v[24:27], v20 offset:0
    ds_read_b128 v[28:31], v20 offset:2048
    ds_read_b128 v[32:35], v20 offset:4096
    ds_read_b128 v[36:39], v20 offset:6144
    s_waitcnt vmcnt(20) lgkmcnt(3)
    v_mfma_f32_16x16x32_bf16 v[68:71], v[96:99], v[24:27], 0
    s_waitcnt vmcnt(19)
    v_mfma_f32_16x16x32_bf16 v[72:75], v[100:103], v[24:27], 0
    s_add_u32 s40, s8, 21504
    buffer_load_dwordx4 v[180:183], v3, s[4:7], s40 offen offset:0 sc1
    s_waitcnt vmcnt(19)
    v_mfma_f32_16x16x32_bf16 v[76:79], v[104:107], v[24:27], 0
    s_waitcnt vmcnt(18)
    v_mfma_f32_16x16x32_bf16 v[80:83], v[108:111], v[24:27], 0
    buffer_load_dwordx4 v[184:187], v3, s[4:7], s40 offen offset:1024 sc1
    s_waitcnt vmcnt(18)
    v_mfma_f32_16x16x32_bf16 v[84:87], v[112:115], v[24:27], 0
    s_waitcnt vmcnt(17)
    v_mfma_f32_16x16x32_bf16 v[88:91], v[116:119], v[24:27], 0
    buffer_load_dwordx4 v[188:191], v3, s[4:7], s40 offen offset:2048 sc1
    s_waitcnt vmcnt(17)
    v_mfma_f32_16x16x32_bf16 v[92:95], v[120:123], v[24:27], 0
    s_waitcnt lgkmcnt(2)
    v_mfma_f32_16x16x32_bf16 a[112:115], v[96:99], v[28:31], 0
    buffer_load_dwordx4 v[192:195], v3, s[4:7], s40 offen offset:3072 sc1
    v_mfma_f32_16x16x32_bf16 a[116:119], v[100:103], v[28:31], 0
    v_mfma_f32_16x16x32_bf16 a[120:123], v[104:107], v[28:31], 0
    s_add_u32 s40, s8, 25600
    buffer_load_dwordx4 v[196:199], v3, s[4:7], s40 offen offset:0 sc1
    v_mfma_f32_16x16x32_bf16 a[124:127], v[108:111], v[28:31], 0
    v_mfma_f32_16x16x32_bf16 a[128:131], v[112:115], v[28:31], 0
    buffer_load_dwordx4 v[200:203], v3, s[4:7], s40 offen offset:1024 sc1
    v_mfma_f32_16x16x32_bf16 a[132:135], v[116:119], v[28:31], 0
    v_mfma_f32_16x16x32_bf16 a[136:139], v[120:123], v[28:31], 0
    buffer_load_dwordx4 v[204:207], v3, s[4:7], s40 offen offset:2048 sc1
    s_waitcnt lgkmcnt(1)
    v_mfma_f32_16x16x32_bf16 a[140:143], v[96:99], v[32:35], 0
    v_mfma_f32_16x16x32_bf16 a[144:147], v[100:103], v[32:35], 0
    ds_read_b128 v[208:211], v21 offset:0
    v_mfma_f32_16x16x32_bf16 a[148:151], v[104:107], v[32:35], 0
    v_mfma_f32_16x16x32_bf16 a[152:155], v[108:111], v[32:35], 0
    ds_read_b128 v[212:215], v21 offset:2048
    v_mfma_f32_16x16x32_bf16 a[156:159], v[112:115], v[32:35], 0
    v_mfma_f32_16x16x32_bf16 a[160:163], v[116:119], v[32:35], 0
    ds_read_b128 v[216:219], v21 offset:4096
    v_mfma_f32_16x16x32_bf16 a[164:167], v[120:123], v[32:35], 0
    s_waitcnt lgkmcnt(3)
    v_mfma_f32_16x16x32_bf16 a[168:171], v[96:99], v[36:39], 0
    ds_read_b128 v[220:223], v21 offset:6144
    v_mfma_f32_16x16x32_bf16 a[172:175], v[100:103], v[36:39], 0
    v_mfma_f32_16x16x32_bf16 a[176:179], v[104:107], v[36:39], 0
    v_mfma_f32_16x16x32_bf16 a[180:183], v[108:111], v[36:39], 0
    v_mfma_f32_16x16x32_bf16 a[184:187], v[112:115], v[36:39], 0
    v_mfma_f32_16x16x32_bf16 a[188:191], v[116:119], v[36:39], 0
    v_mfma_f32_16x16x32_bf16 a[192:195], v[120:123], v[36:39], 0
    s_waitcnt vmcnt(20) lgkmcnt(3)
    v_mfma_f32_16x16x32_bf16 v[68:71], v[124:127], v[208:211], v[68:71]
    s_waitcnt vmcnt(19)
    v_mfma_f32_16x16x32_bf16 v[72:75], v[128:131], v[208:211], v[72:75]
    s_add_u32 s40, s8, 28672
    buffer_load_dwordx4 v[96:99], v3, s[4:7], s40 offen offset:0 sc1
    s_waitcnt vmcnt(19)
    v_mfma_f32_16x16x32_bf16 v[76:79], v[132:135], v[208:211], v[76:79]
    s_waitcnt vmcnt(18)
    v_mfma_f32_16x16x32_bf16 v[80:83], v[136:139], v[208:211], v[80:83]
    buffer_load_dwordx4 v[100:103], v3, s[4:7], s40 offen offset:1024 sc1
    s_waitcnt vmcnt(18)
    v_mfma_f32_16x16x32_bf16 v[84:87], v[140:143], v[208:211], v[84:87]
    s_waitcnt vmcnt(17)
    v_mfma_f32_16x16x32_bf16 v[88:91], v[144:147], v[208:211], v[88:91]
    buffer_load_dwordx4 v[104:107], v3, s[4:7], s40 offen offset:2048 sc1
    s_waitcnt vmcnt(17)
    v_mfma_f32_16x16x32_bf16 v[92:95], v[148:151], v[208:211], v[92:95]
    s_waitcnt lgkmcnt(2)
    v_mfma_f32_16x16x32_bf16 a[112:115], v[124:127], v[212:215], a[112:115]
    buffer_load_dwordx4 v[108:111], v3, s[4:7], s40 offen offset:3072 sc1
    v_mfma_f32_16x16x32_bf16 a[116:119], v[128:131], v[212:215], a[116:119]
    v_mfma_f32_16x16x32_bf16 a[120:123], v[132:135], v[212:215], a[120:123]
    s_add_u32 s40, s8, 32768
    buffer_load_dwordx4 v[112:115], v3, s[4:7], s40 offen offset:0 sc1
    v_mfma_f32_16x16x32_bf16 a[124:127], v[136:139], v[212:215], a[124:127]
    v_mfma_f32_16x16x32_bf16 a[128:131], v[140:143], v[212:215], a[128:131]
    buffer_load_dwordx4 v[116:119], v3, s[4:7], s40 offen offset:1024 sc1
    v_mfma_f32_16x16x32_bf16 a[132:135], v[144:147], v[212:215], a[132:135]
    v_mfma_f32_16x16x32_bf16 a[136:139], v[148:151], v[212:215], a[136:139]
    buffer_load_dwordx4 v[120:123], v3, s[4:7], s40 offen offset:2048 sc1
    s_waitcnt lgkmcnt(1)
    v_mfma_f32_16x16x32_bf16 a[140:143], v[124:127], v[216:219], a[140:143]
    v_mfma_f32_16x16x32_bf16 a[144:147], v[128:131], v[216:219], a[144:147]
    ds_read_b128 v[24:27], v20 offset:8192
    v_mfma_f32_16x16x32_bf16 a[148:151], v[132:135], v[216:219], a[148:151]
    v_mfma_f32_16x16x32_bf16 a[152:155], v[136:139], v[216:219], a[152:155]
    ds_read_b128 v[28:31], v20 offset:10240
    v_mfma_f32_16x16x32_bf16 a[156:159], v[140:143], v[216:219], a[156:159]
    v_mfma_f32_16x16x32_bf16 a[160:163], v[144:147], v[216:219], a[160:163]
    ds_read_b128 v[32:35], v20 offset:12288
    v_mfma_f32_16x16x32_bf16 a[164:167], v[148:151], v[216:219], a[164:167]
    s_waitcnt lgkmcnt(3)
    v_mfma_f32_16x16x32_bf16 a[168:171], v[124:127], v[220:223], a[168:171]
    ds_read_b128 v[36:39], v20 offset:14336
    v_mfma_f32_16x16x32_bf16 a[172:175], v[128:131], v[220:223], a[172:175]
    v_mfma_f32_16x16x32_bf16 a[176:179], v[132:135], v[220:223], a[176:179]
    v_mfma_f32_16x16x32_bf16 a[180:183], v[136:139], v[220:223], a[180:183]
    v_mfma_f32_16x16x32_bf16 a[184:187], v[140:143], v[220:223], a[184:187]
    v_mfma_f32_16x16x32_bf16 a[188:191], v[144:147], v[220:223], a[188:191]
    v_mfma_f32_16x16x32_bf16 a[192:195], v[148:151], v[220:223], a[192:195]
    s_waitcnt vmcnt(20) lgkmcnt(3)
    v_mfma_f32_16x16x32_bf16 v[68:71], v[152:155], v[24:27], v[68:71]
    s_waitcnt vmcnt(19)
    v_mfma_f32_16x16x32_bf16 v[72:75], v[156:159], v[24:27], v[72:75]
    s_add_u32 s40, s8, 35840
    buffer_load_dwordx4 v[124:127], v3, s[4:7], s40 offen offset:0 sc1
    s_waitcnt vmcnt(19)
    v_mfma_f32_16x16x32_bf16 v[76:79], v[160:163], v[24:27], v[76:79]
    s_waitcnt vmcnt(18)
    v_mfma_f32_16x16x32_bf16 v[80:83], v[164:167], v[24:27], v[80:83]
    buffer_load_dwordx4 v[128:131], v3, s[4:7], s40 offen offset:1024 sc1
    s_waitcnt vmcnt(18)
    v_mfma_f32_16x16x32_bf16 v[84:87], v[168:171], v[24:27], v[84:87]
    s_waitcnt vmcnt(17)
    v_mfma_f32_16x16x32_bf16 v[88:91], v[172:175], v[24:27], v[88:91]
    buffer_load_dwordx4 v[132:135], v3, s[4:7], s40 offen offset:2048 sc1
    s_waitcnt vmcnt(17)
    v_mfma_f32_16x16x32_bf16 v[92:95], v[176:179], v[24:27], v[92:95]
    s_waitcnt lgkmcnt(2)
    v_mfma_f32_16x16x32_bf16 a[112:115], v[152:155], v[28:31], a[112:115]
    buffer_load_dwordx4 v[136:139], v3, s[4:7], s40 offen offset:3072 sc1
    v_mfma_f32_16x16x32_bf16 a[116:119], v[156:159], v[28:31], a[116:119]
    v_mfma_f32_16x16x32_bf16 a[120:123], v[160:163], v[28:31], a[120:123]
    s_add_u32 s40, s8, 39936
    buffer_load_dwordx4 v[140:143], v3, s[4:7], s40 offen offset:0 sc1
    v_mfma_f32_16x16x32_bf16 a[124:127], v[164:167], v[28:31], a[124:127]
    v_mfma_f32_16x16x32_bf16 a[128:131], v[168:171], v[28:31], a[128:131]
    buffer_load_dwordx4 v[144:147], v3, s[4:7], s40 offen offset:1024 sc1
    v_mfma_f32_16x16x32_bf16 a[132:135], v[172:175], v[28:31], a[132:135]
    v_mfma_f32_16x16x32_bf16 a[136:139], v[176:179], v[28:31], a[136:139]
    buffer_load_dwordx4 v[148:151], v3, s[4:7], s40 offen offset:2048 sc1
    s_waitcnt lgkmcnt(1)
    v_mfma_f32_16x16x32_bf16 a[140:143], v[152:155], v[32:35], a[140:143]
    v_mfma_f32_16x16x32_bf16 a[144:147], v[156:159], v[32:35], a[144:147]
    ds_read_b128 v[208:211], v21 offset:8192
    v_mfma_f32_16x16x32_bf16 a[148:151], v[160:163], v[32:35], a[148:151]
    v_mfma_f32_16x16x32_bf16 a[152:155], v[164:167], v[32:35], a[152:155]
    ds_read_b128 v[212:215], v21 offset:10240
    v_mfma_f32_16x16x32_bf16 a[156:159], v[168:171], v[32:35], a[156:159]
    v_mfma_f32_16x16x32_bf16 a[160:163], v[172:175], v[32:35], a[160:163]
    ds_read_b128 v[216:219], v21 offset:12288
    v_mfma_f32_16x16x32_bf16 a[164:167], v[176:179], v[32:35], a[164:167]
    s_waitcnt lgkmcnt(3)
    v_mfma_f32_16x16x32_bf16 a[168:171], v[152:155], v[36:39], a[168:171]
    ds_read_b128 v[220:223], v21 offset:14336
    v_mfma_f32_16x16x32_bf16 a[172:175], v[156:159], v[36:39], a[172:175]
    v_mfma_f32_16x16x32_bf16 a[176:179], v[160:163], v[36:39], a[176:179]
    v_mfma_f32_16x16x32_bf16 a[180:183], v[164:167], v[36:39], a[180:183]
    v_mfma_f32_16x16x32_bf16 a[184:187], v[168:171], v[36:39], a[184:187]
    v_mfma_f32_16x16x32_bf16 a[188:191], v[172:175], v[36:39], a[188:191]
    v_mfma_f32_16x16x32_bf16 a[192:195], v[176:179], v[36:39], a[192:195]
    s_waitcnt vmcnt(20) lgkmcnt(3)
    v_mfma_f32_16x16x32_bf16 v[68:71], v[180:183], v[208:211], v[68:71]
    s_waitcnt vmcnt(19)
    v_mfma_f32_16x16x32_bf16 v[72:75], v[184:187], v[208:211], v[72:75]
    s_add_u32 s40, s8, 43008
    buffer_load_dwordx4 v[152:155], v3, s[4:7], s40 offen offset:0 sc1
    s_waitcnt vmcnt(19)
    v_mfma_f32_16x16x32_bf16 v[76:79], v[188:191], v[208:211], v[76:79]
    s_waitcnt vmcnt(18)
    v_mfma_f32_16x16x32_bf16 v[80:83], v[192:195], v[208:211], v[80:83]
    buffer_load_dwordx4 v[156:159], v3, s[4:7], s40 offen offset:1024 sc1
    s_waitcnt vmcnt(18)
    v_mfma_f32_16x16x32_bf16 v[84:87], v[196:199], v[208:211], v[84:87]
    s_waitcnt vmcnt(17)
    v_mfma_f32_16x16x32_bf16 v[88:91], v[200:203], v[208:211], v[88:91]
    buffer_load_dwordx4 v[160:163], v3, s[4:7], s40 offen offset:2048 sc1
    s_waitcnt vmcnt(17)
    v_mfma_f32_16x16x32_bf16 v[92:95], v[204:207], v[208:211], v[92:95]
    s_waitcnt lgkmcnt(2)
    v_mfma_f32_16x16x32_bf16 a[112:115], v[180:183], v[212:215], a[112:115]
    buffer_load_dwordx4 v[164:167], v3, s[4:7], s40 offen offset:3072 sc1
    v_mfma_f32_16x16x32_bf16 a[116:119], v[184:187], v[212:215], a[116:119]
    v_mfma_f32_16x16x32_bf16 a[120:123], v[188:191], v[212:215], a[120:123]
    s_add_u32 s40, s8, 47104
    buffer_load_dwordx4 v[168:171], v3, s[4:7], s40 offen offset:0 sc1
    v_mfma_f32_16x16x32_bf16 a[124:127], v[192:195], v[212:215], a[124:127]
    v_mfma_f32_16x16x32_bf16 a[128:131], v[196:199], v[212:215], a[128:131]
    buffer_load_dwordx4 v[172:175], v3, s[4:7], s40 offen offset:1024 sc1
    v_mfma_f32_16x16x32_bf16 a[132:135], v[200:203], v[212:215], a[132:135]
    v_mfma_f32_16x16x32_bf16 a[136:139], v[204:207], v[212:215], a[136:139]
    buffer_load_dwordx4 v[176:179], v3, s[4:7], s40 offen offset:2048 sc1
    s_waitcnt lgkmcnt(1)
    v_mfma_f32_16x16x32_bf16 a[140:143], v[180:183], v[216:219], a[140:143]
    v_mfma_f32_16x16x32_bf16 a[144:147], v[184:187], v[216:219], a[144:147]
    ds_read_b128 v[24:27], v22 offset:0
    v_mfma_f32_16x16x32_bf16 a[148:151], v[188:191], v[216:219], a[148:151]
    v_mfma_f32_16x16x32_bf16 a[152:155], v[192:195], v[216:219], a[152:155]
    ds_read_b128 v[28:31], v22 offset:2048
    v_mfma_f32_16x16x32_bf16 a[156:159], v[196:199], v[216:219], a[156:159]
    v_mfma_f32_16x16x32_bf16 a[160:163], v[200:203], v[216:219], a[160:163]
    ds_read_b128 v[32:35], v22 offset:4096
    v_mfma_f32_16x16x32_bf16 a[164:167], v[204:207], v[216:219], a[164:167]
    s_waitcnt lgkmcnt(3)
    v_mfma_f32_16x16x32_bf16 a[168:171], v[180:183], v[220:223], a[168:171]
    ds_read_b128 v[36:39], v22 offset:6144
    v_mfma_f32_16x16x32_bf16 a[172:175], v[184:187], v[220:223], a[172:175]
    v_mfma_f32_16x16x32_bf16 a[176:179], v[188:191], v[220:223], a[176:179]
    v_mfma_f32_16x16x32_bf16 a[180:183], v[192:195], v[220:223], a[180:183]
    v_mfma_f32_16x16x32_bf16 a[184:187], v[196:199], v[220:223], a[184:187]
    v_mfma_f32_16x16x32_bf16 a[188:191], v[200:203], v[220:223], a[188:191]
    v_mfma_f32_16x16x32_bf16 a[192:195], v[204:207], v[220:223], a[192:195]
    s_waitcnt vmcnt(20) lgkmcnt(3)
    v_mfma_f32_16x16x32_bf16 v[68:71], v[96:99], v[24:27], v[68:71]
    s_waitcnt vmcnt(19)
    v_mfma_f32_16x16x32_bf16 v[72:75], v[100:103], v[24:27], v[72:75]
    s_add_u32 s40, s8, 50176
    buffer_load_dwordx4 v[180:183], v3, s[4:7], s40 offen offset:0 sc1
    s_waitcnt vmcnt(19)
    v_mfma_f32_16x16x32_bf16 v[76:79], v[104:107], v[24:27], v[76:79]
    s_waitcnt vmcnt(18)
    v_mfma_f32_16x16x32_bf16 v[80:83], v[108:111], v[24:27], v[80:83]
    buffer_load_dwordx4 v[184:187], v3, s[4:7], s40 offen offset:1024 sc1
    s_waitcnt vmcnt(18)
    v_mfma_f32_16x16x32_bf16 v[84:87], v[112:115], v[24:27], v[84:87]
    s_waitcnt vmcnt(17)
    v_mfma_f32_16x16x32_bf16 v[88:91], v[116:119], v[24:27], v[88:91]
    buffer_load_dwordx4 v[188:191], v3, s[4:7], s40 offen offset:2048 sc1
    s_waitcnt vmcnt(17)
    v_mfma_f32_16x16x32_bf16 v[92:95], v[120:123], v[24:27], v[92:95]
    s_waitcnt lgkmcnt(2)
    v_mfma_f32_16x16x32_bf16 a[112:115], v[96:99], v[28:31], a[112:115]
    buffer_load_dwordx4 v[192:195], v3, s[4:7], s40 offen offset:3072 sc1
    v_mfma_f32_16x16x32_bf16 a[116:119], v[100:103], v[28:31], a[116:119]
    v_mfma_f32_16x16x32_bf16 a[120:123], v[104:107], v[28:31], a[120:123]
    s_add_u32 s40, s8, 54272
    buffer_load_dwordx4 v[196:199], v3, s[4:7], s40 offen offset:0 sc1
    v_mfma_f32_16x16x32_bf16 a[124:127], v[108:111], v[28:31], a[124:127]
    v_mfma_f32_16x16x32_bf16 a[128:131], v[112:115], v[28:31], a[128:131]
    buffer_load_dwordx4 v[200:203], v3, s[4:7], s40 offen offset:1024 sc1
    v_mfma_f32_16x16x32_bf16 a[132:135], v[116:119], v[28:31], a[132:135]
    v_mfma_f32_16x16x32_bf16 a[136:139], v[120:123], v[28:31], a[136:139]
    buffer_load_dwordx4 v[204:207], v3, s[4:7], s40 offen offset:2048 sc1
    s_waitcnt lgkmcnt(1)
    v_mfma_f32_16x16x32_bf16 a[140:143], v[96:99], v[32:35], a[140:143]
    v_mfma_f32_16x16x32_bf16 a[144:147], v[100:103], v[32:35], a[144:147]
    ds_read_b128 v[208:211], v23 offset:0
    v_mfma_f32_16x16x32_bf16 a[148:151], v[104:107], v[32:35], a[148:151]
    v_mfma_f32_16x16x32_bf16 a[152:155], v[108:111], v[32:35], a[152:155]
    ds_read_b128 v[212:215], v23 offset:2048
    v_mfma_f32_16x16x32_bf16 a[156:159], v[112:115], v[32:35], a[156:159]
    v_mfma_f32_16x16x32_bf16 a[160:163], v[116:119], v[32:35], a[160:163]
    ds_read_b128 v[216:219], v23 offset:4096
    v_mfma_f32_16x16x32_bf16 a[164:167], v[120:123], v[32:35], a[164:167]
    s_waitcnt lgkmcnt(3)
    v_mfma_f32_16x16x32_bf16 a[168:171], v[96:99], v[36:39], a[168:171]
    ds_read_b128 v[220:223], v23 offset:6144
    v_mfma_f32_16x16x32_bf16 a[172:175], v[100:103], v[36:39], a[172:175]
    v_mfma_f32_16x16x32_bf16 a[176:179], v[104:107], v[36:39], a[176:179]
    v_mfma_f32_16x16x32_bf16 a[180:183], v[108:111], v[36:39], a[180:183]
    v_mfma_f32_16x16x32_bf16 a[184:187], v[112:115], v[36:39], a[184:187]
    v_mfma_f32_16x16x32_bf16 a[188:191], v[116:119], v[36:39], a[188:191]
    v_mfma_f32_16x16x32_bf16 a[192:195], v[120:123], v[36:39], a[192:195]
    s_waitcnt vmcnt(20) lgkmcnt(3)
    v_mfma_f32_16x16x32_bf16 v[68:71], v[124:127], v[208:211], v[68:71]
    s_waitcnt vmcnt(19)
    v_mfma_f32_16x16x32_bf16 v[72:75], v[128:131], v[208:211], v[72:75]
    s_add_u32 s40, s8, 57344
    buffer_load_dwordx4 v[96:99], v3, s[4:7], s40 offen offset:0 sc1
    s_waitcnt vmcnt(19)
    v_mfma_f32_16x16x32_bf16 v[76:79], v[132:135], v[208:211], v[76:79]
    s_waitcnt vmcnt(18)
    v_mfma_f32_16x16x32_bf16 v[80:83], v[136:139], v[208:211], v[80:83]
    buffer_load_dwordx4 v[100:103], v3, s[4:7], s40 offen offset:1024 sc1
    s_waitcnt vmcnt(18)
    v_mfma_f32_16x16x32_bf16 v[84:87], v[140:143], v[208:211], v[84:87]
    s_waitcnt vmcnt(17)
    v_mfma_f32_16x16x32_bf16 v[88:91], v[144:147], v[208:211], v[88:91]
    buffer_load_dwordx4 v[104:107], v3, s[4:7], s40 offen offset:2048 sc1
    s_waitcnt vmcnt(17)
    v_mfma_f32_16x16x32_bf16 v[92:95], v[148:151], v[208:211], v[92:95]
    s_waitcnt lgkmcnt(2)
    v_mfma_f32_16x16x32_bf16 a[112:115], v[124:127], v[212:215], a[112:115]
    buffer_load_dwordx4 v[108:111], v3, s[4:7], s40 offen offset:3072 sc1
    v_mfma_f32_16x16x32_bf16 a[116:119], v[128:131], v[212:215], a[116:119]
    v_mfma_f32_16x16x32_bf16 a[120:123], v[132:135], v[212:215], a[120:123]
    s_add_u32 s40, s8, 61440
    buffer_load_dwordx4 v[112:115], v3, s[4:7], s40 offen offset:0 sc1
    v_mfma_f32_16x16x32_bf16 a[124:127], v[136:139], v[212:215], a[124:127]
    v_mfma_f32_16x16x32_bf16 a[128:131], v[140:143], v[212:215], a[128:131]
    buffer_load_dwordx4 v[116:119], v3, s[4:7], s40 offen offset:1024 sc1
    v_mfma_f32_16x16x32_bf16 a[132:135], v[144:147], v[212:215], a[132:135]
    v_mfma_f32_16x16x32_bf16 a[136:139], v[148:151], v[212:215], a[136:139]
    buffer_load_dwordx4 v[120:123], v3, s[4:7], s40 offen offset:2048 sc1
    s_waitcnt lgkmcnt(1)
    v_mfma_f32_16x16x32_bf16 a[140:143], v[124:127], v[216:219], a[140:143]
    v_mfma_f32_16x16x32_bf16 a[144:147], v[128:131], v[216:219], a[144:147]
    ds_read_b128 v[24:27], v22 offset:8192
    v_mfma_f32_16x16x32_bf16 a[148:151], v[132:135], v[216:219], a[148:151]
    v_mfma_f32_16x16x32_bf16 a[152:155], v[136:139], v[216:219], a[152:155]
    ds_read_b128 v[28:31], v22 offset:10240
    v_mfma_f32_16x16x32_bf16 a[156:159], v[140:143], v[216:219], a[156:159]
    v_mfma_f32_16x16x32_bf16 a[160:163], v[144:147], v[216:219], a[160:163]
    ds_read_b128 v[32:35], v22 offset:12288
    v_mfma_f32_16x16x32_bf16 a[164:167], v[148:151], v[216:219], a[164:167]
    s_waitcnt lgkmcnt(3)
    v_mfma_f32_16x16x32_bf16 a[168:171], v[124:127], v[220:223], a[168:171]
    ds_read_b128 v[36:39], v22 offset:14336
    v_mfma_f32_16x16x32_bf16 a[172:175], v[128:131], v[220:223], a[172:175]
    v_mfma_f32_16x16x32_bf16 a[176:179], v[132:135], v[220:223], a[176:179]
    v_mfma_f32_16x16x32_bf16 a[180:183], v[136:139], v[220:223], a[180:183]
    v_mfma_f32_16x16x32_bf16 a[184:187], v[140:143], v[220:223], a[184:187]
    v_mfma_f32_16x16x32_bf16 a[188:191], v[144:147], v[220:223], a[188:191]
    v_mfma_f32_16x16x32_bf16 a[192:195], v[148:151], v[220:223], a[192:195]
    s_waitcnt vmcnt(20) lgkmcnt(3)
    v_mfma_f32_16x16x32_bf16 v[68:71], v[152:155], v[24:27], v[68:71]
    s_waitcnt vmcnt(19)
    v_mfma_f32_16x16x32_bf16 v[72:75], v[156:159], v[24:27], v[72:75]
    s_add_u32 s40, s8, 64512
    buffer_load_dwordx4 v[124:127], v3, s[4:7], s40 offen offset:0 sc1
    s_waitcnt vmcnt(19)
    v_mfma_f32_16x16x32_bf16 v[76:79], v[160:163], v[24:27], v[76:79]
    s_waitcnt vmcnt(18)
    v_mfma_f32_16x16x32_bf16 v[80:83], v[164:167], v[24:27], v[80:83]
    buffer_load_dwordx4 v[128:131], v3, s[4:7], s40 offen offset:1024 sc1
    s_waitcnt vmcnt(18)
    v_mfma_f32_16x16x32_bf16 v[84:87], v[168:171], v[24:27], v[84:87]
    s_waitcnt vmcnt(17)
    v_mfma_f32_16x16x32_bf16 v[88:91], v[172:175], v[24:27], v[88:91]
    buffer_load_dwordx4 v[132:135], v3, s[4:7], s40 offen offset:2048 sc1
    s_waitcnt vmcnt(17)
    v_mfma_f32_16x16x32_bf16 v[92:95], v[176:179], v[24:27], v[92:95]
    s_waitcnt lgkmcnt(2)
    v_mfma_f32_16x16x32_bf16 a[112:115], v[152:155], v[28:31], a[112:115]
    buffer_load_dwordx4 v[136:139], v3, s[4:7], s40 offen offset:3072 sc1
    v_mfma_f32_16x16x32_bf16 a[116:119], v[156:159], v[28:31], a[116:119]
    v_mfma_f32_16x16x32_bf16 a[120:123], v[160:163], v[28:31], a[120:123]
    s_add_u32 s40, s8, 68608
    buffer_load_dwordx4 v[140:143], v3, s[4:7], s40 offen offset:0 sc1
    v_mfma_f32_16x16x32_bf16 a[124:127], v[164:167], v[28:31], a[124:127]
    v_mfma_f32_16x16x32_bf16 a[128:131], v[168:171], v[28:31], a[128:131]
    buffer_load_dwordx4 v[144:147], v3, s[4:7], s40 offen offset:1024 sc1
    v_mfma_f32_16x16x32_bf16 a[132:135], v[172:175], v[28:31], a[132:135]
    v_mfma_f32_16x16x32_bf16 a[136:139], v[176:179], v[28:31], a[136:139]
    buffer_load_dwordx4 v[148:151], v3, s[4:7], s40 offen offset:2048 sc1
    s_waitcnt lgkmcnt(1)
    v_mfma_f32_16x16x32_bf16 a[140:143], v[152:155], v[32:35], a[140:143]
    v_mfma_f32_16x16x32_bf16 a[144:147], v[156:159], v[32:35], a[144:147]
    ds_read_b128 v[208:211], v23 offset:8192
    v_mfma_f32_16x16x32_bf16 a[148:151], v[160:163], v[32:35], a[148:151]
    v_mfma_f32_16x16x32_bf16 a[152:155], v[164:167], v[32:35], a[152:155]
    ds_read_b128 v[212:215], v23 offset:10240
    v_mfma_f32_16x16x32_bf16 a[156:159], v[168:171], v[32:35], a[156:159]
    v_mfma_f32_16x16x32_bf16 a[160:163], v[172:175], v[32:35], a[160:163]
    ds_read_b128 v[216:219], v23 offset:12288
    v_mfma_f32_16x16x32_bf16 a[164:167], v[176:179], v[32:35], a[164:167]
    s_waitcnt lgkmcnt(3)
    v_mfma_f32_16x16x32_bf16 a[168:171], v[152:155], v[36:39], a[168:171]
    ds_read_b128 v[220:223], v23 offset:14336
    v_mfma_f32_16x16x32_bf16 a[172:175], v[156:159], v[36:39], a[172:175]
    v_mfma_f32_16x16x32_bf16 a[176:179], v[160:163], v[36:39], a[176:179]
    v_mfma_f32_16x16x32_bf16 a[180:183], v[164:167], v[36:39], a[180:183]
    v_mfma_f32_16x16x32_bf16 a[184:187], v[168:171], v[36:39], a[184:187]
    v_mfma_f32_16x16x32_bf16 a[188:191], v[172:175], v[36:39], a[188:191]
    v_mfma_f32_16x16x32_bf16 a[192:195], v[176:179], v[36:39], a[192:195]
    s_waitcnt vmcnt(20) lgkmcnt(3)
    v_mfma_f32_16x16x32_bf16 v[68:71], v[180:183], v[208:211], v[68:71]
    s_waitcnt vmcnt(19)
    v_mfma_f32_16x16x32_bf16 v[72:75], v[184:187], v[208:211], v[72:75]
    s_add_u32 s40, s8, 71680
    buffer_load_dwordx4 v[152:155], v3, s[4:7], s40 offen offset:0 sc1
    s_waitcnt vmcnt(19)
    v_mfma_f32_16x16x32_bf16 v[76:79], v[188:191], v[208:211], v[76:79]
    s_waitcnt vmcnt(18)
    v_mfma_f32_16x16x32_bf16 v[80:83], v[192:195], v[208:211], v[80:83]
    buffer_load_dwordx4 v[156:159], v3, s[4:7], s40 offen offset:1024 sc1
    s_waitcnt vmcnt(18)
    v_mfma_f32_16x16x32_bf16 v[84:87], v[196:199], v[208:211], v[84:87]
    s_waitcnt vmcnt(17)
    v_mfma_f32_16x16x32_bf16 v[88:91], v[200:203], v[208:211], v[88:91]
    buffer_load_dwordx4 v[160:163], v3, s[4:7], s40 offen offset:2048 sc1
    s_waitcnt vmcnt(17)
    v_mfma_f32_16x16x32_bf16 v[92:95], v[204:207], v[208:211], v[92:95]
    s_waitcnt lgkmcnt(2)
    v_mfma_f32_16x16x32_bf16 a[112:115], v[180:183], v[212:215], a[112:115]
    buffer_load_dwordx4 v[164:167], v3, s[4:7], s40 offen offset:3072 sc1
    v_mfma_f32_16x16x32_bf16 a[116:119], v[184:187], v[212:215], a[116:119]
    v_mfma_f32_16x16x32_bf16 a[120:123], v[188:191], v[212:215], a[120:123]
    s_add_u32 s40, s8, 75776
    buffer_load_dwordx4 v[168:171], v3, s[4:7], s40 offen offset:0 sc1
    v_mfma_f32_16x16x32_bf16 a[124:127], v[192:195], v[212:215], a[124:127]
    v_mfma_f32_16x16x32_bf16 a[128:131], v[196:199], v[212:215], a[128:131]
    buffer_load_dwordx4 v[172:175], v3, s[4:7], s40 offen offset:1024 sc1
    v_mfma_f32_16x16x32_bf16 a[132:135], v[200:203], v[212:215], a[132:135]
    v_mfma_f32_16x16x32_bf16 a[136:139], v[204:207], v[212:215], a[136:139]
    buffer_load_dwordx4 v[176:179], v3, s[4:7], s40 offen offset:2048 sc1
    s_waitcnt lgkmcnt(1)
    v_mfma_f32_16x16x32_bf16 a[140:143], v[180:183], v[216:219], a[140:143]
    v_mfma_f32_16x16x32_bf16 a[144:147], v[184:187], v[216:219], a[144:147]
    ds_read_b128 v[24:27], v22 offset:16384
    v_mfma_f32_16x16x32_bf16 a[148:151], v[188:191], v[216:219], a[148:151]
    v_mfma_f32_16x16x32_bf16 a[152:155], v[192:195], v[216:219], a[152:155]
    ds_read_b128 v[28:31], v22 offset:18432
    v_mfma_f32_16x16x32_bf16 a[156:159], v[196:199], v[216:219], a[156:159]
    v_mfma_f32_16x16x32_bf16 a[160:163], v[200:203], v[216:219], a[160:163]
    ds_read_b128 v[32:35], v22 offset:20480
    v_mfma_f32_16x16x32_bf16 a[164:167], v[204:207], v[216:219], a[164:167]
    s_waitcnt lgkmcnt(3)
    v_mfma_f32_16x16x32_bf16 a[168:171], v[180:183], v[220:223], a[168:171]
    ds_read_b128 v[36:39], v22 offset:22528
    v_mfma_f32_16x16x32_bf16 a[172:175], v[184:187], v[220:223], a[172:175]
    v_mfma_f32_16x16x32_bf16 a[176:179], v[188:191], v[220:223], a[176:179]
    v_mfma_f32_16x16x32_bf16 a[180:183], v[192:195], v[220:223], a[180:183]
    v_mfma_f32_16x16x32_bf16 a[184:187], v[196:199], v[220:223], a[184:187]
    v_mfma_f32_16x16x32_bf16 a[188:191], v[200:203], v[220:223], a[188:191]
    v_mfma_f32_16x16x32_bf16 a[192:195], v[204:207], v[220:223], a[192:195]
    s_waitcnt vmcnt(20) lgkmcnt(3)
    v_mfma_f32_16x16x32_bf16 v[68:71], v[96:99], v[24:27], v[68:71]
    s_waitcnt vmcnt(19)
    v_mfma_f32_16x16x32_bf16 v[72:75], v[100:103], v[24:27], v[72:75]
    s_add_u32 s40, s8, 78848
    buffer_load_dwordx4 v[180:183], v3, s[4:7], s40 offen offset:0 sc1
    s_waitcnt vmcnt(19)
    v_mfma_f32_16x16x32_bf16 v[76:79], v[104:107], v[24:27], v[76:79]
    s_waitcnt vmcnt(18)
    v_mfma_f32_16x16x32_bf16 v[80:83], v[108:111], v[24:27], v[80:83]
    buffer_load_dwordx4 v[184:187], v3, s[4:7], s40 offen offset:1024 sc1
    s_waitcnt vmcnt(18)
    v_mfma_f32_16x16x32_bf16 v[84:87], v[112:115], v[24:27], v[84:87]
    s_waitcnt vmcnt(17)
    v_mfma_f32_16x16x32_bf16 v[88:91], v[116:119], v[24:27], v[88:91]
    buffer_load_dwordx4 v[188:191], v3, s[4:7], s40 offen offset:2048 sc1
    s_waitcnt vmcnt(17)
    v_mfma_f32_16x16x32_bf16 v[92:95], v[120:123], v[24:27], v[92:95]
    s_waitcnt lgkmcnt(2)
    v_mfma_f32_16x16x32_bf16 a[112:115], v[96:99], v[28:31], a[112:115]
    buffer_load_dwordx4 v[192:195], v3, s[4:7], s40 offen offset:3072 sc1
    v_mfma_f32_16x16x32_bf16 a[116:119], v[100:103], v[28:31], a[116:119]
    v_mfma_f32_16x16x32_bf16 a[120:123], v[104:107], v[28:31], a[120:123]
    s_add_u32 s40, s8, 82944
    buffer_load_dwordx4 v[196:199], v3, s[4:7], s40 offen offset:0 sc1
    v_mfma_f32_16x16x32_bf16 a[124:127], v[108:111], v[28:31], a[124:127]
    v_mfma_f32_16x16x32_bf16 a[128:131], v[112:115], v[28:31], a[128:131]
    buffer_load_dwordx4 v[200:203], v3, s[4:7], s40 offen offset:1024 sc1
    v_mfma_f32_16x16x32_bf16 a[132:135], v[116:119], v[28:31], a[132:135]
    v_mfma_f32_16x16x32_bf16 a[136:139], v[120:123], v[28:31], a[136:139]
    buffer_load_dwordx4 v[204:207], v3, s[4:7], s40 offen offset:2048 sc1
    s_waitcnt lgkmcnt(1)
    v_mfma_f32_16x16x32_bf16 a[140:143], v[96:99], v[32:35], a[140:143]
    v_mfma_f32_16x16x32_bf16 a[144:147], v[100:103], v[32:35], a[144:147]
    ds_read_b128 v[208:211], v23 offset:16384
    v_mfma_f32_16x16x32_bf16 a[148:151], v[104:107], v[32:35], a[148:151]
    v_mfma_f32_16x16x32_bf16 a[152:155], v[108:111], v[32:35], a[152:155]
    ds_read_b128 v[212:215], v23 offset:18432
    v_mfma_f32_16x16x32_bf16 a[156:159], v[112:115], v[32:35], a[156:159]
    v_mfma_f32_16x16x32_bf16 a[160:163], v[116:119], v[32:35], a[160:163]
    ds_read_b128 v[216:219], v23 offset:20480
    v_mfma_f32_16x16x32_bf16 a[164:167], v[120:123], v[32:35], a[164:167]
    s_waitcnt lgkmcnt(3)
    v_mfma_f32_16x16x32_bf16 a[168:171], v[96:99], v[36:39], a[168:171]
    ds_read_b128 v[220:223], v23 offset:22528
    v_mfma_f32_16x16x32_bf16 a[172:175], v[100:103], v[36:39], a[172:175]
    v_mfma_f32_16x16x32_bf16 a[176:179], v[104:107], v[36:39], a[176:179]
    v_mfma_f32_16x16x32_bf16 a[180:183], v[108:111], v[36:39], a[180:183]
    v_mfma_f32_16x16x32_bf16 a[184:187], v[112:115], v[36:39], a[184:187]
    v_mfma_f32_16x16x32_bf16 a[188:191], v[116:119], v[36:39], a[188:191]
    v_mfma_f32_16x16x32_bf16 a[192:195], v[120:123], v[36:39], a[192:195]
    s_waitcnt vmcnt(20) lgkmcnt(3)
    v_mfma_f32_16x16x32_bf16 v[68:71], v[124:127], v[208:211], v[68:71]
    s_waitcnt vmcnt(19)
    v_mfma_f32_16x16x32_bf16 v[72:75], v[128:131], v[208:211], v[72:75]
    s_add_u32 s40, s8, 86016
    buffer_load_dwordx4 v[96:99], v3, s[4:7], s40 offen offset:0 sc1
    s_waitcnt vmcnt(19)
    v_mfma_f32_16x16x32_bf16 v[76:79], v[132:135], v[208:211], v[76:79]
    s_waitcnt vmcnt(18)
    v_mfma_f32_16x16x32_bf16 v[80:83], v[136:139], v[208:211], v[80:83]
    buffer_load_dwordx4 v[100:103], v3, s[4:7], s40 offen offset:1024 sc1
    s_waitcnt vmcnt(18)
    v_mfma_f32_16x16x32_bf16 v[84:87], v[140:143], v[208:211], v[84:87]
    s_waitcnt vmcnt(17)
    v_mfma_f32_16x16x32_bf16 v[88:91], v[144:147], v[208:211], v[88:91]
    buffer_load_dwordx4 v[104:107], v3, s[4:7], s40 offen offset:2048 sc1
    s_waitcnt vmcnt(17)
    v_mfma_f32_16x16x32_bf16 v[92:95], v[148:151], v[208:211], v[92:95]
    s_waitcnt lgkmcnt(2)
    v_mfma_f32_16x16x32_bf16 a[112:115], v[124:127], v[212:215], a[112:115]
    buffer_load_dwordx4 v[108:111], v3, s[4:7], s40 offen offset:3072 sc1
    v_mfma_f32_16x16x32_bf16 a[116:119], v[128:131], v[212:215], a[116:119]
    v_mfma_f32_16x16x32_bf16 a[120:123], v[132:135], v[212:215], a[120:123]
    s_add_u32 s40, s8, 90112
    buffer_load_dwordx4 v[112:115], v3, s[4:7], s40 offen offset:0 sc1
    v_mfma_f32_16x16x32_bf16 a[124:127], v[136:139], v[212:215], a[124:127]
    v_mfma_f32_16x16x32_bf16 a[128:131], v[140:143], v[212:215], a[128:131]
    buffer_load_dwordx4 v[116:119], v3, s[4:7], s40 offen offset:1024 sc1
    v_mfma_f32_16x16x32_bf16 a[132:135], v[144:147], v[212:215], a[132:135]
    v_mfma_f32_16x16x32_bf16 a[136:139], v[148:151], v[212:215], a[136:139]
    buffer_load_dwordx4 v[120:123], v3, s[4:7], s40 offen offset:2048 sc1
    s_waitcnt lgkmcnt(1)
    v_mfma_f32_16x16x32_bf16 a[140:143], v[124:127], v[216:219], a[140:143]
    v_mfma_f32_16x16x32_bf16 a[144:147], v[128:131], v[216:219], a[144:147]
    v_mfma_f32_16x16x32_bf16 a[148:151], v[132:135], v[216:219], a[148:151]
    v_mfma_f32_16x16x32_bf16 a[152:155], v[136:139], v[216:219], a[152:155]
    v_mfma_f32_16x16x32_bf16 a[156:159], v[140:143], v[216:219], a[156:159]
    v_mfma_f32_16x16x32_bf16 a[160:163], v[144:147], v[216:219], a[160:163]
    v_mfma_f32_16x16x32_bf16 a[164:167], v[148:151], v[216:219], a[164:167]
    s_waitcnt lgkmcnt(0)
    v_mfma_f32_16x16x32_bf16 a[168:171], v[124:127], v[220:223], a[168:171]
    v_mfma_f32_16x16x32_bf16 a[172:175], v[128:131], v[220:223], a[172:175]
    v_mfma_f32_16x16x32_bf16 a[176:179], v[132:135], v[220:223], a[176:179]
    v_mfma_f32_16x16x32_bf16 a[180:183], v[136:139], v[220:223], a[180:183]
    v_mfma_f32_16x16x32_bf16 a[184:187], v[140:143], v[220:223], a[184:187]
    v_mfma_f32_16x16x32_bf16 a[188:191], v[144:147], v[220:223], a[188:191]
    v_mfma_f32_16x16x32_bf16 a[192:195], v[148:151], v[220:223], a[192:195]
    s_waitcnt vmcnt(20)
    v_mfma_f32_16x16x32_bf16 v[68:71], v[152:155], a[0:3], v[68:71]
    s_waitcnt vmcnt(19)
    v_mfma_f32_16x16x32_bf16 v[72:75], v[156:159], a[0:3], v[72:75]
    s_add_u32 s40, s8, 93184
    buffer_load_dwordx4 v[124:127], v3, s[4:7], s40 offen offset:0 sc1
    s_waitcnt vmcnt(19)
    v_mfma_f32_16x16x32_bf16 v[76:79], v[160:163], a[0:3], v[76:79]
    s_waitcnt vmcnt(18)
    v_mfma_f32_16x16x32_bf16 v[80:83], v[164:167], a[0:3], v[80:83]
    buffer_load_dwordx4 v[128:131], v3, s[4:7], s40 offen offset:1024 sc1
    s_waitcnt vmcnt(18)
    v_mfma_f32_16x16x32_bf16 v[84:87], v[168:171], a[0:3], v[84:87]
    s_waitcnt vmcnt(17)
    v_mfma_f32_16x16x32_bf16 v[88:91], v[172:175], a[0:3], v[88:91]
    buffer_load_dwordx4 v[132:135], v3, s[4:7], s40 offen offset:2048 sc1
    s_waitcnt vmcnt(17)
    v_mfma_f32_16x16x32_bf16 v[92:95], v[176:179], a[0:3], v[92:95]
    v_mfma_f32_16x16x32_bf16 a[112:115], v[152:155], a[4:7], a[112:115]
    buffer_load_dwordx4 v[136:139], v3, s[4:7], s40 offen offset:3072 sc1
    v_mfma_f32_16x16x32_bf16 a[116:119], v[156:159], a[4:7], a[116:119]
    v_mfma_f32_16x16x32_bf16 a[120:123], v[160:163], a[4:7], a[120:123]
    s_add_u32 s40, s8, 97280
    buffer_load_dwordx4 v[140:143], v3, s[4:7], s40 offen offset:0 sc1
    v_mfma_f32_16x16x32_bf16 a[124:127], v[164:167], a[4:7], a[124:127]
    v_mfma_f32_16x16x32_bf16 a[128:131], v[168:171], a[4:7], a[128:131]
    buffer_load_dwordx4 v[144:147], v3, s[4:7], s40 offen offset:1024 sc1
    v_mfma_f32_16x16x32_bf16 a[132:135], v[172:175], a[4:7], a[132:135]
    v_mfma_f32_16x16x32_bf16 a[136:139], v[176:179], a[4:7], a[136:139]
    buffer_load_dwordx4 v[148:151], v3, s[4:7], s40 offen offset:2048 sc1
    v_mfma_f32_16x16x32_bf16 a[140:143], v[152:155], a[8:11], a[140:143]
    v_mfma_f32_16x16x32_bf16 a[144:147], v[156:159], a[8:11], a[144:147]
    v_mfma_f32_16x16x32_bf16 a[148:151], v[160:163], a[8:11], a[148:151]
    v_mfma_f32_16x16x32_bf16 a[152:155], v[164:167], a[8:11], a[152:155]
    v_mfma_f32_16x16x32_bf16 a[156:159], v[168:171], a[8:11], a[156:159]
    v_mfma_f32_16x16x32_bf16 a[160:163], v[172:175], a[8:11], a[160:163]
    v_mfma_f32_16x16x32_bf16 a[164:167], v[176:179], a[8:11], a[164:167]
    v_mfma_f32_16x16x32_bf16 a[168:171], v[152:155], a[12:15], a[168:171]
    v_mfma_f32_16x16x32_bf16 a[172:175], v[156:159], a[12:15], a[172:175]
    v_mfma_f32_16x16x32_bf16 a[176:179], v[160:163], a[12:15], a[176:179]
    v_mfma_f32_16x16x32_bf16 a[180:183], v[164:167], a[12:15], a[180:183]
    v_mfma_f32_16x16x32_bf16 a[184:187], v[168:171], a[12:15], a[184:187]
    v_mfma_f32_16x16x32_bf16 a[188:191], v[172:175], a[12:15], a[188:191]
    v_mfma_f32_16x16x32_bf16 a[192:195], v[176:179], a[12:15], a[192:195]
    s_waitcnt vmcnt(20)
    v_mfma_f32_16x16x32_bf16 v[68:71], v[180:183], a[16:19], v[68:71]
    s_waitcnt vmcnt(19)
    v_mfma_f32_16x16x32_bf16 v[72:75], v[184:187], a[16:19], v[72:75]
    s_add_u32 s40, s8, 100352
    buffer_load_dwordx4 v[152:155], v3, s[4:7], s40 offen offset:0 sc1
    s_waitcnt vmcnt(19)
    v_mfma_f32_16x16x32_bf16 v[76:79], v[188:191], a[16:19], v[76:79]
    s_waitcnt vmcnt(18)
    v_mfma_f32_16x16x32_bf16 v[80:83], v[192:195], a[16:19], v[80:83]
    buffer_load_dwordx4 v[156:159], v3, s[4:7], s40 offen offset:1024 sc1
    s_waitcnt vmcnt(18)
    v_mfma_f32_16x16x32_bf16 v[84:87], v[196:199], a[16:19], v[84:87]
    s_waitcnt vmcnt(17)
    v_mfma_f32_16x16x32_bf16 v[88:91], v[200:203], a[16:19], v[88:91]
    buffer_load_dwordx4 v[160:163], v3, s[4:7], s40 offen offset:2048 sc1
    s_waitcnt vmcnt(17)
    v_mfma_f32_16x16x32_bf16 v[92:95], v[204:207], a[16:19], v[92:95]
    v_mfma_f32_16x16x32_bf16 a[112:115], v[180:183], a[20:23], a[112:115]
    buffer_load_dwordx4 v[164:167], v3, s[4:7], s40 offen offset:3072 sc1
    v_mfma_f32_16x16x32_bf16 a[116:119], v[184:187], a[20:23], a[116:119]
    v_mfma_f32_16x16x32_bf16 a[120:123], v[188:191], a[20:23], a[120:123]
    s_add_u32 s40, s8, 104448
    buffer_load_dwordx4 v[168:171], v3, s[4:7], s40 offen offset:0 sc1
    v_mfma_f32_16x16x32_bf16 a[124:127], v[192:195], a[20:23], a[124:127]
    v_mfma_f32_16x16x32_bf16 a[128:131], v[196:199], a[20:23], a[128:131]
    buffer_load_dwordx4 v[172:175], v3, s[4:7], s40 offen offset:1024 sc1
    v_mfma_f32_16x16x32_bf16 a[132:135], v[200:203], a[20:23], a[132:135]
    v_mfma_f32_16x16x32_bf16 a[136:139], v[204:207], a[20:23], a[136:139]
    buffer_load_dwordx4 v[176:179], v3, s[4:7], s40 offen offset:2048 sc1
    v_mfma_f32_16x16x32_bf16 a[140:143], v[180:183], a[24:27], a[140:143]
    v_mfma_f32_16x16x32_bf16 a[144:147], v[184:187], a[24:27], a[144:147]
    v_mfma_f32_16x16x32_bf16 a[148:151], v[188:191], a[24:27], a[148:151]
    v_mfma_f32_16x16x32_bf16 a[152:155], v[192:195], a[24:27], a[152:155]
    v_mfma_f32_16x16x32_bf16 a[156:159], v[196:199], a[24:27], a[156:159]
    v_mfma_f32_16x16x32_bf16 a[160:163], v[200:203], a[24:27], a[160:163]
    v_mfma_f32_16x16x32_bf16 a[164:167], v[204:207], a[24:27], a[164:167]
    v_mfma_f32_16x16x32_bf16 a[168:171], v[180:183], a[28:31], a[168:171]
    v_mfma_f32_16x16x32_bf16 a[172:175], v[184:187], a[28:31], a[172:175]
    v_mfma_f32_16x16x32_bf16 a[176:179], v[188:191], a[28:31], a[176:179]
    v_mfma_f32_16x16x32_bf16 a[180:183], v[192:195], a[28:31], a[180:183]
    v_mfma_f32_16x16x32_bf16 a[184:187], v[196:199], a[28:31], a[184:187]
    v_mfma_f32_16x16x32_bf16 a[188:191], v[200:203], a[28:31], a[188:191]
    v_mfma_f32_16x16x32_bf16 a[192:195], v[204:207], a[28:31], a[192:195]
    s_waitcnt vmcnt(20)
    v_mfma_f32_16x16x32_bf16 v[68:71], v[96:99], a[32:35], v[68:71]
    s_waitcnt vmcnt(19)
    v_mfma_f32_16x16x32_bf16 v[72:75], v[100:103], a[32:35], v[72:75]
    s_add_u32 s40, s8, 107520
    buffer_load_dwordx4 v[180:183], v3, s[4:7], s40 offen offset:0 sc1
    s_waitcnt vmcnt(19)
    v_mfma_f32_16x16x32_bf16 v[76:79], v[104:107], a[32:35], v[76:79]
    s_waitcnt vmcnt(18)
    v_mfma_f32_16x16x32_bf16 v[80:83], v[108:111], a[32:35], v[80:83]
    buffer_load_dwordx4 v[184:187], v3, s[4:7], s40 offen offset:1024 sc1
    s_waitcnt vmcnt(18)
    v_mfma_f32_16x16x32_bf16 v[84:87], v[112:115], a[32:35], v[84:87]
    s_waitcnt vmcnt(17)
    v_mfma_f32_16x16x32_bf16 v[88:91], v[116:119], a[32:35], v[88:91]
    buffer_load_dwordx4 v[188:191], v3, s[4:7], s40 offen offset:2048 sc1
    s_waitcnt vmcnt(17)
    v_mfma_f32_16x16x32_bf16 v[92:95], v[120:123], a[32:35], v[92:95]
    v_mfma_f32_16x16x32_bf16 a[112:115], v[96:99], a[36:39], a[112:115]
    buffer_load_dwordx4 v[192:195], v3, s[4:7], s40 offen offset:3072 sc1
    v_mfma_f32_16x16x32_bf16 a[116:119], v[100:103], a[36:39], a[116:119]
    v_mfma_f32_16x16x32_bf16 a[120:123], v[104:107], a[36:39], a[120:123]
    s_add_u32 s40, s8, 111616
    buffer_load_dwordx4 v[196:199], v3, s[4:7], s40 offen offset:0 sc1
    v_mfma_f32_16x16x32_bf16 a[124:127], v[108:111], a[36:39], a[124:127]
    v_mfma_f32_16x16x32_bf16 a[128:131], v[112:115], a[36:39], a[128:131]
    buffer_load_dwordx4 v[200:203], v3, s[4:7], s40 offen offset:1024 sc1
    v_mfma_f32_16x16x32_bf16 a[132:135], v[116:119], a[36:39], a[132:135]
    v_mfma_f32_16x16x32_bf16 a[136:139], v[120:123], a[36:39], a[136:139]
    buffer_load_dwordx4 v[204:207], v3, s[4:7], s40 offen offset:2048 sc1
    v_mfma_f32_16x16x32_bf16 a[140:143], v[96:99], a[40:43], a[140:143]
    v_mfma_f32_16x16x32_bf16 a[144:147], v[100:103], a[40:43], a[144:147]
    v_mfma_f32_16x16x32_bf16 a[148:151], v[104:107], a[40:43], a[148:151]
    v_mfma_f32_16x16x32_bf16 a[152:155], v[108:111], a[40:43], a[152:155]
    v_mfma_f32_16x16x32_bf16 a[156:159], v[112:115], a[40:43], a[156:159]
    v_mfma_f32_16x16x32_bf16 a[160:163], v[116:119], a[40:43], a[160:163]
    v_mfma_f32_16x16x32_bf16 a[164:167], v[120:123], a[40:43], a[164:167]
    v_mfma_f32_16x16x32_bf16 a[168:171], v[96:99], a[44:47], a[168:171]
    v_mfma_f32_16x16x32_bf16 a[172:175], v[100:103], a[44:47], a[172:175]
    v_mfma_f32_16x16x32_bf16 a[176:179], v[104:107], a[44:47], a[176:179]
    v_mfma_f32_16x16x32_bf16 a[180:183], v[108:111], a[44:47], a[180:183]
    v_mfma_f32_16x16x32_bf16 a[184:187], v[112:115], a[44:47], a[184:187]
    v_mfma_f32_16x16x32_bf16 a[188:191], v[116:119], a[44:47], a[188:191]
    v_mfma_f32_16x16x32_bf16 a[192:195], v[120:123], a[44:47], a[192:195]
    s_waitcnt vmcnt(20)
    v_mfma_f32_16x16x32_bf16 v[68:71], v[124:127], a[48:51], v[68:71]
    s_waitcnt vmcnt(19)
    v_mfma_f32_16x16x32_bf16 v[72:75], v[128:131], a[48:51], v[72:75]
    s_waitcnt vmcnt(18)
    v_mfma_f32_16x16x32_bf16 v[76:79], v[132:135], a[48:51], v[76:79]
    s_waitcnt vmcnt(17)
    v_mfma_f32_16x16x32_bf16 v[80:83], v[136:139], a[48:51], v[80:83]
    s_waitcnt vmcnt(16)
    v_mfma_f32_16x16x32_bf16 v[84:87], v[140:143], a[48:51], v[84:87]
    s_waitcnt vmcnt(15)
    v_mfma_f32_16x16x32_bf16 v[88:91], v[144:147], a[48:51], v[88:91]
    s_waitcnt vmcnt(14)
    v_mfma_f32_16x16x32_bf16 v[92:95], v[148:151], a[48:51], v[92:95]
    v_mfma_f32_16x16x32_bf16 a[112:115], v[124:127], a[52:55], a[112:115]
    v_mfma_f32_16x16x32_bf16 a[116:119], v[128:131], a[52:55], a[116:119]
    v_mfma_f32_16x16x32_bf16 a[120:123], v[132:135], a[52:55], a[120:123]
    v_mfma_f32_16x16x32_bf16 a[124:127], v[136:139], a[52:55], a[124:127]
    v_mfma_f32_16x16x32_bf16 a[128:131], v[140:143], a[52:55], a[128:131]
    v_mfma_f32_16x16x32_bf16 a[132:135], v[144:147], a[52:55], a[132:135]
    v_mfma_f32_16x16x32_bf16 a[136:139], v[148:151], a[52:55], a[136:139]
    v_mfma_f32_16x16x32_bf16 a[140:143], v[124:127], a[56:59], a[140:143]
    v_mfma_f32_16x16x32_bf16 a[144:147], v[128:131], a[56:59], a[144:147]
    v_mfma_f32_16x16x32_bf16 a[148:151], v[132:135], a[56:59], a[148:151]
    v_mfma_f32_16x16x32_bf16 a[152:155], v[136:139], a[56:59], a[152:155]
    v_mfma_f32_16x16x32_bf16 a[156:159], v[140:143], a[56:59], a[156:159]
    v_mfma_f32_16x16x32_bf16 a[160:163], v[144:147], a[56:59], a[160:163]
    v_mfma_f32_16x16x32_bf16 a[164:167], v[148:151], a[56:59], a[164:167]
    v_mfma_f32_16x16x32_bf16 a[168:171], v[124:127], a[60:63], a[168:171]
    v_mfma_f32_16x16x32_bf16 a[172:175], v[128:131], a[60:63], a[172:175]
    v_mfma_f32_16x16x32_bf16 a[176:179], v[132:135], a[60:63], a[176:179]
    v_mfma_f32_16x16x32_bf16 a[180:183], v[136:139], a[60:63], a[180:183]
    v_mfma_f32_16x16x32_bf16 a[184:187], v[140:143], a[60:63], a[184:187]
    v_mfma_f32_16x16x32_bf16 a[188:191], v[144:147], a[60:63], a[188:191]
    v_mfma_f32_16x16x32_bf16 a[192:195], v[148:151], a[60:63], a[192:195]
    s_waitcnt vmcnt(13)
    v_mfma_f32_16x16x32_bf16 v[68:71], v[152:155], a[64:67], v[68:71]
    s_waitcnt vmcnt(12)
    v_mfma_f32_16x16x32_bf16 v[72:75], v[156:159], a[64:67], v[72:75]
    s_waitcnt vmcnt(11)
    v_mfma_f32_16x16x32_bf16 v[76:79], v[160:163], a[64:67], v[76:79]
    s_waitcnt vmcnt(10)
    v_mfma_f32_16x16x32_bf16 v[80:83], v[164:167], a[64:67], v[80:83]
    s_waitcnt vmcnt(9)
    v_mfma_f32_16x16x32_bf16 v[84:87], v[168:171], a[64:67], v[84:87]
    s_waitcnt vmcnt(8)
    v_mfma_f32_16x16x32_bf16 v[88:91], v[172:175], a[64:67], v[88:91]
    s_waitcnt vmcnt(7)
    v_mfma_f32_16x16x32_bf16 v[92:95], v[176:179], a[64:67], v[92:95]
    v_mfma_f32_16x16x32_bf16 a[112:115], v[152:155], a[68:71], a[112:115]
    v_mfma_f32_16x16x32_bf16 a[116:119], v[156:159], a[68:71], a[116:119]
    v_mfma_f32_16x16x32_bf16 a[120:123], v[160:163], a[68:71], a[120:123]
    v_mfma_f32_16x16x32_bf16 a[124:127], v[164:167], a[68:71], a[124:127]
    v_mfma_f32_16x16x32_bf16 a[128:131], v[168:171], a[68:71], a[128:131]
    v_mfma_f32_16x16x32_bf16 a[132:135], v[172:175], a[68:71], a[132:135]
    v_mfma_f32_16x16x32_bf16 a[136:139], v[176:179], a[68:71], a[136:139]
    v_mfma_f32_16x16x32_bf16 a[140:143], v[152:155], a[72:75], a[140:143]
    v_mfma_f32_16x16x32_bf16 a[144:147], v[156:159], a[72:75], a[144:147]
    v_mfma_f32_16x16x32_bf16 a[148:151], v[160:163], a[72:75], a[148:151]
    v_mfma_f32_16x16x32_bf16 a[152:155], v[164:167], a[72:75], a[152:155]
    v_mfma_f32_16x16x32_bf16 a[156:159], v[168:171], a[72:75], a[156:159]
    v_mfma_f32_16x16x32_bf16 a[160:163], v[172:175], a[72:75], a[160:163]
    v_mfma_f32_16x16x32_bf16 a[164:167], v[176:179], a[72:75], a[164:167]
    v_mfma_f32_16x16x32_bf16 a[168:171], v[152:155], a[76:79], a[168:171]
    v_mfma_f32_16x16x32_bf16 a[172:175], v[156:159], a[76:79], a[172:175]
    v_mfma_f32_16x16x32_bf16 a[176:179], v[160:163], a[76:79], a[176:179]
    v_mfma_f32_16x16x32_bf16 a[180:183], v[164:167], a[76:79], a[180:183]
    v_mfma_f32_16x16x32_bf16 a[184:187], v[168:171], a[76:79], a[184:187]
    v_mfma_f32_16x16x32_bf16 a[188:191], v[172:175], a[76:79], a[188:191]
    v_mfma_f32_16x16x32_bf16 a[192:195], v[176:179], a[76:79], a[192:195]
    s_waitcnt vmcnt(6)
    v_mfma_f32_16x16x32_bf16 v[68:71], v[180:183], a[80:83], v[68:71]
    s_waitcnt vmcnt(5)
    v_mfma_f32_16x16x32_bf16 v[72:75], v[184:187], a[80:83], v[72:75]
    s_waitcnt vmcnt(4)
    v_mfma_f32_16x16x32_bf16 v[76:79], v[188:191], a[80:83], v[76:79]
    s_waitcnt vmcnt(3)
    v_mfma_f32_16x16x32_bf16 v[80:83], v[192:195], a[80:83], v[80:83]
    s_waitcnt vmcnt(2)
    v_mfma_f32_16x16x32_bf16 v[84:87], v[196:199], a[80:83], v[84:87]
    s_waitcnt vmcnt(1)
    v_mfma_f32_16x16x32_bf16 v[88:91], v[200:203], a[80:83], v[88:91]
    s_waitcnt vmcnt(0)
    v_mfma_f32_16x16x32_bf16 v[92:95], v[204:207], a[80:83], v[92:95]
    v_mfma_f32_16x16x32_bf16 a[112:115], v[180:183], a[84:87], a[112:115]
    v_mfma_f32_16x16x32_bf16 a[116:119], v[184:187], a[84:87], a[116:119]
    v_mfma_f32_16x16x32_bf16 a[120:123], v[188:191], a[84:87], a[120:123]
    v_mfma_f32_16x16x32_bf16 a[124:127], v[192:195], a[84:87], a[124:127]
    v_mfma_f32_16x16x32_bf16 a[128:131], v[196:199], a[84:87], a[128:131]
    v_mfma_f32_16x16x32_bf16 a[132:135], v[200:203], a[84:87], a[132:135]
    v_mfma_f32_16x16x32_bf16 a[136:139], v[204:207], a[84:87], a[136:139]
    v_mfma_f32_16x16x32_bf16 a[140:143], v[180:183], a[88:91], a[140:143]
    v_mfma_f32_16x16x32_bf16 a[144:147], v[184:187], a[88:91], a[144:147]
    v_mfma_f32_16x16x32_bf16 a[148:151], v[188:191], a[88:91], a[148:151]
    v_mfma_f32_16x16x32_bf16 a[152:155], v[192:195], a[88:91], a[152:155]
    v_mfma_f32_16x16x32_bf16 a[156:159], v[196:199], a[88:91], a[156:159]
    v_mfma_f32_16x16x32_bf16 a[160:163], v[200:203], a[88:91], a[160:163]
    v_mfma_f32_16x16x32_bf16 a[164:167], v[204:207], a[88:91], a[164:167]
    v_mfma_f32_16x16x32_bf16 a[168:171], v[180:183], a[92:95], a[168:171]
    v_mfma_f32_16x16x32_bf16 a[172:175], v[184:187], a[92:95], a[172:175]
    v_mfma_f32_16x16x32_bf16 a[176:179], v[188:191], a[92:95], a[176:179]
    v_mfma_f32_16x16x32_bf16 a[180:183], v[192:195], a[92:95], a[180:183]
    v_mfma_f32_16x16x32_bf16 a[184:187], v[196:199], a[92:95], a[184:187]
    v_mfma_f32_16x16x32_bf16 a[188:191], v[200:203], a[92:95], a[188:191]
    v_mfma_f32_16x16x32_bf16 a[192:195], v[204:207], a[92:95], a[192:195]
    s_min_u32 s8, s57, 13
    s_mul_i32 s8, s8, 57344
    s_add_u32 s8, s8, 17838080
    s_cmp_lt_u32 s57, 14
    s_cselect_b32 s8, s8, 2130706432
    v_lshrrev_b32 v11, 5, v1
    v_lshlrev_b32 v11, 4, v11
    s_min_u32 s39, s57, 13
    s_lshl_b32 s39, s39, 7
    v_add_u32 v11, s39, v11
    s_mov_b32 s9, 13056
    s_mov_b32 s10, 13088
    s_mov_b32 s11, 13120
    s_mov_b32 s12, 13152
    buffer_load_dwordx4 v[12:15], v11, s[4:7], s9 offen sc1
    buffer_load_dwordx4 v[16:19], v11, s[4:7], s10 offen sc1
    buffer_load_dwordx4 v[20:23], v11, s[4:7], s11 offen sc1
    buffer_load_dwordx4 v[24:27], v11, s[4:7], s12 offen sc1
    v_add_u32 v28, s19, v3
    ds_write_b128 v28, a[112:115] offset:0
    buffer_load_dwordx4 a[0:3], v3, s[4:7], s8 offen offset:3072 sc1
    ds_write_b128 v28, a[116:119] offset:1024
    ds_write_b128 v28, a[120:123] offset:2048
    s_add_u32 s8, s8, 4096
    buffer_load_dwordx4 a[4:7], v3, s[4:7], s8 offen offset:0 sc1
    ds_write_b128 v28, a[124:127] offset:3072
    ds_write_b128 v28, a[128:131] offset:4096
    buffer_load_dwordx4 a[8:11], v3, s[4:7], s8 offen offset:1024 sc1
    ds_write_b128 v28, a[132:135] offset:5120
    ds_write_b128 v28, a[136:139] offset:6144
    buffer_load_dwordx4 a[12:15], v3, s[4:7], s8 offen offset:2048 sc1
    ds_write_b128 v28, a[140:143] offset:7168
    buffer_load_dwordx4 a[16:19], v3, s[4:7], s8 offen offset:3072 sc1
    ds_write_b128 v28, a[144:147] offset:8192
    ds_write_b128 v28, a[148:151] offset:9216
    s_add_u32 s8, s8, 4096
    buffer_load_dwordx4 a[20:23], v3, s[4:7], s8 offen offset:0 sc1
    ds_write_b128 v28, a[152:155] offset:10240
    ds_write_b128 v28, a[156:159] offset:11264
    buffer_load_dwordx4 a[24:27], v3, s[4:7], s8 offen offset:1024 sc1
    ds_write_b128 v28, a[160:163] offset:12288
    ds_write_b128 v28, a[164:167] offset:13312
    buffer_load_dwordx4 a[28:31], v3, s[4:7], s8 offen offset:2048 sc1
    ds_write_b128 v28, a[168:171] offset:14336
    buffer_load_dwordx4 a[32:35], v3, s[4:7], s8 offen offset:3072 sc1
    ds_write_b128 v28, a[172:175] offset:15360
    ds_write_b128 v28, a[176:179] offset:16384
    s_add_u32 s8, s8, 4096
    buffer_load_dwordx4 a[36:39], v3, s[4:7], s8 offen offset:0 sc1
    ds_write_b128 v28, a[180:183] offset:17408
    ds_write_b128 v28, a[184:187] offset:18432
    buffer_load_dwordx4 a[40:43], v3, s[4:7], s8 offen offset:1024 sc1
    ds_write_b128 v28, a[188:191] offset:19456
    ds_write_b128 v28, a[192:195] offset:20480
    buffer_load_dwordx4 a[44:47], v3, s[4:7], s8 offen offset:2048 sc1
    v_lshlrev_b32 v6, 3, v1
    s_mov_b32 s39, 98304
    v_add_u32 v6, s39, v6
    s_lshl_b32 s40, s30, 10
    v_add_u32 v7, s40, v6
    s_waitcnt lgkmcnt(0)
    s_barrier
    s_sub_u32 s39, s30, 1
    s_and_b32 s39, s39, 3
    s_mul_i32 s39, s39, 24576
    v_add_u32 v28, s39, v3
    ds_read_b128 v[96:99], v28 offset:0
    ds_read_b128 v[100:103], v28 offset:1024
    ds_read_b128 v[104:107], v28 offset:2048
    ds_read_b128 v[108:111], v28 offset:3072
    ds_read_b128 v[112:115], v28 offset:4096
    ds_read_b128 v[116:119], v28 offset:5120
    ds_read_b128 v[120:123], v28 offset:6144
    s_sub_u32 s39, s30, 2
    s_and_b32 s39, s39, 3
    s_mul_i32 s39, s39, 24576
    v_add_u32 v28, s39, v3
    ds_read_b128 v[124:127], v28 offset:7168
    ds_read_b128 v[128:131], v28 offset:8192
    ds_read_b128 v[132:135], v28 offset:9216
    ds_read_b128 v[136:139], v28 offset:10240
    ds_read_b128 v[140:143], v28 offset:11264
    ds_read_b128 v[144:147], v28 offset:12288
    ds_read_b128 v[148:151], v28 offset:13312
    s_sub_u32 s39, s30, 3
    s_and_b32 s39, s39, 3
    s_mul_i32 s39, s39, 24576
    v_add_u32 v28, s39, v3
    ds_read_b128 v[152:155], v28 offset:14336
    ds_read_b128 v[156:159], v28 offset:15360
    ds_read_b128 v[160:163], v28 offset:16384
    ds_read_b128 v[164:167], v28 offset:17408
    ds_read_b128 v[168:171], v28 offset:18432
    ds_read_b128 v[172:175], v28 offset:19456
    ds_read_b128 v[176:179], v28 offset:20480
    ds_write_b64 v7, v[52:53] offset:0
    ds_write_b64 v7, v[54:55] offset:3584
    ds_write_b64 v7, v[56:57] offset:7168
    ds_write_b64 v7, v[58:59] offset:10752
    s_cmp_ge_u32 s30, 3
    s_nop 0
    s_cbranch_scc1 L_z1skip_35
    ds_write_b64 v7, v[60:61] offset:512
    ds_write_b64 v7, v[62:63] offset:4096
    ds_write_b64 v7, v[64:65] offset:7680
    ds_write_b64 v7, v[66:67] offset:11264
L_z1skip_35:
    v_lshlrev_b32 v10, 16, v10
    v_mov_b32 v30, v10
    v_pk_add_f32 v[68:69], v[68:69], v[30:31] op_sel_hi:[1,0]
    v_pk_add_f32 v[70:71], v[70:71], v[30:31] op_sel_hi:[1,0]
    v_pk_add_f32 v[72:73], v[72:73], v[30:31] op_sel_hi:[1,0]
    v_pk_add_f32 v[74:75], v[74:75], v[30:31] op_sel_hi:[1,0]
    v_pk_add_f32 v[76:77], v[76:77], v[30:31] op_sel_hi:[1,0]
    v_pk_add_f32 v[78:79], v[78:79], v[30:31] op_sel_hi:[1,0]
    v_pk_add_f32 v[80:81], v[80:81], v[30:31] op_sel_hi:[1,0]
    v_pk_add_f32 v[82:83], v[82:83], v[30:31] op_sel_hi:[1,0]
    v_pk_add_f32 v[84:85], v[84:85], v[30:31] op_sel_hi:[1,0]
    v_pk_add_f32 v[86:87], v[86:87], v[30:31] op_sel_hi:[1,0]
    v_pk_add_f32 v[88:89], v[88:89], v[30:31] op_sel_hi:[1,0]
    v_pk_add_f32 v[90:91], v[90:91], v[30:31] op_sel_hi:[1,0]
    v_pk_add_f32 v[92:93], v[92:93], v[30:31] op_sel_hi:[1,0]
    v_pk_add_f32 v[94:95], v[94:95], v[30:31] op_sel_hi:[1,0]
    s_waitcnt lgkmcnt(15)
    v_pk_add_f32 v[68:69], v[68:69], v[96:97]
    buffer_load_dwordx4 a[48:51], v3, s[4:7], s8 offen offset:3072 sc1
    v_pk_add_f32 v[70:71], v[70:71], v[98:99]
    v_pk_add_f32 v[72:73], v[72:73], v[100:101]
    v_pk_add_f32 v[74:75], v[74:75], v[102:103]
    s_add_u32 s8, s8, 4096
    buffer_load_dwordx4 a[52:55], v3, s[4:7], s8 offen offset:0 sc1
    v_pk_add_f32 v[76:77], v[76:77], v[104:105]
    v_pk_add_f32 v[78:79], v[78:79], v[106:107]
    v_pk_add_f32 v[80:81], v[80:81], v[108:109]
    buffer_load_dwordx4 a[56:59], v3, s[4:7], s8 offen offset:1024 sc1
    v_pk_add_f32 v[82:83], v[82:83], v[110:111]
    v_pk_add_f32 v[84:85], v[84:85], v[112:113]
    v_pk_add_f32 v[86:87], v[86:87], v[114:115]
    buffer_load_dwordx4 a[60:63], v3, s[4:7], s8 offen offset:2048 sc1
    v_pk_add_f32 v[88:89], v[88:89], v[116:117]
    v_pk_add_f32 v[90:91], v[90:91], v[118:119]
    v_pk_add_f32 v[92:93], v[92:93], v[120:121]
    buffer_load_dwordx4 a[64:67], v3, s[4:7], s8 offen offset:3072 sc1
    v_pk_add_f32 v[94:95], v[94:95], v[122:123]
    v_pk_add_f32 v[68:69], v[68:69], v[124:125]
    s_add_u32 s8, s8, 4096
    buffer_load_dwordx4 a[68:71], v3, s[4:7], s8 offen offset:0 sc1
    v_pk_add_f32 v[70:71], v[70:71], v[126:127]
    v_pk_add_f32 v[72:73], v[72:73], v[128:129]
    v_pk_add_f32 v[74:75], v[74:75], v[130:131]
    buffer_load_dwordx4 a[72:75], v3, s[4:7], s8 offen offset:1024 sc1
    v_pk_add_f32 v[76:77], v[76:77], v[132:133]
    v_pk_add_f32 v[78:79], v[78:79], v[134:135]
    s_waitcnt lgkmcnt(14)
    v_pk_add_f32 v[80:81], v[80:81], v[136:137]
    buffer_load_dwordx4 a[76:79], v3, s[4:7], s8 offen offset:2048 sc1
    v_pk_add_f32 v[82:83], v[82:83], v[138:139]
    s_waitcnt lgkmcnt(13)
    v_pk_add_f32 v[84:85], v[84:85], v[140:141]
    v_pk_add_f32 v[86:87], v[86:87], v[142:143]
    buffer_load_dwordx4 a[80:83], v3, s[4:7], s8 offen offset:3072 sc1
    s_waitcnt lgkmcnt(12)
    v_pk_add_f32 v[88:89], v[88:89], v[144:145]
    v_pk_add_f32 v[90:91], v[90:91], v[146:147]
    s_waitcnt lgkmcnt(11)
    v_pk_add_f32 v[92:93], v[92:93], v[148:149]
    s_add_u32 s8, s8, 4096
    buffer_load_dwordx4 a[84:87], v3, s[4:7], s8 offen offset:0 sc1
    v_pk_add_f32 v[94:95], v[94:95], v[150:151]
    s_waitcnt lgkmcnt(10)
    v_pk_add_f32 v[68:69], v[68:69], v[152:153]
    buffer_load_dwordx4 a[88:91], v3, s[4:7], s8 offen offset:1024 sc1
    v_pk_add_f32 v[70:71], v[70:71], v[154:155]
    s_waitcnt lgkmcnt(9)
    v_pk_add_f32 v[72:73], v[72:73], v[156:157]
    v_pk_add_f32 v[74:75], v[74:75], v[158:159]
    buffer_load_dwordx4 a[92:95], v3, s[4:7], s8 offen offset:2048 sc1
    s_waitcnt lgkmcnt(8)
    v_pk_add_f32 v[76:77], v[76:77], v[160:161]
    v_pk_add_f32 v[78:79], v[78:79], v[162:163]
    s_waitcnt lgkmcnt(7)
    v_pk_add_f32 v[80:81], v[80:81], v[164:165]
    v_pk_add_f32 v[82:83], v[82:83], v[166:167]
    s_waitcnt lgkmcnt(6)
    v_pk_add_f32 v[84:85], v[84:85], v[168:169]
    v_pk_add_f32 v[86:87], v[86:87], v[170:171]
    s_waitcnt lgkmcnt(5)
    v_pk_add_f32 v[88:89], v[88:89], v[172:173]
    v_pk_add_f32 v[90:91], v[90:91], v[174:175]
    s_waitcnt lgkmcnt(4)
    v_pk_add_f32 v[92:93], v[92:93], v[176:177]
    v_pk_add_f32 v[94:95], v[94:95], v[178:179]
    s_waitcnt lgkmcnt(0)
    s_barrier
    s_mul_i32 s40, s30, 3584
    v_add_u32 v6, s40, v6
    ds_read_b64 v[52:53], v6 offset:0
    ds_read_b64 v[54:55], v6 offset:512
    ds_read_b64 v[56:57], v6 offset:1024
    ds_read_b64 v[58:59], v6 offset:1536
    ds_read_b64 v[60:61], v6 offset:2048
    ds_read_b64 v[62:63], v6 offset:2560
    ds_read_b64 v[64:65], v6 offset:3072
    s_waitcnt lgkmcnt(6)
    v_lshlrev_b32 v96, 16, v52
    v_and_b32 v97, s46, v52
    v_lshlrev_b32 v98, 16, v53
    v_and_b32 v99, s46, v53
    s_waitcnt lgkmcnt(5)
    v_lshlrev_b32 v100, 16, v54
    v_and_b32 v101, s46, v54
    v_lshlrev_b32 v102, 16, v55
    v_and_b32 v103, s46, v55
    s_waitcnt lgkmcnt(4)
    v_lshlrev_b32 v104, 16, v56
    v_and_b32 v105, s46, v56
    v_lshlrev_b32 v106, 16, v57
    v_and_b32 v107, s46, v57
    s_waitcnt lgkmcnt(3)
    v_lshlrev_b32 v108, 16, v58
    v_and_b32 v109, s46, v58
    v_lshlrev_b32 v110, 16, v59
    v_and_b32 v111, s46, v59
    s_waitcnt lgkmcnt(2)
    v_lshlrev_b32 v112, 16, v60
    v_and_b32 v113, s46, v60
    v_lshlrev_b32 v114, 16, v61
    v_and_b32 v115, s46, v61
    s_waitcnt lgkmcnt(1)
    v_lshlrev_b32 v116, 16, v62
    v_and_b32 v117, s46, v62
    v_lshlrev_b32 v118, 16, v63
    v_and_b32 v119, s46, v63
    s_waitcnt lgkmcnt(0)
    v_lshlrev_b32 v120, 16, v64
    v_and_b32 v121, s46, v64
    v_lshlrev_b32 v122, 16, v65
    v_and_b32 v123, s46, v65
    v_pk_mul_f32 v[68:69], v[68:69], v[96:97]
    v_pk_mul_f32 v[70:71], v[70:71], v[98:99]
    v_pk_mul_f32 v[72:73], v[72:73], v[100:101]
    v_pk_mul_f32 v[74:75], v[74:75], v[102:103]
    v_pk_mul_f32 v[76:77], v[76:77], v[104:105]
    v_pk_mul_f32 v[78:79], v[78:79], v[106:107]
    v_pk_mul_f32 v[80:81], v[80:81], v[108:109]
    v_pk_mul_f32 v[82:83], v[82:83], v[110:111]
    v_pk_mul_f32 v[84:85], v[84:85], v[112:113]
    v_pk_mul_f32 v[86:87], v[86:87], v[114:115]
    v_pk_mul_f32 v[88:89], v[88:89], v[116:117]
    v_pk_mul_f32 v[90:91], v[90:91], v[118:119]
    v_pk_mul_f32 v[92:93], v[92:93], v[120:121]
    v_pk_mul_f32 v[94:95], v[94:95], v[122:123]
    v_cvt_pk_bf16_f32 v124, v68, v69
    v_cvt_pk_bf16_f32 v125, v70, v71
    v_cvt_pk_bf16_f32 v126, v72, v73
    v_cvt_pk_bf16_f32 v127, v74, v75
    v_cvt_pk_bf16_f32 v128, v76, v77
    v_cvt_pk_bf16_f32 v129, v78, v79
    v_cvt_pk_bf16_f32 v130, v80, v81
    v_cvt_pk_bf16_f32 v131, v82, v83
    v_cvt_pk_bf16_f32 v132, v84, v85
    v_cvt_pk_bf16_f32 v133, v86, v87
    v_cvt_pk_bf16_f32 v134, v88, v89
    v_cvt_pk_bf16_f32 v135, v90, v91
    v_cvt_pk_bf16_f32 v136, v92, v93
    v_cvt_pk_bf16_f32 v137, v94, v95
    v_bfe_u32 v6, v1, 4, 1
    v_lshlrev_b32 v28, 10, v6
    v_lshrrev_b32 v6, 5, v1
    v_lshl_add_u32 v28, v6, 9, v28
    v_and_b32 v6, 15, v1
    s_and_b32 s39, s30, 1
    s_lshl_b32 s39, s39, 4
    v_add_u32 v6, s39, v6
    v_lshl_add_u32 v28, v6, 4, v28
    s_lshl_b32 s39, s35, 1
    s_lshr_b32 s40, s30, 1
    s_add_u32 s39, s39, s40
    s_mul_i32 s39, s39, 56
    s_mul_i32 s40, s36, 7
    s_add_u32 s39, s39, s40
    s_lshl_b32 s39, s39, 10
    s_add_u32 s41, s39, 13631488
    v_permlane16_swap_b32 v124, v126
    v_permlane16_swap_b32 v125, v127
    buffer_store_dwordx4 v[124:127], v28, s[4:7], s41 offen offset:0 sc1
    v_permlane16_swap_b32 v128, v130
    v_permlane16_swap_b32 v129, v131
    buffer_store_dwordx4 v[128:131], v28, s[4:7], s41 offen offset:2048 sc1
    v_permlane16_swap_b32 v132, v134
    v_permlane16_swap_b32 v133, v135
    s_add_u32 s41, s41, 4096
    buffer_store_dwordx4 v[132:135], v28, s[4:7], s41 offen offset:0 sc1
    v_mov_b32 v138, 0
    v_mov_b32 v139, 0
    s_nop 0
    v_permlane16_swap_b32 v136, v138
    v_permlane16_swap_b32 v137, v139
    s_add_u32 s41, s41, 2048
    s_mov_b32 s44, 0xffff
    s_mov_b32 s45, 0xffff
    s_mov_b64 exec, s[44:45]
    buffer_store_dwordx4 v[136:139], v28, s[4:7], s41 offen sc1
    s_mov_b64 exec, -1
    s_lshl_b32 s39, s35, 1
    s_lshr_b32 s40, s30, 1
    s_add_u32 s39, s39, s40
    s_lshl_b32 s39, s39, 3
    s_add_u32 s39, s39, s36
    s_lshl_b32 s39, s39, 1
    s_and_b32 s40, s30, 1
    s_add_u32 s39, s39, s40
    s_lshl_b32 s39, s39, 7
    s_add_u32 s42, s39, 589824
    s_waitcnt vmcnt(0)
    buffer_store_dwordx2 v[4:5], v2, s[4:7], s42 offen sc1
    s_xor_b32 s40, s37, 0x5a5a5a5a
    s_mov_b32 s41, 0x05040100
    s_mov_b64 s[14:15], -1
    v_perm_b32 v52, v13, v12, s41
    v_perm_b32 v53, v15, v14, s41
    v_cmp_eq_u32 vcc, s37, v52
    v_cmp_eq_u32 s[44:45], s40, v53
    s_nop 2
    s_and_b64 s[14:15], s[14:15], vcc
    s_and_b64 s[14:15], s[14:15], s[44:45]
    v_perm_b32 v52, v17, v16, s41
    v_perm_b32 v53, v19, v18, s41
    v_cmp_eq_u32 vcc, s37, v52
    v_cmp_eq_u32 s[44:45], s40, v53
    s_nop 2
    s_and_b64 s[14:15], s[14:15], vcc
    s_and_b64 s[14:15], s[14:15], s[44:45]
    v_perm_b32 v52, v21, v20, s41
    v_perm_b32 v53, v23, v22, s41
    v_cmp_eq_u32 vcc, s37, v52
    v_cmp_eq_u32 s[44:45], s40, v53
    s_nop 2
    s_and_b64 s[14:15], s[14:15], vcc
    s_and_b64 s[14:15], s[14:15], s[44:45]
    v_perm_b32 v52, v25, v24, s41
    v_perm_b32 v53, v27, v26, s41
    v_cmp_eq_u32 vcc, s37, v52
    v_cmp_eq_u32 s[44:45], s40, v53
    s_nop 2
    s_and_b64 s[14:15], s[14:15], vcc
    s_and_b64 s[14:15], s[14:15], s[44:45]
    s_cmp_eq_u64 s[14:15], -1
    s_nop 0
    s_cbranch_scc1 L_apd_37
    s_mov_b32 s43, 400000
    s_nop 0
L_ap_36:
    buffer_load_dwordx4 v[12:15], v11, s[4:7], s9 offen sc1
    buffer_load_dwordx4 v[16:19], v11, s[4:7], s10 offen sc1
    buffer_load_dwordx4 v[20:23], v11, s[4:7], s11 offen sc1
    buffer_load_dwordx4 v[24:27], v11, s[4:7], s12 offen sc1
    s_waitcnt vmcnt(0)
    s_xor_b32 s40, s37, 0x5a5a5a5a
    s_mov_b32 s41, 0x05040100
    s_mov_b64 s[14:15], -1
    v_perm_b32 v52, v13, v12, s41
    v_perm_b32 v53, v15, v14, s41
    v_cmp_eq_u32 vcc, s37, v52
    v_cmp_eq_u32 s[44:45], s40, v53
    s_nop 2
    s_and_b64 s[14:15], s[14:15], vcc
    s_and_b64 s[14:15], s[14:15], s[44:45]
    v_perm_b32 v52, v17, v16, s41
    v_perm_b32 v53, v19, v18, s41
    v_cmp_eq_u32 vcc, s37, v52
    v_cmp_eq_u32 s[44:45], s40, v53
    s_nop 2
    s_and_b64 s[14:15], s[14:15], vcc
    s_and_b64 s[14:15], s[14:15], s[44:45]
    v_perm_b32 v52, v21, v20, s41
    v_perm_b32 v53, v23, v22, s41
    v_cmp_eq_u32 vcc, s37, v52
    v_cmp_eq_u32 s[44:45], s40, v53
    s_nop 2
    s_and_b64 s[14:15], s[14:15], vcc
    s_and_b64 s[14:15], s[14:15], s[44:45]
    v_perm_b32 v52, v25, v24, s41
    v_perm_b32 v53, v27, v26, s41
    v_cmp_eq_u32 vcc, s37, v52
    v_cmp_eq_u32 s[44:45], s40, v53
    s_nop 2
    s_and_b64 s[14:15], s[14:15], vcc
    s_and_b64 s[14:15], s[14:15], s[44:45]
    s_cmp_eq_u64 s[14:15], -1
    s_nop 0
    s_cbranch_scc1 L_apd_37
    s_sub_u32 s43, s43, 1
    s_cmp_lg_u32 s43, 0
    s_nop 0
    s_cbranch_scc1 L_ap_36
    v_mov_b32 v52, 9
    s_mov_b32 s39, 0
    buffer_store_dword v52, v2, s[24:27], s39 offen
    s_nop 1
L_apd_37:
    v_and_b32 v12, s46, v12
    v_and_b32 v13, s46, v13
    v_and_b32 v14, s46, v14
    v_and_b32 v15, s46, v15
    v_and_b32 v16, s46, v16
    v_and_b32 v17, s46, v17
    v_and_b32 v18, s46, v18
    v_and_b32 v19, s46, v19
    v_and_b32 v20, s46, v20
    v_and_b32 v21, s46, v21
    v_and_b32 v22, s46, v22
    v_and_b32 v23, s46, v23
    v_and_b32 v24, s46, v24
    v_and_b32 v25, s46, v25
    v_and_b32 v26, s46, v26
    v_and_b32 v27, s46, v27
    v_lshlrev_b32 v28, 16, v44
    v_and_b32 v29, s46, v44
    v_lshlrev_b32 v30, 16, v45
    v_and_b32 v31, s46, v45
    v_lshlrev_b32 v32, 16, v46
    v_and_b32 v33, s46, v46
    v_lshlrev_b32 v34, 16, v47
    v_and_b32 v35, s46, v47
    v_lshlrev_b32 v36, 16, v48
    v_and_b32 v37, s46, v48
    v_lshlrev_b32 v38, 16, v49
    v_and_b32 v39, s46, v49
    v_lshlrev_b32 v40, 16, v50
    v_and_b32 v41, s46, v50
    v_lshlrev_b32 v42, 16, v51
    v_and_b32 v43, s46, v51
    v_and_b32 v6, 15, v1
    v_lshlrev_b32 v6, 7, v6
    s_lshl_b32 s39, s33, 11
    s_add_u32 s42, s39, 589824
    s_mov_b32 s43, 400000
    s_nop 0
L_poll_38:
    buffer_load_dwordx2 v[10:11], v6, s[4:7], s42 offen sc1
    s_waitcnt vmcnt(0)
    v_cmp_eq_u32 vcc, s37, v10
    v_cmp_eq_u32 s[44:45], s38, v11
    s_nop 3
    s_and_b64 vcc, vcc, s[44:45]
    s_cmp_eq_u64 vcc, -1
    s_nop 0
    s_cbranch_scc1 L_polld_39
    s_sub_u32 s43, s43, 1
    s_cmp_lg_u32 s43, 0
    s_nop 0
    s_cbranch_scc1 L_poll_38
    v_mov_b32 v10, 10
    s_mov_b32 s39, 0
    buffer_store_dword v10, v2, s[24:27], s39 offen
    s_nop 1
L_polld_39:
    s_waitcnt lgkmcnt(0)
    s_barrier
    s_mul_i32 s39, s33, 57344
    s_lshl_b32 s40, s30, 10
    s_add_u32 s39, s39, s40
    s_add_u32 s39, s39, 13631488
    s_add_u32 m0, s40, 0
    s_nop 0
    buffer_load_dwordx4 v3, s[4:7], s39 offen sc1 lds
    s_add_u32 m0, s40, 4096
    s_add_u32 s39, s39, 4096
    buffer_load_dwordx4 v3, s[4:7], s39 offen sc1 lds
    s_add_u32 m0, s40, 8192
    s_add_u32 s39, s39, 4096
    buffer_load_dwordx4 v3, s[4:7], s39 offen sc1 lds
    s_add_u32 m0, s40, 12288
    s_add_u32 s39, s39, 4096
    buffer_load_dwordx4 v3, s[4:7], s39 offen sc1 lds
    s_add_u32 m0, s40, 16384
    s_add_u32 s39, s39, 4096
    buffer_load_dwordx4 v3, s[4:7], s39 offen sc1 lds
    s_add_u32 m0, s40, 20480
    s_add_u32 s39, s39, 4096
    buffer_load_dwordx4 v3, s[4:7], s39 offen sc1 lds
    s_add_u32 m0, s40, 24576
    s_add_u32 s39, s39, 4096
    buffer_load_dwordx4 v3, s[4:7], s39 offen sc1 lds
    s_add_u32 m0, s40, 28672
    s_add_u32 s39, s39, 4096
    buffer_load_dwordx4 v3, s[4:7], s39 offen sc1 lds
    s_add_u32 m0, s40, 32768
    s_add_u32 s39, s39, 4096
    buffer_load_dwordx4 v3, s[4:7], s39 offen sc1 lds
    s_add_u32 m0, s40, 36864
    s_add_u32 s39, s39, 4096
    buffer_load_dwordx4 v3, s[4:7], s39 offen sc1 lds
    s_add_u32 m0, s40, 40960
    s_add_u32 s39, s39, 4096
    buffer_load_dwordx4 v3, s[4:7], s39 offen sc1 lds
    s_add_u32 m0, s40, 45056
    s_add_u32 s39, s39, 4096
    buffer_load_dwordx4 v3, s[4:7], s39 offen sc1 lds
    s_add_u32 m0, s40, 49152
    s_add_u32 s39, s39, 4096
    buffer_load_dwordx4 v3, s[4:7], s39 offen sc1 lds
    s_add_u32 m0, s40, 53248
    s_add_u32 s39, s39, 4096
    buffer_load_dwordx4 v3, s[4:7], s39 offen sc1 lds
    s_min_u32 s8, s57, 13
    s_mul_i32 s8, s8, 57344
    s_add_u32 s8, s8, 17862656
    s_cmp_lt_u32 s57, 14
    s_cselect_b32 s8, s8, 2130706432
    s_waitcnt vmcnt(10)
    s_barrier
    ds_read_b128 v[68:71], v3 offset:0
    ds_read_b128 v[72:75], v3 offset:1024
    ds_read_b128 v[76:79], v3 offset:2048
    s_waitcnt lgkmcnt(2)
    v_mfma_f32_32x32x16_bf16 v[52:67], a[96:99], v[68:71], 0
    ds_read_b128 v[80:83], v3 offset:3072
    buffer_load_dwordx4 a[112:115], v3, s[4:7], s8 offen offset:3072 sc1
    s_waitcnt lgkmcnt(2)
    v_mfma_f32_32x32x16_bf16 v[52:67], a[100:103], v[72:75], v[52:67]
    ds_read_b128 v[68:71], v3 offset:4096
    s_add_u32 s8, s8, 4096
    buffer_load_dwordx4 a[116:119], v3, s[4:7], s8 offen offset:0 sc1
    s_waitcnt lgkmcnt(2)
    v_mfma_f32_32x32x16_bf16 v[52:67], a[104:107], v[76:79], v[52:67]
    ds_read_b128 v[72:75], v3 offset:5120
    buffer_load_dwordx4 a[120:123], v3, s[4:7], s8 offen offset:1024 sc1
    s_waitcnt lgkmcnt(2)
    v_mfma_f32_32x32x16_bf16 v[52:67], a[108:111], v[80:83], v[52:67]
    ds_read_b128 v[76:79], v3 offset:6144
    buffer_load_dwordx4 a[124:127], v3, s[4:7], s8 offen offset:2048 sc1
    s_waitcnt lgkmcnt(2)
    v_mfma_f32_32x32x16_bf16 v[52:67], a[196:199], v[68:71], v[52:67]
    ds_read_b128 v[80:83], v3 offset:7168
    buffer_load_dwordx4 a[128:131], v3, s[4:7], s8 offen offset:3072 sc1
    s_waitcnt lgkmcnt(2)
    v_mfma_f32_32x32x16_bf16 v[52:67], a[200:203], v[72:75], v[52:67]
    ds_read_b128 v[68:71], v3 offset:8192
    s_add_u32 s8, s8, 4096
    buffer_load_dwordx4 a[132:135], v3, s[4:7], s8 offen offset:0 sc1
    s_waitcnt lgkmcnt(2)
    v_mfma_f32_32x32x16_bf16 v[52:67], a[204:207], v[76:79], v[52:67]
    ds_read_b128 v[72:75], v3 offset:9216
    buffer_load_dwordx4 a[136:139], v3, s[4:7], s8 offen offset:1024 sc1
    s_waitcnt lgkmcnt(2)
    v_mfma_f32_32x32x16_bf16 v[52:67], a[208:211], v[80:83], v[52:67]
    ds_read_b128 v[76:79], v3 offset:10240
    buffer_load_dwordx4 a[140:143], v3, s[4:7], s8 offen offset:2048 sc1
    s_waitcnt lgkmcnt(2)
    v_mfma_f32_32x32x16_bf16 v[52:67], a[212:215], v[68:71], v[52:67]
    ds_read_b128 v[80:83], v3 offset:11264
    buffer_load_dwordx4 a[144:147], v3, s[4:7], s8 offen offset:3072 sc1
    s_waitcnt lgkmcnt(2)
    v_mfma_f32_32x32x16_bf16 v[52:67], a[216:219], v[72:75], v[52:67]
    ds_read_b128 v[68:71], v3 offset:12288
    s_add_u32 s8, s8, 4096
    buffer_load_dwordx4 a[148:151], v3, s[4:7], s8 offen offset:0 sc1
    s_waitcnt lgkmcnt(2)
    v_mfma_f32_32x32x16_bf16 v[52:67], a[220:223], v[76:79], v[52:67]
    ds_read_b128 v[72:75], v3 offset:13312
    buffer_load_dwordx4 a[152:155], v3, s[4:7], s8 offen offset:1024 sc1
    s_waitcnt lgkmcnt(2)
    v_mfma_f32_32x32x16_bf16 v[52:67], a[224:227], v[80:83], v[52:67]
    ds_read_b128 v[76:79], v3 offset:14336
    buffer_load_dwordx4 a[156:159], v3, s[4:7], s8 offen offset:2048 sc1
    s_waitcnt lgkmcnt(2)
    v_mfma_f32_32x32x16_bf16 v[52:67], a[228:231], v[68:71], v[52:67]
    ds_read_b128 v[80:83], v3 offset:15360
    buffer_load_dwordx4 a[160:163], v3, s[4:7], s8 offen offset:3072 sc1
    s_waitcnt lgkmcnt(2)
    v_mfma_f32_32x32x16_bf16 v[52:67], a[232:235], v[72:75], v[52:67]
    s_waitcnt vmcnt(13)
    s_waitcnt lgkmcnt(0)
    s_barrier
    ds_read_b128 v[68:71], v3 offset:16384
    s_add_u32 s8, s8, 4096
    buffer_load_dwordx4 a[164:167], v3, s[4:7], s8 offen offset:0 sc1
    v_mfma_f32_32x32x16_bf16 v[52:67], a[236:239], v[76:79], v[52:67]
    ds_read_b128 v[72:75], v3 offset:17408
    buffer_load_dwordx4 a[168:171], v3, s[4:7], s8 offen offset:1024 sc1
    v_mfma_f32_32x32x16_bf16 v[52:67], a[0:3], v[80:83], v[52:67]
    ds_read_b128 v[76:79], v3 offset:18432
    buffer_load_dwordx4 a[172:175], v3, s[4:7], s8 offen offset:2048 sc1
    s_waitcnt lgkmcnt(2)
    v_mfma_f32_32x32x16_bf16 v[52:67], a[4:7], v[68:71], v[52:67]
    ds_read_b128 v[80:83], v3 offset:19456
    buffer_load_dwordx4 a[176:179], v3, s[4:7], s8 offen offset:3072 sc1
    s_waitcnt lgkmcnt(2)
    v_mfma_f32_32x32x16_bf16 v[52:67], a[8:11], v[72:75], v[52:67]
    ds_read_b128 v[68:71], v3 offset:20480
    s_waitcnt lgkmcnt(2)
    v_mfma_f32_32x32x16_bf16 v[52:67], a[12:15], v[76:79], v[52:67]
    ds_read_b128 v[72:75], v3 offset:21504
    s_waitcnt lgkmcnt(2)
    v_mfma_f32_32x32x16_bf16 v[52:67], a[16:19], v[80:83], v[52:67]
    ds_read_b128 v[76:79], v3 offset:22528
    s_waitcnt lgkmcnt(2)
    v_mfma_f32_32x32x16_bf16 v[52:67], a[20:23], v[68:71], v[52:67]
    ds_read_b128 v[80:83], v3 offset:23552
    s_waitcnt lgkmcnt(2)
    v_mfma_f32_32x32x16_bf16 v[52:67], a[24:27], v[72:75], v[52:67]
    ds_read_b128 v[68:71], v3 offset:24576
    s_waitcnt lgkmcnt(2)
    v_mfma_f32_32x32x16_bf16 v[52:67], a[28:31], v[76:79], v[52:67]
    ds_read_b128 v[72:75], v3 offset:25600
    s_waitcnt lgkmcnt(2)
    v_mfma_f32_32x32x16_bf16 v[52:67], a[32:35], v[80:83], v[52:67]
    ds_read_b128 v[76:79], v3 offset:26624
    s_waitcnt lgkmcnt(2)
    v_mfma_f32_32x32x16_bf16 v[52:67], a[36:39], v[68:71], v[52:67]
    ds_read_b128 v[80:83], v3 offset:27648
    s_waitcnt lgkmcnt(2)
    v_mfma_f32_32x32x16_bf16 v[52:67], a[40:43], v[72:75], v[52:67]
    ds_read_b128 v[68:71], v3 offset:28672
    s_waitcnt lgkmcnt(2)
    v_mfma_f32_32x32x16_bf16 v[52:67], a[44:47], v[76:79], v[52:67]
    ds_read_b128 v[72:75], v3 offset:29696
    s_waitcnt lgkmcnt(2)
    v_mfma_f32_32x32x16_bf16 v[52:67], a[48:51], v[80:83], v[52:67]
    ds_read_b128 v[76:79], v3 offset:30720
    s_waitcnt lgkmcnt(2)
    v_mfma_f32_32x32x16_bf16 v[52:67], a[52:55], v[68:71], v[52:67]
    ds_read_b128 v[80:83], v3 offset:31744
    s_waitcnt lgkmcnt(2)
    v_mfma_f32_32x32x16_bf16 v[52:67], a[56:59], v[72:75], v[52:67]
    ds_read_b128 v[68:71], v3 offset:32768
    s_waitcnt lgkmcnt(2)
    v_mfma_f32_32x32x16_bf16 v[52:67], a[60:63], v[76:79], v[52:67]
    ds_read_b128 v[72:75], v3 offset:33792
    s_waitcnt lgkmcnt(2)
    v_mfma_f32_32x32x16_bf16 v[52:67], a[64:67], v[80:83], v[52:67]
    ds_read_b128 v[76:79], v3 offset:34816
    s_waitcnt lgkmcnt(2)
    v_mfma_f32_32x32x16_bf16 v[52:67], a[68:71], v[68:71], v[52:67]
    ds_read_b128 v[80:83], v3 offset:35840
    s_waitcnt lgkmcnt(2)
    v_mfma_f32_32x32x16_bf16 v[52:67], a[72:75], v[72:75], v[52:67]
    ds_read_b128 v[68:71], v3 offset:36864
    s_waitcnt lgkmcnt(2)
    v_mfma_f32_32x32x16_bf16 v[52:67], a[76:79], v[76:79], v[52:67]
    ds_read_b128 v[72:75], v3 offset:37888
    s_waitcnt lgkmcnt(2)
    v_mfma_f32_32x32x16_bf16 v[52:67], a[80:83], v[80:83], v[52:67]
    ds_read_b128 v[76:79], v3 offset:38912
    s_waitcnt lgkmcnt(2)
    v_mfma_f32_32x32x16_bf16 v[52:67], a[84:87], v[68:71], v[52:67]
    ds_read_b128 v[80:83], v3 offset:39936
    s_waitcnt lgkmcnt(2)
    v_mfma_f32_32x32x16_bf16 v[52:67], a[88:91], v[72:75], v[52:67]
    ds_read_b128 v[68:71], v3 offset:40960
    s_waitcnt lgkmcnt(2)
    v_mfma_f32_32x32x16_bf16 v[52:67], a[92:95], v[76:79], v[52:67]
    ds_read_b128 v[72:75], v3 offset:41984
    s_waitcnt vmcnt(16) lgkmcnt(2)
    v_mfma_f32_32x32x16_bf16 v[52:67], a[112:115], v[80:83], v[52:67]
    ds_read_b128 v[76:79], v3 offset:43008
    s_waitcnt vmcnt(15) lgkmcnt(2)
    v_mfma_f32_32x32x16_bf16 v[52:67], a[116:119], v[68:71], v[52:67]
    ds_read_b128 v[80:83], v3 offset:44032
    s_waitcnt vmcnt(14) lgkmcnt(2)
    v_mfma_f32_32x32x16_bf16 v[52:67], a[120:123], v[72:75], v[52:67]
    ds_read_b128 v[68:71], v3 offset:45056
    s_waitcnt vmcnt(13) lgkmcnt(2)
    v_mfma_f32_32x32x16_bf16 v[52:67], a[124:127], v[76:79], v[52:67]
    ds_read_b128 v[72:75], v3 offset:46080
    s_waitcnt vmcnt(12) lgkmcnt(2)
    v_mfma_f32_32x32x16_bf16 v[52:67], a[128:131], v[80:83], v[52:67]
    ds_read_b128 v[76:79], v3 offset:47104
    s_waitcnt vmcnt(11) lgkmcnt(2)
    v_mfma_f32_32x32x16_bf16 v[52:67], a[132:135], v[68:71], v[52:67]
    ds_read_b128 v[80:83], v3 offset:48128
    s_waitcnt vmcnt(10) lgkmcnt(2)
    v_mfma_f32_32x32x16_bf16 v[52:67], a[136:139], v[72:75], v[52:67]
    ds_read_b128 v[68:71], v3 offset:49152
    s_waitcnt vmcnt(9) lgkmcnt(2)
    v_mfma_f32_32x32x16_bf16 v[52:67], a[140:143], v[76:79], v[52:67]
    ds_read_b128 v[72:75], v3 offset:50176
    s_waitcnt vmcnt(8) lgkmcnt(2)
    v_mfma_f32_32x32x16_bf16 v[52:67], a[144:147], v[80:83], v[52:67]
    ds_read_b128 v[76:79], v3 offset:51200
    s_waitcnt vmcnt(7) lgkmcnt(2)
    v_mfma_f32_32x32x16_bf16 v[52:67], a[148:151], v[68:71], v[52:67]
    ds_read_b128 v[80:83], v3 offset:52224
    s_waitcnt vmcnt(6) lgkmcnt(2)
    v_mfma_f32_32x32x16_bf16 v[52:67], a[152:155], v[72:75], v[52:67]
    ds_read_b128 v[68:71], v3 offset:53248
    s_waitcnt vmcnt(5) lgkmcnt(2)
    v_mfma_f32_32x32x16_bf16 v[52:67], a[156:159], v[76:79], v[52:67]
    ds_read_b128 v[72:75], v3 offset:54272
    s_waitcnt vmcnt(4) lgkmcnt(2)
    v_mfma_f32_32x32x16_bf16 v[52:67], a[160:163], v[80:83], v[52:67]
    ds_read_b128 v[76:79], v3 offset:55296
    s_waitcnt vmcnt(3) lgkmcnt(2)
    v_mfma_f32_32x32x16_bf16 v[52:67], a[164:167], v[68:71], v[52:67]
    ds_read_b128 v[80:83], v3 offset:56320
    s_waitcnt vmcnt(2) lgkmcnt(2)
    v_mfma_f32_32x32x16_bf16 v[52:67], a[168:171], v[72:75], v[52:67]
    s_waitcnt vmcnt(1) lgkmcnt(1)
    v_mfma_f32_32x32x16_bf16 v[52:67], a[172:175], v[76:79], v[52:67]
    s_waitcnt vmcnt(0) lgkmcnt(0)
    v_mfma_f32_32x32x16_bf16 v[52:67], a[176:179], v[80:83], v[52:67]
    s_nop 11
    v_pk_fma_f32 v[28:29], v[12:13], v[52:53], v[28:29]
    v_pk_fma_f32 v[30:31], v[14:15], v[54:55], v[30:31]
    v_pk_fma_f32 v[32:33], v[16:17], v[56:57], v[32:33]
    v_pk_fma_f32 v[34:35], v[18:19], v[58:59], v[34:35]
    v_pk_fma_f32 v[36:37], v[20:21], v[60:61], v[36:37]
    v_pk_fma_f32 v[38:39], v[22:23], v[62:63], v[38:39]
    v_pk_fma_f32 v[40:41], v[24:25], v[64:65], v[40:41]
    v_pk_fma_f32 v[42:43], v[26:27], v[66:67], v[42:43]
    v_cvt_pk_bf16_f32 v68, v28, v29
    v_cvt_pk_bf16_f32 v69, v30, v31
    v_cvt_pk_bf16_f32 v70, v32, v33
    v_cvt_pk_bf16_f32 v71, v34, v35
    v_cvt_pk_bf16_f32 v72, v36, v37
    v_cvt_pk_bf16_f32 v73, v38, v39
    v_cvt_pk_bf16_f32 v74, v40, v41
    v_cvt_pk_bf16_f32 v75, v42, v43
    v_permlane32_swap_b32 v68, v70
    v_permlane32_swap_b32 v69, v71
    v_permlane32_swap_b32 v72, v74
    v_permlane32_swap_b32 v73, v75
    v_and_b32 v6, 31, v1
    v_mul_u32_u24 v6, 896, v6
    v_lshrrev_b32 v7, 5, v1
    v_lshl_add_u32 v6, v7, 4, v6
    s_mul_i32 s39, s33, 28672
    s_lshl_b32 s40, s57, 6
    s_add_u32 s39, s39, s40
    s_cmp_ge_u32 s57, 14
    s_nop 0
    s_cbranch_scc1 L_p6skip_40
    buffer_store_dwordx4 v[68:71], v6, s[60:63], s39 offen offset:0
    buffer_store_dwordx4 v[72:75], v6, s[60:63], s39 offen offset:32
    s_nop 1
L_p6skip_40:
    s_cmp_lg_u32 s3, 0
    s_nop 0
    s_cbranch_scc1 L_noep_41
    s_cmp_lg_u32 s30, 0
    s_nop 0
    s_cbranch_scc1 L_noep_41
    buffer_store_dword v4, v2, s[4:7], 0 offen sc1
    s_nop 1
L_noep_41:
    s_waitcnt vmcnt(0)
    L_end:
    s_endpgm
.section .rodata,"a"
.p2align 6
.amdhsa_kernel adaLN_cond__sliding_block__mixer_gmlp__prompt_kernel
  .amdhsa_next_free_vgpr 512
  .amdhsa_next_free_sgpr 102
  .amdhsa_accum_offset 256
  .amdhsa_group_segment_fixed_size 0
  .amdhsa_kernarg_size 104
  .amdhsa_user_sgpr_count 2
  .amdhsa_user_sgpr_kernarg_segment_ptr 1
  .amdhsa_system_sgpr_workgroup_id_x 1
.end_amdhsa_kernel
```
